```python
import torch

def _softmax(x, axis=-1):
    return torch.softmax(x, dim=axis)
def _gelu(x):
    return torch.nn.functional.gelu(x, approximate="tanh")
def _silu(x):
    return torch.nn.functional.silu(x)
def _sigmoid(x):
    return torch.sigmoid(x)
def _layernorm(x, axis=-1, eps=1e-5):
    m = x.mean(dim=axis, keepdim=True)
    v = x.var(dim=axis, keepdim=True, unbiased=False)
    return (x - m) / torch.sqrt(v + eps)
def _scatter_add(tgt, idx, src, axis=0):
    return tgt.clone().index_add_(axis, idx, src)
def _segment_sum(src, seg, n):
    out = torch.zeros((n,) + src.shape[1:], dtype=src.dtype)
    return out.index_add_(0, seg, src)
def _pad(x, pw):
    flat = tuple(v for pair in reversed(pw) for v in pair)
    return torch.nn.functional.pad(x, flat)

kernel_name = 'gated_mix__linear_attn_block__glu_gated_bilinear__prompt'

def setup_inputs():

    _w = (lambda a: (lambda t: t.to(torch.bfloat16) if t.is_floating_point() else t)(torch.as_tensor(a)))
    def _A_setup():
        B, S, D = 1, 2048, 576
        return {
            "x": _w((lambda *s: torch.randn(*s, dtype=torch.bfloat16) * 0.05)(B, S, D)),
            "wqkv": _w((lambda *s: torch.randn(*s, dtype=torch.bfloat16) * 0.8)(D, 3 * D)),
            "wo": _w((lambda *s: torch.randn(*s, dtype=torch.bfloat16) * 0.05)(D, D)),
        }
    _A_in = _A_setup()

    def _B_setup():
        B, S, D, F = 1, 2048, 576, 4608
        return {
            "x": _w((lambda *s: torch.randn(*s, dtype=torch.bfloat16) * 0.05)(B, S, D)),
            "w_gate": _w((lambda *s: torch.randn(*s, dtype=torch.bfloat16) * 1.6)(D, F) * (D ** -0.5)),
            "w_up": _w((lambda *s: torch.randn(*s, dtype=torch.bfloat16) * 1.6)(D, F) * (D ** -0.5)),
            "w_down": _w((lambda *s: torch.randn(*s, dtype=torch.bfloat16) * 1.6)(F, D) * (F ** -0.5)),
        }
    _B_in = _B_setup()

    return {
        "A_x": _A_in["x"],
        "A_wqkv": _A_in["wqkv"],
        "A_wo": _A_in["wo"],
        "B_x": _B_in["x"],
        "B_w_gate": _B_in["w_gate"],
        "B_w_up": _B_in["w_up"],
        "B_w_down": _B_in["w_down"],
        "gate_w": _w((lambda *s: torch.randn(*s, dtype=torch.bfloat16) * 0.05)(576) * 16.0),
    }

def reference(A_x, A_wqkv, A_wo, B_x, B_w_gate, B_w_up, B_w_down, gate_w):
    def _A_ref(x, wqkv, wo):
        B, S, D = x.shape
        H = 32; Dh = D // H
        qkv = (lambda x, *d: x.permute(*d))((x @ wqkv).reshape(B, S, 3, H, Dh), 2, 0, 3, 1, 4)
        q, k, v = qkv[0], qkv[1], qkv[2]
        phi = lambda t: torch.where(t > 0, t + 1, torch.exp(t)) + 1e-6
        pq, pk = phi(q), phi(k)
        kv = torch.einsum("bhsd,bhse->bhde", pk, v)
        z = torch.einsum("bhsd->bhd", pk)
        num = torch.einsum("bhqd,bhde->bhqe", pq, kv)
        den = torch.einsum("bhqd,bhd->bhq", pq, z)[..., None] + 1e-6
        o = num / den
        return (lambda x, *d: x.permute(*d))(o, 0, 2, 1, 3).reshape(B, S, D) @ wo

    def _B_ref(x, w_gate, w_up, w_down):
        g = torch.einsum("bsd,df->bsf", x, w_gate)
        u = torch.einsum("bsd,df->bsf", x, w_up)
        h = g * u
        return torch.einsum("bsf,fd->bsd", h, w_down)

    x = A_x
    g = _sigmoid((x * gate_w).sum(-1, keepdims=True))
    a = _A_ref(x, A_wqkv, A_wo)
    b = _B_ref(x, B_w_gate, B_w_up, B_w_down)
    return g * a + (1 - g) * b
```

```asm
; @launch grid=(256,1,1) block=(256,1,1) lds=163840
.amdgcn_target "amdgcn-amd-amdhsa--gfx950"
.text
.globl gated_mix__linear_attn_block__glu_gated_bilinear__prompt_kernel
.p2align 8
.type gated_mix__linear_attn_block__glu_gated_bilinear__prompt_kernel,@function
gated_mix__linear_attn_block__glu_gated_bilinear__prompt_kernel:
    s_cmp_ge_u32 s2, 256
    s_cbranch_scc1 L_end
    s_load_dwordx16 s[32:47], s[0:1], 0
    s_load_dwordx4 s[48:51], s[0:1], 64
    s_load_dwordx2 s[52:53], s[0:1], 80
    s_memrealtime s[80:81]
    v_lshrrev_b32 v1, 6, v0
    v_and_b32 v12, 63, v0
    v_readfirstlane_b32 s54, v1
    v_mov_b32 v14, 1073741824
    v_cmp_eq_u32 vcc, 0, v0
    s_getpc_b64 s[24:25]
L_pc:
    s_mov_b32 s26, L_code_end-L_pc
    v_cndmask_b32 v0, v14, 0, vcc
    s_mov_b32 s27, 0x00020000
    s_lshr_b32 s3, s2, 3
    s_lshl_b32 s3, s3, 2
    s_add_u32 s3, s3, s54
    s_lshl_b32 s3, s3, 9
    v_and_b32 v13, 3, v12
    v_lshlrev_b32 v13, 7, v13
    buffer_load_dword v168, v13, s[24:27], s3 offen
    s_and_b32 s58, s2, 3
    s_bfe_u32 s57, s2, 0x30003
    s_lshl_b32 s55, s58, 3
    s_add_u32 s55, s55, s57
    s_and_b32 s56, s2, 4
    s_lshr_b32 s65, s2, 6
    s_add_u32 s56, s56, s65
    s_and_b32 s57, s57, 1
    s_lshl_b32 s57, s57, 1
    s_mov_b32 s95, 8192
    v_lshlrev_b32 v11, 4, v12
    v_lshrrev_b32 v13, 3, v12
    v_lshrrev_b32 v14, 2, v13
    v_and_b32 v15, 3, v13
    v_lshl_add_u32 v14, v14, 3, v15
    v_lshrrev_b32 v13, 1, v13
    v_lshlrev_b32 v13, 5, v13
    v_and_b32 v15, 0x70, v11
    v_xor_b32 v13, v13, v15
    v_mul_u32_u24 v6, 9216, v14
    v_add_u32 v6, v6, v13
    v_lshl_add_u32 v7, v14, 7, v13
    v_lshrrev_b32 v13, 3, v12
    v_mul_u32_u24 v13, 1152, v13
    v_and_b32 v14, 0x30, v12
    v_xor_b32 v14, v14, v15
    v_add_u32 v232, v13, v14
    v_xor_b32 v14, 64, v14
    v_add3_u32 v233, v13, v14, s95
    s_lshl_b32 s60, s54, 12
    s_mul_i32 s61, s54, 147456
    s_lshl_b32 s64, s55, 7
    s_add_u32 s61, s61, s64
    s_lshl_b32 s64, s56, 2
    s_add_u32 s64, s64, s54
    s_lshl_b32 s64, s64, 2
    s_xor_b32 s66, s57, 0
    s_add_u32 s66, s66, s64
    s_mul_i32 s82, s66, 18432
    s_xor_b32 s67, s57, 1
    s_add_u32 s67, s67, s64
    s_mul_i32 s83, s67, 18432
    s_sub_u32 s83, s83, 2048
    s_xor_b32 s68, s57, 2
    s_add_u32 s68, s68, s64
    s_mul_i32 s84, s68, 18432
    s_xor_b32 s69, s57, 3
    s_add_u32 s69, s69, s64
    s_mul_i32 s85, s69, 18432
    s_sub_u32 s85, s85, 2048
    s_lshl_b32 s94, s54, 13
    s_add_u32 s94, s94, 98304
    s_mov_b32 s10, 5308416
    s_mov_b32 s11, 0x00020000
    s_mov_b32 s14, 5310464
    s_mov_b32 s15, 0x00020000
    s_mov_b32 s6, 2359296
    s_mov_b32 s7, 0x00020000
    s_waitcnt lgkmcnt(0)
    s_mov_b32 s8, s40
    s_mov_b32 s9, s41
    s_sub_u32 s12, s42, 2048
    s_subb_u32 s13, s43, 0
    s_mov_b32 s4, s32
    s_mov_b32 s5, s33
    s_add_u32 m0, s60, 0
    s_add_u32 s64, s61, 0
    buffer_load_dwordx4 v6, s[8:11], s64 offen  lds
    s_add_u32 s65, s61, 35840
    buffer_load_dwordx4 v6, s[12:15], s64 offen offset:2048  lds
    buffer_load_dwordx4 v6, s[8:11], s65 offen offset:1024  lds
    buffer_load_dwordx4 v6, s[12:15], s65 offen offset:3072  lds
    s_add_u32 m0, s94, 32768
    s_add_u32 s95, s82, 0
    buffer_load_dwordx4 v232, s[4:7], s95 offen offset:0 lds
    buffer_load_dwordx4 v233, s[4:7], s95 offen offset:1024 lds
    s_add_u32 s95, s83, 0
    buffer_load_dwordx4 v232, s[4:7], s95 offen offset:2048 lds
    buffer_load_dwordx4 v233, s[4:7], s95 offen offset:3072 lds
    s_add_u32 m0, s94, 36864
    s_add_u32 s95, s84, 0
    buffer_load_dwordx4 v232, s[4:7], s95 offen offset:0 lds
    buffer_load_dwordx4 v233, s[4:7], s95 offen offset:1024 lds
    s_add_u32 s95, s85, 0
    buffer_load_dwordx4 v232, s[4:7], s95 offen offset:2048 lds
    buffer_load_dwordx4 v233, s[4:7], s95 offen offset:3072 lds
    s_mov_b32 s91, 0x00020000
    s_mov_b32 s90, 5308416
    s_bitcmp1_b32 s2, 0
    s_cselect_b32 s88, s42, s40
    s_cselect_b32 s89, s43, s41
    s_lshr_b32 s86, s2, 2
    s_mul_i32 s86, s86, 9216
    s_bfe_u32 s3, s2, 0x10001
    s_mov_b32 s92, 589824
    v_lshrrev_b32 v13, 4, v12
    v_mul_lo_u32 v13, v13, s92
    v_and_b32 v14, 15, v12
    v_lshl_add_u32 v13, v14, 7, v13
    s_lshl_b32 s93, s3, 11
    v_add_u32 v236, s93, v13
    s_lshl_b32 s92, s2, 2
    s_add_u32 s92, s92, s54
    s_mul_i32 s87, s92, 2304
    s_mov_b32 s92, 0x3ffff
    s_mov_b32 s93, 0
    v_lshlrev_b32 v240, 3, v11
    v_cndmask_b32 v240, -1, v240, s[92:93]
    buffer_load_dword v240, v240, s[4:7], s87 offen
    s_mul_i32 s87, s54, 1179648
    s_add_u32 s87, s87, s86
    s_add_u32 s87, s87, 589824
    s_cmp_lt_u32 s54, 4
    s_cselect_b32 s92, 4294967295, 0
    s_cselect_b32 s93, 0, 0
    v_cndmask_b32 v241, -1, v236, s[92:93]
    buffer_load_dword v241, v241, s[88:91], s87 offen
    v_lshrrev_b32 v13, 5, v12
    v_lshlrev_b32 v13, 12, v13
    v_and_b32 v14, 3, v12
    v_lshl_add_u32 v9, v14, 3, v13
    v_bfe_u32 v14, v12, 2, 3
    v_lshl_add_u32 v15, v14, 7, v9
    v_lshrrev_b32 v14, 1, v14
    v_lshl_add_u32 v2, v14, 5, v15
    v_xor_b32 v3, 32, v2
    v_xor_b32 v4, 64, v2
    v_xor_b32 v5, 0x60, v2
    v_and_b32 v13, 15, v12
    v_lshrrev_b32 v14, 1, v13
    v_lshrrev_b32 v15, 4, v12
    v_xor_b32 v14, v14, v15
    v_lshlrev_b32 v14, 4, v14
    v_lshl_add_u32 v14, v13, 7, v14
    v_add_u32 v234, s94, v14
    v_xor_b32 v235, 64, v234
    s_mov_b64 exec, 0
    s_cmp_eq_u32 s54, 0
    s_cbranch_scc1 L_wm0
    s_cmp_eq_u32 s54, 1
    s_cbranch_scc1 L_wm1
    s_cmp_eq_u32 s54, 2
    s_cbranch_scc1 L_wm2
    s_branch L_wm3
L_wm_done:
    s_mov_b64 exec, -1
    s_nop 0
    s_nop 0
    s_waitcnt vmcnt(8)
    ds_read_b128 a[0:3], v234 offset:32768
    ds_read_b128 a[16:19], v235 offset:32768
    s_waitcnt vmcnt(6)
    ds_read_b128 a[4:7], v234 offset:34816
    ds_read_b128 a[20:23], v235 offset:34816
    s_waitcnt vmcnt(4)
    ds_read_b128 a[8:11], v234 offset:36864
    ds_read_b128 a[24:27], v235 offset:36864
    s_waitcnt vmcnt(2)
    ds_read_b128 a[12:15], v234 offset:38912
    ds_read_b128 a[28:31], v235 offset:38912
    s_barrier
    ds_read_b64_tr_b16 v[16:17], v2 offset:0
    ds_read_b64_tr_b16 v[18:19], v2 offset:1024
    ds_read_b64_tr_b16 v[20:21], v2 offset:8192
    ds_read_b64_tr_b16 v[22:23], v2 offset:9216
    ds_read_b64_tr_b16 v[24:25], v2 offset:2048
    ds_read_b64_tr_b16 v[26:27], v2 offset:3072
    ds_read_b64_tr_b16 v[28:29], v2 offset:10240
    ds_read_b64_tr_b16 v[30:31], v2 offset:11264
    s_waitcnt lgkmcnt(6)
    v_mfma_f32_16x16x32_bf16 v[40:43], v[16:19], a[0:3], 0
    ds_read_b64_tr_b16 v[32:33], v3 offset:0
    s_add_u32 m0, s60, 16384
    s_mov_b32 s20, s50
    s_waitcnt lgkmcnt(5)
    v_mfma_f32_16x16x32_bf16 v[40:43], v[20:23], a[16:19], v[40:43]
    s_add_u32 s64, s61, 589824
    s_mov_b32 s21, s51
    v_mfma_f32_16x16x32_bf16 v[44:47], v[20:23], a[20:23], 0
    ds_read_b64_tr_b16 v[34:35], v3 offset:1024
    buffer_load_dwordx4 v6, s[8:11], s64 offen  lds
    v_mfma_f32_16x16x32_bf16 v[44:47], v[16:19], a[4:7], v[44:47]
    s_add_u32 s65, s61, 625664
    s_mov_b32 s22, 256
    v_mfma_f32_16x16x32_bf16 v[48:51], v[16:19], a[8:11], 0
    ds_read_b64_tr_b16 v[36:37], v3 offset:8192
    s_mov_b32 s23, 0x00020000
    v_mfma_f32_16x16x32_bf16 v[48:51], v[20:23], a[24:27], v[48:51]
    ds_read_b64_tr_b16 v[38:39], v3 offset:9216
    buffer_load_dwordx4 v6, s[12:15], s64 offen offset:2048  lds
    s_or_b32 s80, s80, 1
    v_mfma_f32_16x16x32_bf16 v[52:55], v[20:23], a[28:31], 0
    buffer_load_dwordx4 v6, s[8:11], s65 offen offset:1024  lds
    v_mov_b32 v13, s80
    v_mfma_f32_16x16x32_bf16 v[52:55], v[16:19], a[12:15], v[52:55]
    buffer_load_dwordx4 v6, s[12:15], s65 offen offset:3072  lds
    s_waitcnt lgkmcnt(4)
    v_mfma_f32_16x16x32_bf16 v[56:59], v[24:27], a[0:3], 0
    ds_read_b64_tr_b16 v[16:17], v3 offset:2048
    s_add_u32 m0, s94, 0
    v_mfma_f32_16x16x32_bf16 v[56:59], v[28:31], a[16:19], v[56:59]
    s_add_u32 s95, s82, 128
    s_cmp_eq_u32 s2, 0
    s_cselect_b32 s74, 0, 1073741824
    v_mfma_f32_16x16x32_bf16 v[60:63], v[28:31], a[20:23], 0
    ds_read_b64_tr_b16 v[18:19], v3 offset:3072
    buffer_store_dword v13, v0, s[20:23], s74 offen sc1
    s_mov_b32 s24, s34
    v_mfma_f32_16x16x32_bf16 v[60:63], v[24:27], a[4:7], v[60:63]
    buffer_load_dwordx4 v232, s[4:7], s95 offen offset:0 lds
    s_mov_b32 s25, s35
    v_mfma_f32_16x16x32_bf16 v[64:67], v[24:27], a[8:11], 0
    ds_read_b64_tr_b16 v[20:21], v3 offset:10240
    buffer_load_dwordx4 v233, s[4:7], s95 offen offset:1024 lds
    v_mfma_f32_16x16x32_bf16 v[64:67], v[28:31], a[24:27], v[64:67]
    ds_read_b64_tr_b16 v[22:23], v3 offset:11264
    s_add_u32 s95, s83, 128
    s_mov_b32 s26, 1990656
    v_mfma_f32_16x16x32_bf16 v[68:71], v[28:31], a[28:31], 0
    buffer_load_dwordx4 v232, s[4:7], s95 offen offset:2048 lds
    s_mov_b32 s27, 0x00020000
    v_mfma_f32_16x16x32_bf16 v[68:71], v[24:27], a[12:15], v[68:71]
    buffer_load_dwordx4 v233, s[4:7], s95 offen offset:3072 lds
    s_waitcnt lgkmcnt(4)
    v_mfma_f32_16x16x32_bf16 v[72:75], v[32:35], a[0:3], 0
    ds_read_b64_tr_b16 v[24:25], v4 offset:0
    s_mov_b32 s28, s46
    v_mfma_f32_16x16x32_bf16 v[72:75], v[36:39], a[16:19], v[72:75]
    s_add_u32 m0, s94, 4096
    s_mov_b32 s29, s47
    v_mfma_f32_16x16x32_bf16 v[76:79], v[36:39], a[20:23], 0
    ds_read_b64_tr_b16 v[26:27], v4 offset:1024
    s_add_u32 s95, s84, 128
    v_mfma_f32_16x16x32_bf16 v[76:79], v[32:35], a[4:7], v[76:79]
    buffer_load_dwordx4 v232, s[4:7], s95 offen offset:0 lds
    s_mov_b32 s30, 1152
    s_mov_b32 s31, 0x00020000
    v_mfma_f32_16x16x32_bf16 v[80:83], v[32:35], a[8:11], 0
    ds_read_b64_tr_b16 v[28:29], v4 offset:8192
    buffer_load_dwordx4 v233, s[4:7], s95 offen offset:1024 lds
    v_mfma_f32_16x16x32_bf16 v[80:83], v[36:39], a[24:27], v[80:83]
    ds_read_b64_tr_b16 v[30:31], v4 offset:9216
    s_mov_b32 s16, s52
    v_mfma_f32_16x16x32_bf16 v[84:87], v[36:39], a[28:31], 0
    s_add_u32 s95, s85, 128
    s_mov_b32 s17, s53
    v_mfma_f32_16x16x32_bf16 v[84:87], v[32:35], a[12:15], v[84:87]
    buffer_load_dwordx4 v232, s[4:7], s95 offen offset:2048 lds
    s_waitcnt lgkmcnt(4)
    v_mfma_f32_16x16x32_bf16 v[88:91], v[16:19], a[0:3], 0
    ds_read_b64_tr_b16 v[32:33], v4 offset:2048
    buffer_load_dwordx4 v233, s[4:7], s95 offen offset:3072 lds
    v_mfma_f32_16x16x32_bf16 v[88:91], v[20:23], a[16:19], v[88:91]
    s_mov_b32 s18, 44040192
    s_mov_b32 s19, 0x00020000
    v_mfma_f32_16x16x32_bf16 v[92:95], v[20:23], a[20:23], 0
    ds_read_b64_tr_b16 v[34:35], v4 offset:3072
    s_lshl_b32 s59, s56, 3
    v_mfma_f32_16x16x32_bf16 v[92:95], v[16:19], a[4:7], v[92:95]
    s_and_b32 s74, s55, 7
    s_add_u32 s59, s59, s74
    v_mfma_f32_16x16x32_bf16 v[96:99], v[16:19], a[8:11], 0
    ds_read_b64_tr_b16 v[36:37], v4 offset:10240
    s_add_u32 m0, s60, 32768
    v_mfma_f32_16x16x32_bf16 v[96:99], v[20:23], a[24:27], v[96:99]
    ds_read_b64_tr_b16 v[38:39], v4 offset:11264
    s_lshl_b32 s59, s59, 2
    v_mfma_f32_16x16x32_bf16 v[100:103], v[20:23], a[28:31], 0
    s_add_u32 s64, s61, 1179648
    s_add_u32 s59, s59, s54
    v_mfma_f32_16x16x32_bf16 v[100:103], v[16:19], a[12:15], v[100:103]
    buffer_load_dwordx4 v6, s[8:11], s64 offen  lds
    s_waitcnt lgkmcnt(4)
    v_mfma_f32_16x16x32_bf16 v[104:107], v[24:27], a[0:3], 0
    ds_read_b64_tr_b16 v[16:17], v5 offset:0
    s_mul_i32 s62, s55, 73728
    v_mfma_f32_16x16x32_bf16 v[104:107], v[28:31], a[16:19], v[104:107]
    s_add_u32 s65, s61, 1215488
    s_add_u32 s62, s62, 30408704
    v_mfma_f32_16x16x32_bf16 v[108:111], v[28:31], a[20:23], 0
    ds_read_b64_tr_b16 v[18:19], v5 offset:1024
    buffer_load_dwordx4 v6, s[12:15], s64 offen offset:2048  lds
    v_mfma_f32_16x16x32_bf16 v[108:111], v[24:27], a[4:7], v[108:111]
    buffer_load_dwordx4 v6, s[8:11], s65 offen offset:1024  lds
    s_lshl_b32 s74, s54, 11
    v_mfma_f32_16x16x32_bf16 v[112:115], v[24:27], a[8:11], 0
    ds_read_b64_tr_b16 v[20:21], v5 offset:8192
    s_add_u32 s62, s62, s74
    v_mfma_f32_16x16x32_bf16 v[112:115], v[28:31], a[24:27], v[112:115]
    ds_read_b64_tr_b16 v[22:23], v5 offset:9216
    buffer_load_dwordx4 v6, s[12:15], s65 offen offset:3072  lds
    v_mfma_f32_16x16x32_bf16 v[116:119], v[28:31], a[28:31], 0
    s_add_u32 m0, s94, 32768
    s_mul_i32 s63, s54, 147456
    v_mfma_f32_16x16x32_bf16 v[116:119], v[24:27], a[12:15], v[116:119]
    s_lshr_b32 s74, s55, 1
    s_waitcnt lgkmcnt(4)
    v_mfma_f32_16x16x32_bf16 v[120:123], v[32:35], a[0:3], 0
    ds_read_b64_tr_b16 v[24:25], v5 offset:2048
    s_add_u32 s95, s82, 256
    v_mfma_f32_16x16x32_bf16 v[120:123], v[36:39], a[16:19], v[120:123]
    s_lshl_b32 s75, s74, 6
    v_mfma_f32_16x16x32_bf16 v[124:127], v[36:39], a[20:23], 0
    ds_read_b64_tr_b16 v[26:27], v5 offset:3072
    s_add_u32 s63, s63, s75
    v_mfma_f32_16x16x32_bf16 v[124:127], v[32:35], a[4:7], v[124:127]
    buffer_load_dwordx4 v232, s[4:7], s95 offen offset:0 lds
    buffer_load_dwordx4 v233, s[4:7], s95 offen offset:1024 lds
    s_add_u32 s63, s63, 8192
    v_mfma_f32_16x16x32_bf16 v[128:131], v[32:35], a[8:11], 0
    ds_read_b64_tr_b16 v[28:29], v5 offset:10240
    s_add_u32 s95, s83, 256
    s_add_u32 s74, s74, 128
    v_mfma_f32_16x16x32_bf16 v[128:131], v[36:39], a[24:27], v[128:131]
    ds_read_b64_tr_b16 v[30:31], v5 offset:11264
    buffer_load_dwordx4 v232, s[4:7], s95 offen offset:2048 lds
    s_lshl_b32 s74, s74, 10
    v_mfma_f32_16x16x32_bf16 v[132:135], v[36:39], a[28:31], 0
    buffer_load_dwordx4 v233, s[4:7], s95 offen offset:3072 lds
    s_add_u32 m0, s94, 36864
    s_lshl_b32 s75, s55, 9
    v_mfma_f32_16x16x32_bf16 v[132:135], v[32:35], a[12:15], v[132:135]
    s_waitcnt vmcnt(17)
    s_barrier
    s_waitcnt lgkmcnt(4)
    v_mfma_f32_16x16x32_bf16 v[136:139], v[16:19], a[0:3], 0
    ds_read_b64_tr_b16 v[32:33], v2 offset:16384
    s_add_u32 s95, s84, 256
    s_add_u32 s75, s75, 18874368
    v_mfma_f32_16x16x32_bf16 v[136:139], v[20:23], a[16:19], v[136:139]
    buffer_load_dwordx4 v232, s[4:7], s95 offen offset:0 lds
    buffer_load_dwordx4 v233, s[4:7], s95 offen offset:1024 lds
    v_mfma_f32_16x16x32_bf16 v[140:143], v[20:23], a[20:23], 0
    ds_read_b64_tr_b16 v[34:35], v2 offset:17408
    s_add_u32 s95, s85, 256
    s_lshl_b32 s32, s66, 14
    v_mfma_f32_16x16x32_bf16 v[140:143], v[16:19], a[4:7], v[140:143]
    s_waitcnt vmcnt(16)
    ds_read_b128 a[32:35], v234 offset:0
    s_add_u32 s32, s32, s75
    v_mfma_f32_16x16x32_bf16 v[144:147], v[16:19], a[8:11], 0
    ds_read_b64_tr_b16 v[36:37], v2 offset:24576
    ds_read_b128 a[48:51], v235 offset:0
    s_mul_i32 s66, s66, 147456
    v_mfma_f32_16x16x32_bf16 v[144:147], v[20:23], a[24:27], v[144:147]
    ds_read_b64_tr_b16 v[38:39], v2 offset:25600
    buffer_load_dwordx4 v232, s[4:7], s95 offen offset:2048 lds
    v_mfma_f32_16x16x32_bf16 v[148:151], v[20:23], a[28:31], 0
    s_waitcnt vmcnt(15)
    ds_read_b128 a[36:39], v234 offset:2048
    v_mfma_f32_16x16x32_bf16 v[148:151], v[16:19], a[12:15], v[148:151]
    ds_read_b128 a[52:55], v235 offset:2048
    s_waitcnt lgkmcnt(8)
    v_mfma_f32_16x16x32_bf16 v[152:155], v[24:27], a[0:3], 0
    ds_read_b64_tr_b16 v[16:17], v2 offset:18432
    buffer_load_dwordx4 v233, s[4:7], s95 offen offset:3072 lds
    v_mfma_f32_16x16x32_bf16 v[152:155], v[28:31], a[16:19], v[152:155]
    s_waitcnt vmcnt(14)
    ds_read_b128 a[40:43], v234 offset:4096
    v_mfma_f32_16x16x32_bf16 v[156:159], v[28:31], a[20:23], 0
    ds_read_b64_tr_b16 v[18:19], v2 offset:19456
    ds_read_b128 a[56:59], v235 offset:4096
    v_mfma_f32_16x16x32_bf16 v[156:159], v[24:27], a[4:7], v[156:159]
    s_waitcnt vmcnt(12)
    ds_read_b128 a[44:47], v234 offset:6144
    v_mfma_f32_16x16x32_bf16 v[160:163], v[24:27], a[8:11], 0
    ds_read_b64_tr_b16 v[20:21], v2 offset:26624
    s_add_u32 s70, s66, s74
    v_mfma_f32_16x16x32_bf16 v[160:163], v[28:31], a[24:27], v[160:163]
    ds_read_b64_tr_b16 v[22:23], v2 offset:27648
    ds_read_b128 a[60:63], v235 offset:6144
    v_mfma_f32_16x16x32_bf16 v[164:167], v[28:31], a[28:31], 0
    s_lshl_b32 s33, s67, 14
    s_add_u32 s33, s33, s75
    v_mfma_f32_16x16x32_bf16 v[164:167], v[24:27], a[12:15], v[164:167]
    s_mul_i32 s67, s67, 147456
    s_waitcnt lgkmcnt(10)
    v_mfma_f32_16x16x32_bf16 v[40:43], v[32:35], a[32:35], v[40:43]
    ds_read_b64_tr_b16 v[24:25], v3 offset:16384
    s_add_u32 s71, s67, s74
    v_mfma_f32_16x16x32_bf16 v[40:43], v[36:39], a[48:51], v[40:43]
    s_lshl_b32 s34, s68, 14
    s_add_u32 s34, s34, s75
    s_waitcnt lgkmcnt(9)
    v_mfma_f32_16x16x32_bf16 v[44:47], v[36:39], a[52:55], v[44:47]
    ds_read_b64_tr_b16 v[26:27], v3 offset:17408
    s_mul_i32 s68, s68, 147456
    v_mfma_f32_16x16x32_bf16 v[44:47], v[32:35], a[36:39], v[44:47]
    s_lshl_b32 s35, s69, 14
    s_add_u32 s35, s35, s75
    s_waitcnt lgkmcnt(8)
    v_mfma_f32_16x16x32_bf16 v[48:51], v[32:35], a[40:43], v[48:51]
    ds_read_b64_tr_b16 v[28:29], v3 offset:24576
    s_mul_i32 s69, s69, 147456
    s_waitcnt lgkmcnt(7)
    v_mfma_f32_16x16x32_bf16 v[48:51], v[36:39], a[56:59], v[48:51]
    ds_read_b64_tr_b16 v[30:31], v3 offset:25600
    s_lshl_b32 s74, s55, 11
    s_waitcnt lgkmcnt(4)
    v_mfma_f32_16x16x32_bf16 v[52:55], v[36:39], a[60:63], v[52:55]
    s_add_u32 m0, s60, 49152
    s_add_u32 s66, s66, s74
    v_mfma_f32_16x16x32_bf16 v[52:55], v[32:35], a[44:47], v[52:55]
    s_add_u32 s67, s67, s74
    v_mfma_f32_16x16x32_bf16 v[56:59], v[16:19], a[32:35], v[56:59]
    ds_read_b64_tr_b16 v[32:33], v3 offset:18432
    s_add_u32 s68, s68, s74
    v_mfma_f32_16x16x32_bf16 v[56:59], v[20:23], a[48:51], v[56:59]
    s_add_u32 s64, s61, 1769472
    s_add_u32 s69, s69, s74
    v_mfma_f32_16x16x32_bf16 v[60:63], v[20:23], a[52:55], v[60:63]
    ds_read_b64_tr_b16 v[34:35], v3 offset:19456
    s_and_b32 s79, s59, 0xfc
    v_mfma_f32_16x16x32_bf16 v[60:63], v[16:19], a[36:39], v[60:63]
    buffer_load_dwordx4 v6, s[8:11], s64 offen  lds
    v_mfma_f32_16x16x32_bf16 v[64:67], v[16:19], a[40:43], v[64:67]
    ds_read_b64_tr_b16 v[36:37], v3 offset:26624
    s_add_u32 s79, s79, s58
    v_mfma_f32_16x16x32_bf16 v[64:67], v[20:23], a[56:59], v[64:67]
    ds_read_b64_tr_b16 v[38:39], v3 offset:27648
    s_lshl_b32 s79, s79, 2
    v_mfma_f32_16x16x32_bf16 v[68:71], v[20:23], a[60:63], v[68:71]
    s_add_u32 s65, s61, 1805312
    s_add_u32 s79, s79, s54
    v_mfma_f32_16x16x32_bf16 v[68:71], v[16:19], a[44:47], v[68:71]
    s_mul_i32 s79, s79, 9216
    s_waitcnt lgkmcnt(4)
    v_mfma_f32_16x16x32_bf16 v[72:75], v[24:27], a[32:35], v[72:75]
    ds_read_b64_tr_b16 v[16:17], v4 offset:16384
    buffer_load_dwordx4 v6, s[12:15], s64 offen offset:2048  lds
    v_mfma_f32_16x16x32_bf16 v[72:75], v[28:31], a[48:51], v[72:75]
    s_add_u32 s79, s79, 33554432
    s_mov_b32 s40, 0x80008000
    v_mfma_f32_16x16x32_bf16 v[76:79], v[28:31], a[52:55], v[76:79]
    ds_read_b64_tr_b16 v[18:19], v4 offset:17408
    s_mov_b32 s41, 0x80008000
    v_mfma_f32_16x16x32_bf16 v[76:79], v[24:27], a[36:39], v[76:79]
    buffer_load_dwordx4 v6, s[8:11], s65 offen offset:1024  lds
    s_mov_b32 s42, 0x0f0f0f0f
    v_mfma_f32_16x16x32_bf16 v[80:83], v[24:27], a[40:43], v[80:83]
    ds_read_b64_tr_b16 v[20:21], v4 offset:24576
    s_mov_b32 s43, 0x0f0f0f0f
    v_mfma_f32_16x16x32_bf16 v[80:83], v[28:31], a[56:59], v[80:83]
    ds_read_b64_tr_b16 v[22:23], v4 offset:25600
    buffer_load_dwordx4 v6, s[12:15], s65 offen offset:3072  lds
    v_mfma_f32_16x16x32_bf16 v[84:87], v[28:31], a[60:63], v[84:87]
    s_mov_b32 s46, 0x11111111
    s_mov_b32 s47, 0x11111111
    v_mfma_f32_16x16x32_bf16 v[84:87], v[24:27], a[44:47], v[84:87]
    s_add_u32 m0, s94, 0
    s_waitcnt lgkmcnt(4)
    v_mfma_f32_16x16x32_bf16 v[88:91], v[32:35], a[32:35], v[88:91]
    ds_read_b64_tr_b16 v[24:25], v4 offset:18432
    s_mov_b32 s50, 0xffff
    v_mfma_f32_16x16x32_bf16 v[88:91], v[36:39], a[48:51], v[88:91]
    s_add_u32 s95, s82, 384
    s_mov_b32 s51, 0
    v_mfma_f32_16x16x32_bf16 v[92:95], v[36:39], a[52:55], v[92:95]
    ds_read_b64_tr_b16 v[26:27], v4 offset:19456
    v_bfe_u32 v14, v11, 8, 1
    v_mfma_f32_16x16x32_bf16 v[92:95], v[32:35], a[36:39], v[92:95]
    v_mul_u32_u24 v14, 544, v14
    v_bfe_u32 v15, v11, 6, 2
    v_mfma_f32_16x16x32_bf16 v[96:99], v[32:35], a[40:43], v[96:99]
    ds_read_b64_tr_b16 v[28:29], v4 offset:26624
    v_mfma_f32_16x16x32_bf16 v[96:99], v[36:39], a[56:59], v[96:99]
    ds_read_b64_tr_b16 v[30:31], v4 offset:27648
    v_lshl_add_u32 v14, v15, 6, v14
    v_mfma_f32_16x16x32_bf16 v[100:103], v[36:39], a[60:63], v[100:103]
    buffer_load_dwordx4 v232, s[4:7], s95 offen offset:0 lds
    v_add_u32 v9, v9, v14
    v_mfma_f32_16x16x32_bf16 v[100:103], v[32:35], a[44:47], v[100:103]
    v_xor_b32 v10, 32, v9
    s_waitcnt lgkmcnt(4)
    v_mfma_f32_16x16x32_bf16 v[104:107], v[16:19], a[32:35], v[104:107]
    ds_read_b64_tr_b16 v[32:33], v5 offset:16384
    v_lshrrev_b32 v13, 6, v11
    v_mfma_f32_16x16x32_bf16 v[104:107], v[20:23], a[48:51], v[104:107]
    buffer_load_dwordx4 v233, s[4:7], s95 offen offset:1024 lds
    v_mul_u32_u24 v13, 9216, v13
    v_mfma_f32_16x16x32_bf16 v[108:111], v[20:23], a[52:55], v[108:111]
    ds_read_b64_tr_b16 v[34:35], v5 offset:17408
    v_and_b32 v14, 0x30, v11
    v_mfma_f32_16x16x32_bf16 v[108:111], v[16:19], a[36:39], v[108:111]
    s_add_u32 s95, s83, 384
    v_lshrrev_b32 v15, 9, v11
    v_mfma_f32_16x16x32_bf16 v[112:115], v[16:19], a[40:43], v[112:115]
    ds_read_b64_tr_b16 v[36:37], v5 offset:24576
    v_lshlrev_b32 v15, 5, v15
    v_mfma_f32_16x16x32_bf16 v[112:115], v[20:23], a[56:59], v[112:115]
    ds_read_b64_tr_b16 v[38:39], v5 offset:25600
    buffer_load_dwordx4 v232, s[4:7], s95 offen offset:2048 lds
    v_mfma_f32_16x16x32_bf16 v[116:119], v[20:23], a[60:63], v[116:119]
    s_waitcnt vmcnt(13)
    ds_read_b128 a[64:67], v234 offset:32768
    v_mfma_f32_16x16x32_bf16 v[116:119], v[16:19], a[44:47], v[116:119]
    v_xor_b32 v14, v14, v15
    s_waitcnt lgkmcnt(5)
    v_mfma_f32_16x16x32_bf16 v[120:123], v[24:27], a[32:35], v[120:123]
    ds_read_b64_tr_b16 v[16:17], v5 offset:18432
    ds_read_b128 a[80:83], v235 offset:32768
    v_mfma_f32_16x16x32_bf16 v[120:123], v[28:31], a[48:51], v[120:123]
    buffer_load_dwordx4 v233, s[4:7], s95 offen offset:3072 lds
    v_add_u32 v8, v13, v14
    v_mfma_f32_16x16x32_bf16 v[124:127], v[28:31], a[52:55], v[124:127]
    ds_read_b64_tr_b16 v[18:19], v5 offset:19456
    s_add_u32 m0, s94, 4096
    v_mfma_f32_16x16x32_bf16 v[124:127], v[24:27], a[36:39], v[124:127]
    s_waitcnt vmcnt(12)
    ds_read_b128 a[68:71], v234 offset:34816
    v_mfma_f32_16x16x32_bf16 v[128:131], v[24:27], a[40:43], v[128:131]
    ds_read_b64_tr_b16 v[20:21], v5 offset:26624
    s_mov_b32 s74, 589824
    v_mfma_f32_16x16x32_bf16 v[128:131], v[28:31], a[56:59], v[128:131]
    ds_read_b64_tr_b16 v[22:23], v5 offset:27648
    s_add_u32 s95, s84, 384
    v_mfma_f32_16x16x32_bf16 v[132:135], v[28:31], a[60:63], v[132:135]
    ds_read_b128 a[84:87], v235 offset:34816
    v_lshrrev_b32 v13, 6, v11
    v_mfma_f32_16x16x32_bf16 v[132:135], v[24:27], a[44:47], v[132:135]
    s_barrier
    s_waitcnt lgkmcnt(8)
    v_mfma_f32_16x16x32_bf16 v[136:139], v[32:35], a[32:35], v[136:139]
    ds_read_b64_tr_b16 v[24:25], v2 offset:32768
    buffer_load_dwordx4 v232, s[4:7], s95 offen offset:0 lds
    v_mul_lo_u32 v13, v13, s74
    v_mfma_f32_16x16x32_bf16 v[136:139], v[36:39], a[48:51], v[136:139]
    s_waitcnt vmcnt(11)
    ds_read_b128 a[72:75], v234 offset:36864
    v_and_b32 v14, 0x30, v11
    v_mfma_f32_16x16x32_bf16 v[140:143], v[36:39], a[52:55], v[140:143]
    ds_read_b64_tr_b16 v[26:27], v2 offset:33792
    buffer_load_dwordx4 v233, s[4:7], s95 offen offset:1024 lds
    v_mfma_f32_16x16x32_bf16 v[140:143], v[32:35], a[36:39], v[140:143]
    v_lshl_add_u32 v13, v14, 3, v13
    s_bfe_u32 s74, s2, 0x10001
    v_mfma_f32_16x16x32_bf16 v[144:147], v[32:35], a[40:43], v[144:147]
    ds_read_b64_tr_b16 v[28:29], v2 offset:40960
    s_add_u32 s95, s85, 384
    v_mfma_f32_16x16x32_bf16 v[144:147], v[36:39], a[56:59], v[144:147]
    ds_read_b64_tr_b16 v[30:31], v2 offset:41984
    ds_read_b128 a[88:91], v235 offset:36864
    v_mfma_f32_16x16x32_bf16 v[148:151], v[36:39], a[60:63], v[148:151]
    s_lshl_b32 s74, s74, 9
    v_add_u32 v237, s74, v13
    v_mfma_f32_16x16x32_bf16 v[148:151], v[32:35], a[44:47], v[148:151]
    buffer_load_dwordx4 v232, s[4:7], s95 offen offset:2048 lds
    s_waitcnt lgkmcnt(7)
    v_mfma_f32_16x16x32_bf16 v[152:155], v[16:19], a[32:35], v[152:155]
    ds_read_b64_tr_b16 v[32:33], v2 offset:34816
    v_mfma_f32_16x16x32_bf16 v[152:155], v[20:23], a[48:51], v[152:155]
    s_waitcnt vmcnt(11)
    ds_read_b128 a[76:79], v234 offset:38912
    v_mfma_f32_16x16x32_bf16 v[156:159], v[20:23], a[52:55], v[156:159]
    ds_read_b64_tr_b16 v[34:35], v2 offset:35840
    buffer_load_dwordx4 v233, s[4:7], s95 offen offset:3072 lds
    v_mfma_f32_16x16x32_bf16 v[156:159], v[16:19], a[36:39], v[156:159]
    ds_read_b128 a[92:95], v235 offset:38912
    v_mov_b32 v1, 0
    v_mfma_f32_16x16x32_bf16 v[160:163], v[16:19], a[40:43], v[160:163]
    ds_read_b64_tr_b16 v[36:37], v2 offset:43008
    v_mfma_f32_16x16x32_bf16 v[160:163], v[20:23], a[56:59], v[160:163]
    ds_read_b64_tr_b16 v[38:39], v2 offset:44032
    buffer_load_dword v1, v1, s[20:23], 0 offen sc1
    v_mfma_f32_16x16x32_bf16 v[164:167], v[20:23], a[60:63], v[164:167]
    v_mfma_f32_16x16x32_bf16 v[164:167], v[16:19], a[44:47], v[164:167]
    s_waitcnt lgkmcnt(7)
    v_mfma_f32_16x16x32_bf16 v[40:43], v[24:27], a[64:67], v[40:43]
    ds_read_b64_tr_b16 v[16:17], v3 offset:32768
    v_mfma_f32_16x16x32_bf16 v[40:43], v[28:31], a[80:83], v[40:43]
    v_mfma_f32_16x16x32_bf16 v[44:47], v[28:31], a[84:87], v[44:47]
    ds_read_b64_tr_b16 v[18:19], v3 offset:33792
    v_mfma_f32_16x16x32_bf16 v[44:47], v[24:27], a[68:71], v[44:47]
    v_mfma_f32_16x16x32_bf16 v[48:51], v[24:27], a[72:75], v[48:51]
    ds_read_b64_tr_b16 v[20:21], v3 offset:40960
    s_waitcnt lgkmcnt(9)
    v_mfma_f32_16x16x32_bf16 v[48:51], v[28:31], a[88:91], v[48:51]
    ds_read_b64_tr_b16 v[22:23], v3 offset:41984
    s_lshr_b32 s72, s59, 2
    s_waitcnt lgkmcnt(6)
    v_mfma_f32_16x16x32_bf16 v[52:55], v[28:31], a[92:95], v[52:55]
    s_add_u32 m0, s60, 65536
    s_mul_i32 s72, s72, 9
    v_mfma_f32_16x16x32_bf16 v[52:55], v[24:27], a[76:79], v[52:55]
    s_waitcnt lgkmcnt(4)
    v_mfma_f32_16x16x32_bf16 v[56:59], v[32:35], a[64:67], v[56:59]
    ds_read_b64_tr_b16 v[24:25], v3 offset:34816
    s_lshl_b32 s73, s72, 1
    v_mfma_f32_16x16x32_bf16 v[56:59], v[36:39], a[80:83], v[56:59]
    s_add_u32 s64, s61, 2359296
    s_mul_i32 s74, s72, 3456
    v_mfma_f32_16x16x32_bf16 v[60:63], v[36:39], a[84:87], v[60:63]
    ds_read_b64_tr_b16 v[26:27], v3 offset:35840
    s_mul_i32 s75, s58, 288
    v_mfma_f32_16x16x32_bf16 v[60:63], v[32:35], a[68:71], v[60:63]
    buffer_load_dwordx4 v6, s[8:11], s64 offen  lds
    v_mfma_f32_16x16x32_bf16 v[64:67], v[32:35], a[72:75], v[64:67]
    ds_read_b64_tr_b16 v[28:29], v3 offset:43008
    s_add_u32 s74, s74, s75
    v_mfma_f32_16x16x32_bf16 v[64:67], v[36:39], a[88:91], v[64:67]
    ds_read_b64_tr_b16 v[30:31], v3 offset:44032
    s_lshl_b32 s72, s72, 7
    v_mfma_f32_16x16x32_bf16 v[68:71], v[36:39], a[92:95], v[68:71]
    s_add_u32 s65, s61, 2395136
    s_mul_i32 s75, s58, 589824
    v_mfma_f32_16x16x32_bf16 v[68:71], v[32:35], a[76:79], v[68:71]
    s_add_u32 s72, s72, s75
    s_waitcnt lgkmcnt(4)
    v_mfma_f32_16x16x32_bf16 v[72:75], v[16:19], a[64:67], v[72:75]
    ds_read_b64_tr_b16 v[32:33], v4 offset:32768
    buffer_load_dwordx4 v6, s[12:15], s64 offen offset:2048  lds
    v_mfma_f32_16x16x32_bf16 v[72:75], v[20:23], a[80:83], v[72:75]
    s_add_u32 s72, s72, 30408704
    v_mfma_f32_16x16x32_bf16 v[76:79], v[20:23], a[84:87], v[76:79]
    ds_read_b64_tr_b16 v[34:35], v4 offset:33792
    s_mul_i32 s75, s54, 18
    v_mfma_f32_16x16x32_bf16 v[76:79], v[16:19], a[68:71], v[76:79]
    buffer_load_dwordx4 v6, s[8:11], s65 offen offset:1024  lds
    v_mfma_f32_16x16x32_bf16 v[80:83], v[16:19], a[72:75], v[80:83]
    ds_read_b64_tr_b16 v[36:37], v4 offset:40960
    v_bfe_u32 v13, v11, 4, 4
    v_mfma_f32_16x16x32_bf16 v[80:83], v[20:23], a[88:91], v[80:83]
    ds_read_b64_tr_b16 v[38:39], v4 offset:41984
    buffer_load_dwordx4 v6, s[12:15], s65 offen offset:3072  lds
    v_mfma_f32_16x16x32_bf16 v[84:87], v[20:23], a[92:95], v[84:87]
    v_lshrrev_b32 v14, 8, v11
    v_add_u32 v253, s75, v14
    v_mfma_f32_16x16x32_bf16 v[84:87], v[16:19], a[76:79], v[84:87]
    s_add_u32 m0, s94, 32768
    s_waitcnt lgkmcnt(4)
L_wm0:
    s_cbranch_execz L_wm4
    v_mfma_f32_16x16x32_bf16 v[88:91], v[24:27], a[64:67], v[88:91]
    ds_read_b64_tr_b16 v[16:17], v4 offset:34816
    v_cmp_gt_u32 vcc, 12, v13
    v_mfma_f32_16x16x32_bf16 v[88:91], v[28:31], a[80:83], v[88:91]
    s_add_u32 s95, s82, 512
    v_lshrrev_b32 v14, 2, v13
    v_mfma_f32_16x16x32_bf16 v[92:95], v[28:31], a[84:87], v[92:95]
    ds_read_b64_tr_b16 v[18:19], v4 offset:35840
    v_subrev_u32 v15, 12, v13
    v_mfma_f32_16x16x32_bf16 v[92:95], v[24:27], a[68:71], v[92:95]
    v_cndmask_b32 v14, v15, v14, vcc
    v_and_b32 v254, 3, v13
    v_mfma_f32_16x16x32_bf16 v[96:99], v[24:27], a[72:75], v[96:99]
    ds_read_b64_tr_b16 v[20:21], v4 offset:43008
    v_mfma_f32_16x16x32_bf16 v[96:99], v[28:31], a[88:91], v[96:99]
    ds_read_b64_tr_b16 v[22:23], v4 offset:44032
    v_lshlrev_b32 v254, 3, v254
    v_mfma_f32_16x16x32_bf16 v[100:103], v[28:31], a[92:95], v[100:103]
    buffer_load_dwordx4 v232, s[4:7], s95 offen offset:0 lds
    v_cndmask_b32 v254, 28, v254, vcc
    v_mfma_f32_16x16x32_bf16 v[100:103], v[24:27], a[76:79], v[100:103]
    v_add_u32 v14, 1, v14
    s_waitcnt lgkmcnt(4)
    v_mfma_f32_16x16x32_bf16 v[104:107], v[32:35], a[64:67], v[104:107]
    ds_read_b64_tr_b16 v[24:25], v5 offset:32768
    v_subrev_u32 v15, 3, v14
    v_mfma_f32_16x16x32_bf16 v[104:107], v[36:39], a[80:83], v[104:107]
    buffer_load_dwordx4 v233, s[4:7], s95 offen offset:1024 lds
    v_min_u32 v14, v14, v15
    v_mfma_f32_16x16x32_bf16 v[108:111], v[36:39], a[84:87], v[108:111]
    ds_read_b64_tr_b16 v[26:27], v5 offset:33792
    v_mul_u32_u24 v14, 1152, v14
    v_mfma_f32_16x16x32_bf16 v[108:111], v[32:35], a[68:71], v[108:111]
    s_add_u32 s95, s83, 512
    v_add_u32 v254, v254, v14
    v_mfma_f32_16x16x32_bf16 v[112:115], v[32:35], a[72:75], v[112:115]
    ds_read_b64_tr_b16 v[28:29], v5 offset:40960
    v_lshlrev_b32 v13, 3, v13
    v_mfma_f32_16x16x32_bf16 v[112:115], v[36:39], a[88:91], v[112:115]
    ds_read_b64_tr_b16 v[30:31], v5 offset:41984
    buffer_load_dwordx4 v232, s[4:7], s95 offen offset:2048 lds
    v_mfma_f32_16x16x32_bf16 v[116:119], v[36:39], a[92:95], v[116:119]
    s_waitcnt vmcnt(14)
    ds_read_b128 a[96:99], v234 offset:0
    v_mfma_f32_16x16x32_bf16 v[116:119], v[32:35], a[76:79], v[116:119]
    v_add_u32 v14, 0, v253
    s_waitcnt lgkmcnt(5)
    v_mfma_f32_16x16x32_bf16 v[120:123], v[16:19], a[64:67], v[120:123]
    ds_read_b64_tr_b16 v[32:33], v5 offset:34816
    ds_read_b128 a[112:115], v235 offset:0
    v_mfma_f32_16x16x32_bf16 v[120:123], v[20:23], a[80:83], v[120:123]
    buffer_load_dwordx4 v233, s[4:7], s95 offen offset:3072 lds
    v_and_b32 v15, 7, v14
    v_mfma_f32_16x16x32_bf16 v[124:127], v[20:23], a[84:87], v[124:127]
    ds_read_b64_tr_b16 v[34:35], v5 offset:35840
    s_add_u32 m0, s94, 36864
    v_mfma_f32_16x16x32_bf16 v[124:127], v[16:19], a[68:71], v[124:127]
    s_waitcnt vmcnt(13)
    ds_read_b128 a[100:103], v234 offset:2048
    v_mfma_f32_16x16x32_bf16 v[128:131], v[16:19], a[72:75], v[128:131]
    ds_read_b64_tr_b16 v[36:37], v5 offset:43008
    v_lshrrev_b32 v14, 3, v14
    v_mfma_f32_16x16x32_bf16 v[128:131], v[20:23], a[88:91], v[128:131]
    ds_read_b64_tr_b16 v[38:39], v5 offset:44032
    s_add_u32 s95, s84, 512
    v_mfma_f32_16x16x32_bf16 v[132:135], v[20:23], a[92:95], v[132:135]
    ds_read_b128 a[116:119], v235 offset:2048
    v_mul_u32_u24 v168, 3456, v14
    v_mfma_f32_16x16x32_bf16 v[132:135], v[16:19], a[76:79], v[132:135]
    s_barrier
    s_waitcnt lgkmcnt(8)
    v_mfma_f32_16x16x32_bf16 v[136:139], v[24:27], a[64:67], v[136:139]
    ds_read_b64_tr_b16 v[16:17], v2 offset:49152
    buffer_load_dwordx4 v232, s[4:7], s95 offen offset:0 lds
    v_mfma_f32_16x16x32_bf16 v[136:139], v[28:31], a[80:83], v[136:139]
    s_waitcnt vmcnt(12)
    ds_read_b128 a[104:107], v234 offset:4096
    v_mfma_f32_16x16x32_bf16 v[140:143], v[28:31], a[84:87], v[140:143]
    ds_read_b64_tr_b16 v[18:19], v2 offset:50176
    buffer_load_dwordx4 v233, s[4:7], s95 offen offset:1024 lds
    v_mfma_f32_16x16x32_bf16 v[140:143], v[24:27], a[68:71], v[140:143]
    v_mad_u32_u24 v168, v15, 36, v168
    v_add_u32 v168, v168, v254
    v_mfma_f32_16x16x32_bf16 v[144:147], v[24:27], a[72:75], v[144:147]
    ds_read_b64_tr_b16 v[20:21], v2 offset:57344
    s_add_u32 s95, s85, 512
    v_mfma_f32_16x16x32_bf16 v[144:147], v[28:31], a[88:91], v[144:147]
    ds_read_b64_tr_b16 v[22:23], v2 offset:58368
    ds_read_b128 a[120:123], v235 offset:4096
    v_mfma_f32_16x16x32_bf16 v[148:151], v[28:31], a[92:95], v[148:151]
    v_lshlrev_b32 v178, 1, v14
    v_mul_u32_u24 v15, 73728, v15
    v_mfma_f32_16x16x32_bf16 v[148:151], v[24:27], a[76:79], v[148:151]
    buffer_load_dwordx4 v232, s[4:7], s95 offen offset:2048 lds
    s_waitcnt lgkmcnt(7)
    v_mfma_f32_16x16x32_bf16 v[152:155], v[32:35], a[64:67], v[152:155]
    ds_read_b64_tr_b16 v[24:25], v2 offset:51200
    v_lshl_add_u32 v14, v14, 7, v13
    v_mfma_f32_16x16x32_bf16 v[152:155], v[36:39], a[80:83], v[152:155]
    s_waitcnt vmcnt(12)
    ds_read_b128 a[108:111], v234 offset:6144
    v_mfma_f32_16x16x32_bf16 v[156:159], v[36:39], a[84:87], v[156:159]
    ds_read_b64_tr_b16 v[26:27], v2 offset:52224
    buffer_load_dwordx4 v233, s[4:7], s95 offen offset:3072 lds
    v_mfma_f32_16x16x32_bf16 v[156:159], v[32:35], a[68:71], v[156:159]
    ds_read_b128 a[124:127], v235 offset:6144
    v_add_u32 v248, v14, v15
    v_mfma_f32_16x16x32_bf16 v[160:163], v[32:35], a[72:75], v[160:163]
    ds_read_b64_tr_b16 v[28:29], v2 offset:59392
    buffer_load_dwordx2 v[168:169], v168, s[24:27], s74 offen
    v_mfma_f32_16x16x32_bf16 v[160:163], v[36:39], a[88:91], v[160:163]
    ds_read_b64_tr_b16 v[30:31], v2 offset:60416
    buffer_load_ushort v178, v178, s[28:31], s73 offen
    v_mfma_f32_16x16x32_bf16 v[164:167], v[36:39], a[92:95], v[164:167]
    v_add_u32 v14, 4, v253
    v_and_b32 v15, 7, v14
    v_mfma_f32_16x16x32_bf16 v[164:167], v[32:35], a[76:79], v[164:167]
    v_lshrrev_b32 v14, 3, v14
    s_waitcnt lgkmcnt(7)
    v_mfma_f32_16x16x32_bf16 v[40:43], v[16:19], a[96:99], v[40:43]
    ds_read_b64_tr_b16 v[32:33], v3 offset:49152
    v_mul_u32_u24 v170, 3456, v14
    v_mfma_f32_16x16x32_bf16 v[40:43], v[20:23], a[112:115], v[40:43]
    v_mad_u32_u24 v170, v15, 36, v170
    v_add_u32 v170, v170, v254
    v_mfma_f32_16x16x32_bf16 v[44:47], v[20:23], a[116:119], v[44:47]
    ds_read_b64_tr_b16 v[34:35], v3 offset:50176
    v_lshlrev_b32 v179, 1, v14
    v_mfma_f32_16x16x32_bf16 v[44:47], v[16:19], a[100:103], v[44:47]
    v_mul_u32_u24 v15, 73728, v15
    v_mfma_f32_16x16x32_bf16 v[48:51], v[16:19], a[104:107], v[48:51]
    ds_read_b64_tr_b16 v[36:37], v3 offset:57344
    v_lshl_add_u32 v14, v14, 7, v13
    s_waitcnt lgkmcnt(9)
    v_mfma_f32_16x16x32_bf16 v[48:51], v[20:23], a[120:123], v[48:51]
    ds_read_b64_tr_b16 v[38:39], v3 offset:58368
    v_add_u32 v249, v14, v15
    s_waitcnt lgkmcnt(6)
    v_mfma_f32_16x16x32_bf16 v[52:55], v[20:23], a[124:127], v[52:55]
    s_add_u32 m0, s60, 81920
    buffer_load_dwordx2 v[170:171], v170, s[24:27], s74 offen
    v_mfma_f32_16x16x32_bf16 v[52:55], v[16:19], a[108:111], v[52:55]
    s_waitcnt lgkmcnt(4)
    v_mfma_f32_16x16x32_bf16 v[56:59], v[24:27], a[96:99], v[56:59]
    ds_read_b64_tr_b16 v[16:17], v3 offset:51200
    buffer_load_ushort v179, v179, s[28:31], s73 offen
    v_mfma_f32_16x16x32_bf16 v[56:59], v[28:31], a[112:115], v[56:59]
    s_add_u32 s64, s61, 2949120
    v_add_u32 v14, 8, v253
    v_mfma_f32_16x16x32_bf16 v[60:63], v[28:31], a[116:119], v[60:63]
    ds_read_b64_tr_b16 v[18:19], v3 offset:52224
    v_and_b32 v15, 7, v14
    v_mfma_f32_16x16x32_bf16 v[60:63], v[24:27], a[100:103], v[60:63]
    buffer_load_dwordx4 v6, s[8:11], s64 offen  lds
    v_mfma_f32_16x16x32_bf16 v[64:67], v[24:27], a[104:107], v[64:67]
    ds_read_b64_tr_b16 v[20:21], v3 offset:59392
    v_lshrrev_b32 v14, 3, v14
    v_mfma_f32_16x16x32_bf16 v[64:67], v[28:31], a[120:123], v[64:67]
    ds_read_b64_tr_b16 v[22:23], v3 offset:60416
    v_mul_u32_u24 v172, 3456, v14
    v_mfma_f32_16x16x32_bf16 v[68:71], v[28:31], a[124:127], v[68:71]
    s_add_u32 s65, s61, 2984960
    v_mad_u32_u24 v172, v15, 36, v172
    v_mfma_f32_16x16x32_bf16 v[68:71], v[24:27], a[108:111], v[68:71]
    v_add_u32 v172, v172, v254
    s_waitcnt lgkmcnt(4)
    v_mfma_f32_16x16x32_bf16 v[72:75], v[32:35], a[96:99], v[72:75]
    ds_read_b64_tr_b16 v[24:25], v4 offset:49152
    buffer_load_dwordx4 v6, s[12:15], s64 offen offset:2048  lds
    v_mfma_f32_16x16x32_bf16 v[72:75], v[36:39], a[112:115], v[72:75]
    v_lshlrev_b32 v180, 1, v14
    v_mul_u32_u24 v15, 73728, v15
    v_mfma_f32_16x16x32_bf16 v[76:79], v[36:39], a[116:119], v[76:79]
    ds_read_b64_tr_b16 v[26:27], v4 offset:50176
    v_lshl_add_u32 v14, v14, 7, v13
    v_mfma_f32_16x16x32_bf16 v[76:79], v[32:35], a[100:103], v[76:79]
    buffer_load_dwordx4 v6, s[8:11], s65 offen offset:1024  lds
    v_add_u32 v250, v14, v15
    v_mfma_f32_16x16x32_bf16 v[80:83], v[32:35], a[104:107], v[80:83]
    ds_read_b64_tr_b16 v[28:29], v4 offset:57344
    buffer_load_dwordx2 v[172:173], v172, s[24:27], s74 offen
    v_mfma_f32_16x16x32_bf16 v[80:83], v[36:39], a[120:123], v[80:83]
    ds_read_b64_tr_b16 v[30:31], v4 offset:58368
    buffer_load_dwordx4 v6, s[12:15], s65 offen offset:3072  lds
    v_mfma_f32_16x16x32_bf16 v[84:87], v[36:39], a[124:127], v[84:87]
    buffer_load_ushort v180, v180, s[28:31], s73 offen
    v_add_u32 v14, 12, v253
    v_mfma_f32_16x16x32_bf16 v[84:87], v[32:35], a[108:111], v[84:87]
    s_add_u32 m0, s94, 0
    s_waitcnt lgkmcnt(4)
    v_mfma_f32_16x16x32_bf16 v[88:91], v[16:19], a[96:99], v[88:91]
    ds_read_b64_tr_b16 v[32:33], v4 offset:51200
    v_and_b32 v15, 7, v14
    v_mfma_f32_16x16x32_bf16 v[88:91], v[20:23], a[112:115], v[88:91]
    s_add_u32 s95, s82, 640
    v_lshrrev_b32 v14, 3, v14
    v_mfma_f32_16x16x32_bf16 v[92:95], v[20:23], a[116:119], v[92:95]
    ds_read_b64_tr_b16 v[34:35], v4 offset:52224
    v_mul_u32_u24 v174, 3456, v14
    v_mfma_f32_16x16x32_bf16 v[92:95], v[16:19], a[100:103], v[92:95]
    v_mad_u32_u24 v174, v15, 36, v174
    v_add_u32 v174, v174, v254
    v_mfma_f32_16x16x32_bf16 v[96:99], v[16:19], a[104:107], v[96:99]
    ds_read_b64_tr_b16 v[36:37], v4 offset:59392
    v_mfma_f32_16x16x32_bf16 v[96:99], v[20:23], a[120:123], v[96:99]
    ds_read_b64_tr_b16 v[38:39], v4 offset:60416
    v_lshlrev_b32 v181, 1, v14
    v_mfma_f32_16x16x32_bf16 v[100:103], v[20:23], a[124:127], v[100:103]
    buffer_load_dwordx4 v232, s[4:7], s95 offen offset:0 lds
    v_mul_u32_u24 v15, 73728, v15
    v_mfma_f32_16x16x32_bf16 v[100:103], v[16:19], a[108:111], v[100:103]
    v_lshl_add_u32 v14, v14, 7, v13
    s_waitcnt lgkmcnt(4)
    v_mfma_f32_16x16x32_bf16 v[104:107], v[24:27], a[96:99], v[104:107]
    ds_read_b64_tr_b16 v[16:17], v5 offset:49152
    v_add_u32 v251, v14, v15
    v_mfma_f32_16x16x32_bf16 v[104:107], v[28:31], a[112:115], v[104:107]
    buffer_load_dwordx4 v233, s[4:7], s95 offen offset:1024 lds
    buffer_load_dwordx2 v[174:175], v174, s[24:27], s74 offen
    v_mfma_f32_16x16x32_bf16 v[108:111], v[28:31], a[116:119], v[108:111]
    ds_read_b64_tr_b16 v[18:19], v5 offset:50176
    buffer_load_ushort v181, v181, s[28:31], s73 offen
    v_mfma_f32_16x16x32_bf16 v[108:111], v[24:27], a[100:103], v[108:111]
    s_add_u32 s95, s83, 640
    v_add_u32 v14, 14, v253
    v_mfma_f32_16x16x32_bf16 v[112:115], v[24:27], a[104:107], v[112:115]
    ds_read_b64_tr_b16 v[20:21], v5 offset:57344
    v_and_b32 v15, 7, v14
    v_mfma_f32_16x16x32_bf16 v[112:115], v[28:31], a[120:123], v[112:115]
    ds_read_b64_tr_b16 v[22:23], v5 offset:58368
    buffer_load_dwordx4 v232, s[4:7], s95 offen offset:2048 lds
    v_mfma_f32_16x16x32_bf16 v[116:119], v[28:31], a[124:127], v[116:119]
    s_waitcnt vmcnt(21)
    ds_read_b128 a[128:131], v234 offset:32768
    v_mfma_f32_16x16x32_bf16 v[116:119], v[24:27], a[108:111], v[116:119]
    v_lshrrev_b32 v14, 3, v14
    s_waitcnt lgkmcnt(5)
    v_mfma_f32_16x16x32_bf16 v[120:123], v[32:35], a[96:99], v[120:123]
    ds_read_b64_tr_b16 v[24:25], v5 offset:51200
    ds_read_b128 a[144:147], v235 offset:32768
    v_mfma_f32_16x16x32_bf16 v[120:123], v[36:39], a[112:115], v[120:123]
    buffer_load_dwordx4 v233, s[4:7], s95 offen offset:3072 lds
    v_mul_u32_u24 v176, 3456, v14
    v_mfma_f32_16x16x32_bf16 v[124:127], v[36:39], a[116:119], v[124:127]
    ds_read_b64_tr_b16 v[26:27], v5 offset:52224
    s_add_u32 m0, s94, 4096
    v_mfma_f32_16x16x32_bf16 v[124:127], v[32:35], a[100:103], v[124:127]
    s_waitcnt vmcnt(20)
    ds_read_b128 a[132:135], v234 offset:34816
    v_mfma_f32_16x16x32_bf16 v[128:131], v[32:35], a[104:107], v[128:131]
    ds_read_b64_tr_b16 v[28:29], v5 offset:59392
    s_add_u32 s95, s84, 640
    v_mfma_f32_16x16x32_bf16 v[128:131], v[36:39], a[120:123], v[128:131]
    ds_read_b64_tr_b16 v[30:31], v5 offset:60416
    ds_read_b128 a[148:151], v235 offset:34816
    v_mfma_f32_16x16x32_bf16 v[132:135], v[36:39], a[124:127], v[132:135]
    s_waitcnt vmcnt(18)
    ds_read_b128 a[136:139], v234 offset:36864
    v_mad_u32_u24 v176, v15, 36, v176
    v_mfma_f32_16x16x32_bf16 v[132:135], v[32:35], a[108:111], v[132:135]
    s_barrier
    s_waitcnt lgkmcnt(9)
    v_mfma_f32_16x16x32_bf16 v[136:139], v[16:19], a[96:99], v[136:139]
    v_xor_b32 v2, 65536, v2
    buffer_load_dwordx4 v232, s[4:7], s95 offen offset:0 lds
    v_add_u32 v176, v176, v254
    v_mfma_f32_16x16x32_bf16 v[136:139], v[20:23], a[112:115], v[136:139]
    v_xor_b32 v3, 65536, v3
    v_lshlrev_b32 v182, 1, v14
    v_mfma_f32_16x16x32_bf16 v[140:143], v[20:23], a[116:119], v[140:143]
    v_xor_b32 v4, 65536, v4
    buffer_load_dwordx4 v233, s[4:7], s95 offen offset:1024 lds
    v_mfma_f32_16x16x32_bf16 v[140:143], v[16:19], a[100:103], v[140:143]
    v_xor_b32 v5, 65536, v5
    v_mul_u32_u24 v15, 73728, v15
    v_lshl_add_u32 v14, v14, 7, v13
    v_mfma_f32_16x16x32_bf16 v[144:147], v[16:19], a[104:107], v[144:147]
    ds_read_b64_tr_b16 v[32:33], v2 offset:0
    ds_read_b64_tr_b16 v[34:35], v2 offset:1024
    v_mfma_f32_16x16x32_bf16 v[144:147], v[20:23], a[120:123], v[144:147]
    ds_read_b64_tr_b16 v[36:37], v2 offset:8192
    ds_read_b128 a[152:155], v235 offset:36864
    v_add_u32 v252, v14, v15
    v_mfma_f32_16x16x32_bf16 v[148:151], v[20:23], a[124:127], v[148:151]
    ds_read_b64_tr_b16 v[38:39], v2 offset:9216
    s_add_u32 s95, s85, 640
    buffer_load_dwordx2 v[176:177], v176, s[24:27], s74 offen
    v_mfma_f32_16x16x32_bf16 v[148:151], v[16:19], a[108:111], v[148:151]
    buffer_load_dwordx4 v232, s[4:7], s95 offen offset:2048 lds
    s_waitcnt lgkmcnt(7)
    v_mfma_f32_16x16x32_bf16 v[152:155], v[24:27], a[96:99], v[152:155]
    ds_read_b64_tr_b16 v[16:17], v2 offset:2048
    buffer_load_ushort v182, v182, s[28:31], s73 offen
    v_mfma_f32_16x16x32_bf16 v[152:155], v[28:31], a[112:115], v[152:155]
    s_waitcnt vmcnt(21)
    ds_read_b128 a[140:143], v234 offset:38912
    v_mfma_f32_16x16x32_bf16 v[156:159], v[28:31], a[116:119], v[156:159]
    ds_read_b64_tr_b16 v[18:19], v2 offset:3072
    buffer_load_dwordx4 v233, s[4:7], s95 offen offset:3072 lds
    v_mfma_f32_16x16x32_bf16 v[156:159], v[24:27], a[100:103], v[156:159]
    ds_read_b128 a[156:159], v235 offset:38912
    v_mfma_f32_16x16x32_bf16 v[160:163], v[24:27], a[104:107], v[160:163]
    ds_read_b64_tr_b16 v[20:21], v2 offset:10240
    v_mfma_f32_16x16x32_bf16 v[160:163], v[28:31], a[120:123], v[160:163]
    ds_read_b64_tr_b16 v[22:23], v2 offset:11264
    v_mfma_f32_16x16x32_bf16 v[164:167], v[28:31], a[124:127], v[164:167]
    v_mfma_f32_16x16x32_bf16 v[164:167], v[24:27], a[108:111], v[164:167]
    s_waitcnt lgkmcnt(6)
    v_mfma_f32_16x16x32_bf16 v[40:43], v[32:35], a[128:131], v[40:43]
    ds_read_b64_tr_b16 v[24:25], v3 offset:0
    v_mfma_f32_16x16x32_bf16 v[40:43], v[36:39], a[144:147], v[40:43]
    v_mfma_f32_16x16x32_bf16 v[44:47], v[36:39], a[148:151], v[44:47]
    ds_read_b64_tr_b16 v[26:27], v3 offset:1024
    v_mfma_f32_16x16x32_bf16 v[44:47], v[32:35], a[132:135], v[44:47]
    v_mfma_f32_16x16x32_bf16 v[48:51], v[32:35], a[136:139], v[48:51]
    ds_read_b64_tr_b16 v[28:29], v3 offset:8192
    v_mfma_f32_16x16x32_bf16 v[48:51], v[36:39], a[152:155], v[48:51]
    ds_read_b64_tr_b16 v[30:31], v3 offset:9216
    s_waitcnt lgkmcnt(6)
    v_mfma_f32_16x16x32_bf16 v[52:55], v[36:39], a[156:159], v[52:55]
    s_add_u32 m0, s60, 0
    v_mfma_f32_16x16x32_bf16 v[52:55], v[32:35], a[140:143], v[52:55]
    s_waitcnt lgkmcnt(4)
    v_mfma_f32_16x16x32_bf16 v[56:59], v[16:19], a[128:131], v[56:59]
    ds_read_b64_tr_b16 v[32:33], v3 offset:2048
    v_mfma_f32_16x16x32_bf16 v[56:59], v[20:23], a[144:147], v[56:59]
    s_add_u32 s64, s61, 3538944
    v_mfma_f32_16x16x32_bf16 v[60:63], v[20:23], a[148:151], v[60:63]
    ds_read_b64_tr_b16 v[34:35], v3 offset:3072
    v_mfma_f32_16x16x32_bf16 v[60:63], v[16:19], a[132:135], v[60:63]
    buffer_load_dwordx4 v6, s[8:11], s64 offen  lds
    v_mfma_f32_16x16x32_bf16 v[64:67], v[16:19], a[136:139], v[64:67]
    ds_read_b64_tr_b16 v[36:37], v3 offset:10240
    v_mfma_f32_16x16x32_bf16 v[64:67], v[20:23], a[152:155], v[64:67]
    ds_read_b64_tr_b16 v[38:39], v3 offset:11264
    v_mfma_f32_16x16x32_bf16 v[68:71], v[20:23], a[156:159], v[68:71]
    s_add_u32 s65, s61, 3574784
    v_mfma_f32_16x16x32_bf16 v[68:71], v[16:19], a[140:143], v[68:71]
    s_waitcnt lgkmcnt(4)
    v_mfma_f32_16x16x32_bf16 v[72:75], v[24:27], a[128:131], v[72:75]
    ds_read_b64_tr_b16 v[16:17], v4 offset:0
    buffer_load_dwordx4 v6, s[12:15], s64 offen offset:2048  lds
    v_mfma_f32_16x16x32_bf16 v[72:75], v[28:31], a[144:147], v[72:75]
    v_mfma_f32_16x16x32_bf16 v[76:79], v[28:31], a[148:151], v[76:79]
    ds_read_b64_tr_b16 v[18:19], v4 offset:1024
    v_mfma_f32_16x16x32_bf16 v[76:79], v[24:27], a[132:135], v[76:79]
    buffer_load_dwordx4 v6, s[8:11], s65 offen offset:1024  lds
    v_mfma_f32_16x16x32_bf16 v[80:83], v[24:27], a[136:139], v[80:83]
    ds_read_b64_tr_b16 v[20:21], v4 offset:8192
    v_mfma_f32_16x16x32_bf16 v[80:83], v[28:31], a[152:155], v[80:83]
    ds_read_b64_tr_b16 v[22:23], v4 offset:9216
    buffer_load_dwordx4 v6, s[12:15], s65 offen offset:3072  lds
    v_mfma_f32_16x16x32_bf16 v[84:87], v[28:31], a[156:159], v[84:87]
    v_mfma_f32_16x16x32_bf16 v[84:87], v[24:27], a[140:143], v[84:87]
    s_add_u32 m0, s94, 32768
    s_waitcnt lgkmcnt(4)
    v_mfma_f32_16x16x32_bf16 v[88:91], v[32:35], a[128:131], v[88:91]
    ds_read_b64_tr_b16 v[24:25], v4 offset:2048
    v_mfma_f32_16x16x32_bf16 v[88:91], v[36:39], a[144:147], v[88:91]
    s_add_u32 s95, s82, 768
    v_mfma_f32_16x16x32_bf16 v[92:95], v[36:39], a[148:151], v[92:95]
    ds_read_b64_tr_b16 v[26:27], v4 offset:3072
    v_mfma_f32_16x16x32_bf16 v[92:95], v[32:35], a[132:135], v[92:95]
    v_mfma_f32_16x16x32_bf16 v[96:99], v[32:35], a[136:139], v[96:99]
    ds_read_b64_tr_b16 v[28:29], v4 offset:10240
    v_mfma_f32_16x16x32_bf16 v[96:99], v[36:39], a[152:155], v[96:99]
    ds_read_b64_tr_b16 v[30:31], v4 offset:11264
    v_mfma_f32_16x16x32_bf16 v[100:103], v[36:39], a[156:159], v[100:103]
    buffer_load_dwordx4 v232, s[4:7], s95 offen offset:0 lds
    v_mfma_f32_16x16x32_bf16 v[100:103], v[32:35], a[140:143], v[100:103]
    v_readfirstlane_b32 s80, v1
    s_waitcnt lgkmcnt(4)
    v_mfma_f32_16x16x32_bf16 v[104:107], v[16:19], a[128:131], v[104:107]
    ds_read_b64_tr_b16 v[32:33], v5 offset:0
    v_mfma_f32_16x16x32_bf16 v[104:107], v[20:23], a[144:147], v[104:107]
    buffer_load_dwordx4 v233, s[4:7], s95 offen offset:1024 lds
    s_cmp_lg_u32 s80, 0
    s_cbranch_scc0 L_slow_non
L_ok_non:
    s_cmp_eq_u32 s54, 0
    s_cselect_b32 s1, s80, 0
    v_mfma_f32_16x16x32_bf16 v[108:111], v[20:23], a[148:151], v[108:111]
    ds_read_b64_tr_b16 v[34:35], v5 offset:1024
    v_mfma_f32_16x16x32_bf16 v[108:111], v[16:19], a[132:135], v[108:111]
    s_add_u32 s95, s83, 768
    v_mfma_f32_16x16x32_bf16 v[112:115], v[16:19], a[136:139], v[112:115]
    ds_read_b64_tr_b16 v[36:37], v5 offset:8192
    v_mfma_f32_16x16x32_bf16 v[112:115], v[20:23], a[152:155], v[112:115]
    ds_read_b64_tr_b16 v[38:39], v5 offset:9216
    buffer_load_dwordx4 v232, s[4:7], s95 offen offset:2048 lds
    v_mfma_f32_16x16x32_bf16 v[116:119], v[20:23], a[156:159], v[116:119]
    s_waitcnt vmcnt(17)
    ds_read_b128 a[160:163], v234 offset:0
    v_mfma_f32_16x16x32_bf16 v[116:119], v[16:19], a[140:143], v[116:119]
    s_waitcnt lgkmcnt(5)
    v_mfma_f32_16x16x32_bf16 v[120:123], v[24:27], a[128:131], v[120:123]
    ds_read_b64_tr_b16 v[16:17], v5 offset:2048
    ds_read_b128 a[176:179], v235 offset:0
    v_mfma_f32_16x16x32_bf16 v[120:123], v[28:31], a[144:147], v[120:123]
    buffer_load_dwordx4 v233, s[4:7], s95 offen offset:3072 lds
    v_mfma_f32_16x16x32_bf16 v[124:127], v[28:31], a[148:151], v[124:127]
    ds_read_b64_tr_b16 v[18:19], v5 offset:3072
    s_add_u32 m0, s94, 36864
    v_mfma_f32_16x16x32_bf16 v[124:127], v[24:27], a[132:135], v[124:127]
    s_waitcnt vmcnt(14)
    ds_read_b128 a[164:167], v234 offset:2048
    v_mfma_f32_16x16x32_bf16 v[128:131], v[24:27], a[136:139], v[128:131]
    ds_read_b64_tr_b16 v[20:21], v5 offset:10240
    v_mfma_f32_16x16x32_bf16 v[128:131], v[28:31], a[152:155], v[128:131]
    ds_read_b64_tr_b16 v[22:23], v5 offset:11264
    s_add_u32 s95, s84, 768
    v_mfma_f32_16x16x32_bf16 v[132:135], v[28:31], a[156:159], v[132:135]
    ds_read_b128 a[180:183], v235 offset:2048
    v_mfma_f32_16x16x32_bf16 v[132:135], v[24:27], a[140:143], v[132:135]
    s_barrier
    s_waitcnt lgkmcnt(8)
    v_mfma_f32_16x16x32_bf16 v[136:139], v[32:35], a[128:131], v[136:139]
    ds_read_b64_tr_b16 v[24:25], v2 offset:16384
    buffer_load_dwordx4 v232, s[4:7], s95 offen offset:0 lds
    v_mfma_f32_16x16x32_bf16 v[136:139], v[36:39], a[144:147], v[136:139]
    s_waitcnt vmcnt(13)
    ds_read_b128 a[168:171], v234 offset:4096
    v_mfma_f32_16x16x32_bf16 v[140:143], v[36:39], a[148:151], v[140:143]
    ds_read_b64_tr_b16 v[26:27], v2 offset:17408
    buffer_load_dwordx4 v233, s[4:7], s95 offen offset:1024 lds
    v_mfma_f32_16x16x32_bf16 v[140:143], v[32:35], a[132:135], v[140:143]
    v_mfma_f32_16x16x32_bf16 v[144:147], v[32:35], a[136:139], v[144:147]
    ds_read_b64_tr_b16 v[28:29], v2 offset:24576
    s_add_u32 s95, s85, 768
    v_mfma_f32_16x16x32_bf16 v[144:147], v[36:39], a[152:155], v[144:147]
    ds_read_b64_tr_b16 v[30:31], v2 offset:25600
    ds_read_b128 a[184:187], v235 offset:4096
    v_mfma_f32_16x16x32_bf16 v[148:151], v[36:39], a[156:159], v[148:151]
    v_mfma_f32_16x16x32_bf16 v[148:151], v[32:35], a[140:143], v[148:151]
    buffer_load_dwordx4 v232, s[4:7], s95 offen offset:2048 lds
    s_waitcnt lgkmcnt(7)
    v_mfma_f32_16x16x32_bf16 v[152:155], v[16:19], a[128:131], v[152:155]
    ds_read_b64_tr_b16 v[32:33], v2 offset:18432
    v_mfma_f32_16x16x32_bf16 v[152:155], v[20:23], a[144:147], v[152:155]
    s_waitcnt vmcnt(11)
    ds_read_b128 a[172:175], v234 offset:6144
    v_mfma_f32_16x16x32_bf16 v[156:159], v[20:23], a[148:151], v[156:159]
    ds_read_b64_tr_b16 v[34:35], v2 offset:19456
    buffer_load_dwordx4 v233, s[4:7], s95 offen offset:3072 lds
    v_mfma_f32_16x16x32_bf16 v[156:159], v[16:19], a[132:135], v[156:159]
    ds_read_b128 a[188:191], v235 offset:6144
    v_mfma_f32_16x16x32_bf16 v[160:163], v[16:19], a[136:139], v[160:163]
    ds_read_b64_tr_b16 v[36:37], v2 offset:26624
    v_mfma_f32_16x16x32_bf16 v[160:163], v[20:23], a[152:155], v[160:163]
    ds_read_b64_tr_b16 v[38:39], v2 offset:27648
    v_mfma_f32_16x16x32_bf16 v[164:167], v[20:23], a[156:159], v[164:167]
    v_mfma_f32_16x16x32_bf16 v[164:167], v[16:19], a[140:143], v[164:167]
    s_waitcnt lgkmcnt(7)
    v_mfma_f32_16x16x32_bf16 v[40:43], v[24:27], a[160:163], v[40:43]
    ds_read_b64_tr_b16 v[16:17], v3 offset:16384
    v_cndmask_b32 v168, v168, v178, s[40:41]
    v_mfma_f32_16x16x32_bf16 v[40:43], v[28:31], a[176:179], v[40:43]
    v_cndmask_b32 v169, v169, 0, s[40:41]
    v_mfma_f32_16x16x32_bf16 v[44:47], v[28:31], a[180:183], v[44:47]
    ds_read_b64_tr_b16 v[18:19], v3 offset:17408
    v_mfma_f32_16x16x32_bf16 v[44:47], v[24:27], a[164:167], v[44:47]
    buffer_store_dwordx2 v[168:169], v248, s[16:19], s72 offen sc1
    v_mfma_f32_16x16x32_bf16 v[48:51], v[24:27], a[168:171], v[48:51]
    ds_read_b64_tr_b16 v[20:21], v3 offset:24576
    s_waitcnt lgkmcnt(9)
    v_mfma_f32_16x16x32_bf16 v[48:51], v[28:31], a[184:187], v[48:51]
    ds_read_b64_tr_b16 v[22:23], v3 offset:25600
    v_cndmask_b32 v170, v170, v179, s[40:41]
    s_waitcnt lgkmcnt(6)
    v_mfma_f32_16x16x32_bf16 v[52:55], v[28:31], a[188:191], v[52:55]
    s_add_u32 m0, s60, 16384
    v_mfma_f32_16x16x32_bf16 v[52:55], v[24:27], a[172:175], v[52:55]
    v_cndmask_b32 v171, v171, 0, s[40:41]
    s_waitcnt lgkmcnt(4)
    v_mfma_f32_16x16x32_bf16 v[56:59], v[32:35], a[160:163], v[56:59]
    ds_read_b64_tr_b16 v[24:25], v3 offset:18432
    buffer_store_dwordx2 v[170:171], v249, s[16:19], s72 offen sc1
    v_mfma_f32_16x16x32_bf16 v[56:59], v[36:39], a[176:179], v[56:59]
    s_add_u32 s64, s61, 4128768
    v_mfma_f32_16x16x32_bf16 v[60:63], v[36:39], a[180:183], v[60:63]
    ds_read_b64_tr_b16 v[26:27], v3 offset:19456
    v_cndmask_b32 v172, v172, v180, s[40:41]
    v_mfma_f32_16x16x32_bf16 v[60:63], v[32:35], a[164:167], v[60:63]
    buffer_load_dwordx4 v6, s[8:11], s64 offen  lds
    v_mfma_f32_16x16x32_bf16 v[64:67], v[32:35], a[168:171], v[64:67]
    ds_read_b64_tr_b16 v[28:29], v3 offset:26624
    v_cndmask_b32 v173, v173, 0, s[40:41]
    v_mfma_f32_16x16x32_bf16 v[64:67], v[36:39], a[184:187], v[64:67]
    ds_read_b64_tr_b16 v[30:31], v3 offset:27648
    buffer_store_dwordx2 v[172:173], v250, s[16:19], s72 offen sc1
    v_mfma_f32_16x16x32_bf16 v[68:71], v[36:39], a[188:191], v[68:71]
    s_add_u32 s65, s61, 4164608
    v_mfma_f32_16x16x32_bf16 v[68:71], v[32:35], a[172:175], v[68:71]
    v_cndmask_b32 v174, v174, v181, s[40:41]
    s_waitcnt lgkmcnt(4)
    v_mfma_f32_16x16x32_bf16 v[72:75], v[16:19], a[160:163], v[72:75]
    ds_read_b64_tr_b16 v[32:33], v4 offset:16384
    buffer_load_dwordx4 v6, s[12:15], s64 offen offset:2048  lds
    v_mfma_f32_16x16x32_bf16 v[72:75], v[20:23], a[176:179], v[72:75]
    v_cndmask_b32 v175, v175, 0, s[40:41]
    v_mfma_f32_16x16x32_bf16 v[76:79], v[20:23], a[180:183], v[76:79]
    ds_read_b64_tr_b16 v[34:35], v4 offset:17408
    buffer_store_dwordx2 v[174:175], v251, s[16:19], s72 offen sc1
    v_mfma_f32_16x16x32_bf16 v[76:79], v[16:19], a[164:167], v[76:79]
    buffer_load_dwordx4 v6, s[8:11], s65 offen offset:1024  lds
    v_mfma_f32_16x16x32_bf16 v[80:83], v[16:19], a[168:171], v[80:83]
    ds_read_b64_tr_b16 v[36:37], v4 offset:24576
    v_cndmask_b32 v176, v176, v182, s[40:41]
    v_mfma_f32_16x16x32_bf16 v[80:83], v[20:23], a[184:187], v[80:83]
    ds_read_b64_tr_b16 v[38:39], v4 offset:25600
    buffer_load_dwordx4 v6, s[12:15], s65 offen offset:3072  lds
    v_mfma_f32_16x16x32_bf16 v[84:87], v[20:23], a[188:191], v[84:87]
    v_cndmask_b32 v177, v177, 0, s[40:41]
    v_mfma_f32_16x16x32_bf16 v[84:87], v[16:19], a[172:175], v[84:87]
    s_add_u32 m0, s94, 0
    s_waitcnt lgkmcnt(4)
    v_mfma_f32_16x16x32_bf16 v[88:91], v[24:27], a[160:163], v[88:91]
    ds_read_b64_tr_b16 v[16:17], v4 offset:18432
    buffer_store_dwordx2 v[176:177], v252, s[16:19], s72 offen sc1
    v_mfma_f32_16x16x32_bf16 v[88:91], v[28:31], a[176:179], v[88:91]
    s_add_u32 s95, s82, 896
    v_mfma_f32_16x16x32_bf16 v[92:95], v[28:31], a[180:183], v[92:95]
    ds_read_b64_tr_b16 v[18:19], v4 offset:19456
    v_mfma_f32_16x16x32_bf16 v[92:95], v[24:27], a[164:167], v[92:95]
    v_mfma_f32_16x16x32_bf16 v[96:99], v[24:27], a[168:171], v[96:99]
    ds_read_b64_tr_b16 v[20:21], v4 offset:26624
    v_mfma_f32_16x16x32_bf16 v[96:99], v[28:31], a[184:187], v[96:99]
    ds_read_b64_tr_b16 v[22:23], v4 offset:27648
    v_mfma_f32_16x16x32_bf16 v[100:103], v[28:31], a[188:191], v[100:103]
    buffer_load_dwordx4 v232, s[4:7], s95 offen offset:0 lds
    v_mfma_f32_16x16x32_bf16 v[100:103], v[24:27], a[172:175], v[100:103]
    v_lshrrev_b32 v12, 7, v11
    s_waitcnt lgkmcnt(4)
    v_mfma_f32_16x16x32_bf16 v[104:107], v[32:35], a[160:163], v[104:107]
    ds_read_b64_tr_b16 v[24:25], v5 offset:16384
    v_mfma_f32_16x16x32_bf16 v[104:107], v[36:39], a[176:179], v[104:107]
    buffer_load_dwordx4 v233, s[4:7], s95 offen offset:1024 lds
    v_lshrrev_b32 v13, 1, v12
    v_mfma_f32_16x16x32_bf16 v[108:111], v[36:39], a[180:183], v[108:111]
    ds_read_b64_tr_b16 v[26:27], v5 offset:17408
    v_lshlrev_b32 v13, 5, v13
    v_mfma_f32_16x16x32_bf16 v[108:111], v[32:35], a[164:167], v[108:111]
    s_add_u32 s95, s83, 896
    v_and_b32 v14, 0x70, v11
    v_mfma_f32_16x16x32_bf16 v[112:115], v[32:35], a[168:171], v[112:115]
    ds_read_b64_tr_b16 v[28:29], v5 offset:24576
    v_xor_b32 v13, v13, v14
    v_mfma_f32_16x16x32_bf16 v[112:115], v[36:39], a[184:187], v[112:115]
    ds_read_b64_tr_b16 v[30:31], v5 offset:25600
    buffer_load_dwordx4 v232, s[4:7], s95 offen offset:2048 lds
    v_mfma_f32_16x16x32_bf16 v[116:119], v[36:39], a[188:191], v[116:119]
    s_waitcnt vmcnt(18)
    ds_read_b128 a[192:195], v234 offset:32768
    v_mfma_f32_16x16x32_bf16 v[116:119], v[32:35], a[172:175], v[116:119]
    v_mul_u32_u24 v244, 1152, v12
    s_waitcnt lgkmcnt(5)
    v_mfma_f32_16x16x32_bf16 v[120:123], v[16:19], a[160:163], v[120:123]
    ds_read_b64_tr_b16 v[32:33], v5 offset:18432
    ds_read_b128 a[208:211], v235 offset:32768
    v_mfma_f32_16x16x32_bf16 v[120:123], v[20:23], a[176:179], v[120:123]
    buffer_load_dwordx4 v233, s[4:7], s95 offen offset:3072 lds
    v_add_u32 v244, v244, v13
L_wm1:
    s_cbranch_execz L_wm5
    v_mfma_f32_16x16x32_bf16 v[124:127], v[20:23], a[180:183], v[124:127]
    ds_read_b64_tr_b16 v[34:35], v5 offset:19456
    s_add_u32 m0, s94, 4096
    v_mfma_f32_16x16x32_bf16 v[124:127], v[16:19], a[164:167], v[124:127]
    s_waitcnt vmcnt(17)
    ds_read_b128 a[196:199], v234 offset:34816
    v_mfma_f32_16x16x32_bf16 v[128:131], v[16:19], a[168:171], v[128:131]
    ds_read_b64_tr_b16 v[36:37], v5 offset:26624
    s_add_u32 s95, s84, 896
    v_mfma_f32_16x16x32_bf16 v[128:131], v[20:23], a[184:187], v[128:131]
    ds_read_b64_tr_b16 v[38:39], v5 offset:27648
    ds_read_b128 a[212:215], v235 offset:34816
    v_mfma_f32_16x16x32_bf16 v[132:135], v[20:23], a[188:191], v[132:135]
    s_waitcnt vmcnt(15)
    ds_read_b128 a[200:203], v234 offset:36864
    v_mfma_f32_16x16x32_bf16 v[132:135], v[16:19], a[172:175], v[132:135]
    s_barrier
    s_waitcnt lgkmcnt(9)
    v_mfma_f32_16x16x32_bf16 v[136:139], v[24:27], a[160:163], v[136:139]
    v_xor_b32 v2, 65536, v2
    buffer_load_dwordx4 v232, s[4:7], s95 offen offset:0 lds
    v_mfma_f32_16x16x32_bf16 v[136:139], v[28:31], a[176:179], v[136:139]
    v_xor_b32 v3, 65536, v3
    v_lshrrev_b32 v13, 2, v12
    v_mfma_f32_16x16x32_bf16 v[140:143], v[28:31], a[180:183], v[140:143]
    v_xor_b32 v4, 65536, v4
    buffer_load_dwordx4 v233, s[4:7], s95 offen offset:1024 lds
    v_mfma_f32_16x16x32_bf16 v[140:143], v[24:27], a[164:167], v[140:143]
    v_xor_b32 v5, 65536, v5
    v_mul_u32_u24 v13, 68, v13
    v_mfma_f32_16x16x32_bf16 v[144:147], v[24:27], a[168:171], v[144:147]
    ds_read_b64_tr_b16 v[16:17], v2 offset:0
    ds_read_b64_tr_b16 v[18:19], v2 offset:1024
    v_mfma_f32_16x16x32_bf16 v[144:147], v[28:31], a[184:187], v[144:147]
    ds_read_b64_tr_b16 v[20:21], v2 offset:8192
    ds_read_b128 a[216:219], v235 offset:36864
    v_mfma_f32_16x16x32_bf16 v[148:151], v[28:31], a[188:191], v[148:151]
    ds_read_b64_tr_b16 v[22:23], v2 offset:9216
    s_add_u32 s95, s85, 896
    v_mfma_f32_16x16x32_bf16 v[148:151], v[24:27], a[172:175], v[148:151]
    buffer_load_dwordx4 v232, s[4:7], s95 offen offset:2048 lds
    s_waitcnt lgkmcnt(7)
    v_mfma_f32_16x16x32_bf16 v[152:155], v[32:35], a[160:163], v[152:155]
    ds_read_b64_tr_b16 v[24:25], v2 offset:2048
    v_and_b32 v12, 2, v12
    v_mfma_f32_16x16x32_bf16 v[152:155], v[36:39], a[176:179], v[152:155]
    s_waitcnt vmcnt(16)
    ds_read_b128 a[204:207], v234 offset:38912
    v_mfma_f32_16x16x32_bf16 v[156:159], v[36:39], a[180:183], v[156:159]
    ds_read_b64_tr_b16 v[26:27], v2 offset:3072
    buffer_load_dwordx4 v233, s[4:7], s95 offen offset:3072 lds
    v_mfma_f32_16x16x32_bf16 v[156:159], v[32:35], a[164:167], v[156:159]
    ds_read_b128 a[220:223], v235 offset:38912
    v_lshl_add_u32 v13, v12, 3, v13
    v_mfma_f32_16x16x32_bf16 v[160:163], v[32:35], a[168:171], v[160:163]
    ds_read_b64_tr_b16 v[28:29], v2 offset:10240
    v_mul_u32_u24 v246, 1152, v13
    v_mfma_f32_16x16x32_bf16 v[160:163], v[36:39], a[184:187], v[160:163]
    ds_read_b64_tr_b16 v[30:31], v2 offset:11264
    s_lshr_b32 s77, s54, 1
    v_mfma_f32_16x16x32_bf16 v[164:167], v[36:39], a[188:191], v[164:167]
    s_lshl_b32 s77, s77, 13
    v_mfma_f32_16x16x32_bf16 v[164:167], v[32:35], a[172:175], v[164:167]
    s_waitcnt lgkmcnt(6)
    v_mfma_f32_16x16x32_bf16 v[40:43], v[16:19], a[192:195], v[40:43]
    ds_read_b64_tr_b16 v[32:33], v3 offset:0
    s_and_b32 s73, s54, 1
    v_mfma_f32_16x16x32_bf16 v[40:43], v[20:23], a[208:211], v[40:43]
    v_mfma_f32_16x16x32_bf16 v[44:47], v[20:23], a[212:215], v[44:47]
    ds_read_b64_tr_b16 v[34:35], v3 offset:1024
    v_mfma_f32_16x16x32_bf16 v[44:47], v[16:19], a[196:199], v[44:47]
    s_lshl_b32 s73, s73, 11
    v_mfma_f32_16x16x32_bf16 v[48:51], v[16:19], a[200:203], v[48:51]
    ds_read_b64_tr_b16 v[36:37], v3 offset:8192
    v_mfma_f32_16x16x32_bf16 v[48:51], v[20:23], a[216:219], v[48:51]
    ds_read_b64_tr_b16 v[38:39], v3 offset:9216
    s_add_u32 s77, s77, s73
    s_waitcnt lgkmcnt(6)
    v_mfma_f32_16x16x32_bf16 v[52:55], v[20:23], a[220:223], v[52:55]
    s_add_u32 m0, s60, 32768
    v_mfma_f32_16x16x32_bf16 v[52:55], v[16:19], a[204:207], v[52:55]
    s_add_u32 s77, s77, 131072
    s_waitcnt lgkmcnt(4)
    v_mfma_f32_16x16x32_bf16 v[56:59], v[24:27], a[192:195], v[56:59]
    ds_read_b64_tr_b16 v[16:17], v3 offset:2048
    v_mfma_f32_16x16x32_bf16 v[56:59], v[28:31], a[208:211], v[56:59]
    s_add_u32 s64, s61, 4718592
    v_mfma_f32_16x16x32_bf16 v[60:63], v[28:31], a[212:215], v[60:63]
    ds_read_b64_tr_b16 v[18:19], v3 offset:3072
    s_add_u32 s72, s59, 0
    v_mfma_f32_16x16x32_bf16 v[60:63], v[24:27], a[196:199], v[60:63]
    buffer_load_dwordx4 v6, s[8:11], s64 offen  lds
    v_mfma_f32_16x16x32_bf16 v[64:67], v[24:27], a[200:203], v[64:67]
    ds_read_b64_tr_b16 v[20:21], v3 offset:10240
    s_mul_i32 s78, s72, 7282
    v_mfma_f32_16x16x32_bf16 v[64:67], v[28:31], a[216:219], v[64:67]
    ds_read_b64_tr_b16 v[22:23], v3 offset:11264
    v_mfma_f32_16x16x32_bf16 v[68:71], v[28:31], a[220:223], v[68:71]
    s_add_u32 s65, s61, 4754432
    s_lshr_b32 s78, s78, 16
    v_mfma_f32_16x16x32_bf16 v[68:71], v[24:27], a[204:207], v[68:71]
    s_waitcnt lgkmcnt(4)
    v_mfma_f32_16x16x32_bf16 v[72:75], v[32:35], a[192:195], v[72:75]
    ds_read_b64_tr_b16 v[24:25], v4 offset:0
    buffer_load_dwordx4 v6, s[12:15], s64 offen offset:2048  lds
    v_mfma_f32_16x16x32_bf16 v[72:75], v[36:39], a[208:211], v[72:75]
    s_mul_i32 s74, s78, 9
    v_mfma_f32_16x16x32_bf16 v[76:79], v[36:39], a[212:215], v[76:79]
    ds_read_b64_tr_b16 v[26:27], v4 offset:1024
    v_mfma_f32_16x16x32_bf16 v[76:79], v[32:35], a[196:199], v[76:79]
    buffer_load_dwordx4 v6, s[8:11], s65 offen offset:1024  lds
    s_sub_u32 s74, s72, s74
    v_mfma_f32_16x16x32_bf16 v[80:83], v[32:35], a[200:203], v[80:83]
    ds_read_b64_tr_b16 v[28:29], v4 offset:8192
    v_mfma_f32_16x16x32_bf16 v[80:83], v[36:39], a[216:219], v[80:83]
    ds_read_b64_tr_b16 v[30:31], v4 offset:9216
    buffer_load_dwordx4 v6, s[12:15], s65 offen offset:3072  lds
    v_mfma_f32_16x16x32_bf16 v[84:87], v[36:39], a[220:223], v[84:87]
    s_lshl_b32 s75, s58, 4
    v_mfma_f32_16x16x32_bf16 v[84:87], v[32:35], a[204:207], v[84:87]
    s_add_u32 m0, s94, 32768
    s_waitcnt lgkmcnt(4)
    v_mfma_f32_16x16x32_bf16 v[88:91], v[16:19], a[192:195], v[88:91]
    ds_read_b64_tr_b16 v[32:33], v4 offset:2048
    s_add_u32 s73, s78, s75
    v_mfma_f32_16x16x32_bf16 v[88:91], v[20:23], a[208:211], v[88:91]
    s_add_u32 s95, s82, 1024
    v_mfma_f32_16x16x32_bf16 v[92:95], v[20:23], a[212:215], v[92:95]
    ds_read_b64_tr_b16 v[34:35], v4 offset:3072
    s_add_u32 s75, s73, 48
    v_mfma_f32_16x16x32_bf16 v[92:95], v[16:19], a[196:199], v[92:95]
    s_cmp_ge_u32 s78, 16
    s_cselect_b32 s73, s75, s73
    v_mfma_f32_16x16x32_bf16 v[96:99], v[16:19], a[200:203], v[96:99]
    ds_read_b64_tr_b16 v[36:37], v4 offset:10240
    v_mfma_f32_16x16x32_bf16 v[96:99], v[20:23], a[216:219], v[96:99]
    ds_read_b64_tr_b16 v[38:39], v4 offset:11264
    v_mfma_f32_16x16x32_bf16 v[100:103], v[20:23], a[220:223], v[100:103]
    buffer_load_dwordx4 v232, s[4:7], s95 offen offset:0 lds
    v_mfma_f32_16x16x32_bf16 v[100:103], v[16:19], a[204:207], v[100:103]
    s_mul_i32 s75, s73, 9
    s_waitcnt lgkmcnt(4)
    v_mfma_f32_16x16x32_bf16 v[104:107], v[24:27], a[192:195], v[104:107]
    ds_read_b64_tr_b16 v[16:17], v5 offset:0
    v_mfma_f32_16x16x32_bf16 v[104:107], v[28:31], a[208:211], v[104:107]
    buffer_load_dwordx4 v233, s[4:7], s95 offen offset:1024 lds
    s_add_u32 s75, s75, s74
    v_mfma_f32_16x16x32_bf16 v[108:111], v[28:31], a[212:215], v[108:111]
    ds_read_b64_tr_b16 v[18:19], v5 offset:1024
    v_mfma_f32_16x16x32_bf16 v[108:111], v[24:27], a[196:199], v[108:111]
    s_add_u32 s95, s83, 1024
    s_lshl_b32 s75, s75, 12
    v_mfma_f32_16x16x32_bf16 v[112:115], v[24:27], a[200:203], v[112:115]
    ds_read_b64_tr_b16 v[20:21], v5 offset:8192
    s_add_u32 s75, s75, 22020096
    v_mfma_f32_16x16x32_bf16 v[112:115], v[28:31], a[216:219], v[112:115]
    ds_read_b64_tr_b16 v[22:23], v5 offset:9216
    buffer_load_dwordx4 v232, s[4:7], s95 offen offset:2048 lds
    v_mfma_f32_16x16x32_bf16 v[116:119], v[28:31], a[220:223], v[116:119]
    s_waitcnt vmcnt(13)
    ds_read_b128 a[224:227], v234 offset:0
    v_mfma_f32_16x16x32_bf16 v[116:119], v[24:27], a[204:207], v[116:119]
    s_lshl_b32 s74, s74, 7
    s_waitcnt lgkmcnt(5)
    v_mfma_f32_16x16x32_bf16 v[120:123], v[32:35], a[192:195], v[120:123]
    ds_read_b64_tr_b16 v[24:25], v5 offset:2048
    ds_read_b128 a[240:243], v235 offset:0
    v_mfma_f32_16x16x32_bf16 v[120:123], v[36:39], a[208:211], v[120:123]
    buffer_load_dwordx4 v233, s[4:7], s95 offen offset:3072 lds
    s_mov_b32 s24, s44
    v_mfma_f32_16x16x32_bf16 v[124:127], v[36:39], a[212:215], v[124:127]
    ds_read_b64_tr_b16 v[26:27], v5 offset:3072
    s_add_u32 m0, s94, 36864
    s_lshl_b32 s38, s58, 8
    v_mfma_f32_16x16x32_bf16 v[124:127], v[32:35], a[196:199], v[124:127]
    s_waitcnt vmcnt(12)
    ds_read_b128 a[228:231], v234 offset:2048
    s_add_u32 s38, s38, s59
    v_mfma_f32_16x16x32_bf16 v[128:131], v[32:35], a[200:203], v[128:131]
    ds_read_b64_tr_b16 v[28:29], v5 offset:10240
    s_lshr_b32 s38, s38, 2
    s_lshl_b32 s38, s38, 7
    v_mfma_f32_16x16x32_bf16 v[128:131], v[36:39], a[216:219], v[128:131]
    ds_read_b64_tr_b16 v[30:31], v5 offset:11264
    s_add_u32 s95, s84, 1024
    v_mfma_f32_16x16x32_bf16 v[132:135], v[36:39], a[220:223], v[132:135]
    ds_read_b128 a[244:247], v235 offset:2048
    s_add_u32 s38, s38, 28311552
    v_mov_b32 v1, s80
    v_mfma_f32_16x16x32_bf16 v[132:135], v[32:35], a[204:207], v[132:135]
    s_barrier
    buffer_store_dword v1, v0, s[16:19], s38 offen sc1
    s_waitcnt lgkmcnt(8)
    v_mfma_f32_16x16x32_bf16 v[136:139], v[16:19], a[192:195], v[136:139]
    ds_read_b64_tr_b16 v[32:33], v2 offset:16384
    buffer_load_dwordx4 v232, s[4:7], s95 offen offset:0 lds
    v_mfma_f32_16x16x32_bf16 v[136:139], v[20:23], a[208:211], v[136:139]
    s_waitcnt vmcnt(12)
    ds_read_b128 a[232:235], v234 offset:4096
    v_mfma_f32_16x16x32_bf16 v[140:143], v[20:23], a[212:215], v[140:143]
    ds_read_b64_tr_b16 v[34:35], v2 offset:17408
    buffer_load_dwordx4 v233, s[4:7], s95 offen offset:1024 lds
    v_mfma_f32_16x16x32_bf16 v[140:143], v[16:19], a[196:199], v[140:143]
    s_mov_b32 s25, s45
    s_mov_b32 s26, 5308416
    v_mfma_f32_16x16x32_bf16 v[144:147], v[16:19], a[200:203], v[144:147]
    ds_read_b64_tr_b16 v[36:37], v2 offset:24576
    s_add_u32 s95, s85, 1024
    v_mfma_f32_16x16x32_bf16 v[144:147], v[20:23], a[216:219], v[144:147]
    ds_read_b64_tr_b16 v[38:39], v2 offset:25600
    ds_read_b128 a[248:251], v235 offset:4096
    v_mfma_f32_16x16x32_bf16 v[148:151], v[20:23], a[220:223], v[148:151]
    s_mov_b32 s27, 0x00020000
    s_mul_i32 s73, s73, 36864
    v_mfma_f32_16x16x32_bf16 v[148:151], v[16:19], a[204:207], v[148:151]
    buffer_load_dwordx4 v232, s[4:7], s95 offen offset:2048 lds
    s_waitcnt lgkmcnt(7)
    v_mfma_f32_16x16x32_bf16 v[152:155], v[24:27], a[192:195], v[152:155]
    ds_read_b64_tr_b16 v[16:17], v2 offset:18432
    s_add_u32 s81, s73, s74
    v_mfma_f32_16x16x32_bf16 v[152:155], v[28:31], a[208:211], v[152:155]
    s_waitcnt vmcnt(12)
    ds_read_b128 a[236:239], v234 offset:6144
    s_mul_i32 s87, s54, 5308416
    v_mfma_f32_16x16x32_bf16 v[156:159], v[28:31], a[212:215], v[156:159]
    ds_read_b64_tr_b16 v[18:19], v2 offset:19456
    buffer_load_dwordx4 v233, s[4:7], s95 offen offset:3072 lds
    s_add_u32 s87, s87, s86
    v_mfma_f32_16x16x32_bf16 v[156:159], v[24:27], a[196:199], v[156:159]
    ds_read_b128 a[252:255], v235 offset:6144
    s_add_u32 s87, s87, 8192
    v_mfma_f32_16x16x32_bf16 v[160:163], v[24:27], a[200:203], v[160:163]
    ds_read_b64_tr_b16 v[20:21], v2 offset:26624
    s_cmp_lt_u32 s54, 1
    s_cselect_b32 s92, 4294967295, 0
    s_cselect_b32 s93, 15, 0
    v_mfma_f32_16x16x32_bf16 v[160:163], v[28:31], a[216:219], v[160:163]
    ds_read_b64_tr_b16 v[22:23], v2 offset:27648
    v_cndmask_b32 v242, -1, v237, s[92:93]
    buffer_load_dword v242, v242, s[88:91], s87 offen
    v_mfma_f32_16x16x32_bf16 v[164:167], v[28:31], a[220:223], v[164:167]
    v_mfma_f32_16x16x32_bf16 v[164:167], v[24:27], a[204:207], v[164:167]
    s_add_u32 s72, s59, 256
    s_waitcnt lgkmcnt(7)
    v_mfma_f32_16x16x32_bf16 v[40:43], v[32:35], a[224:227], v[40:43]
    ds_read_b64_tr_b16 v[24:25], v3 offset:16384
    s_add_u32 m0, s60, 49152
    v_mfma_f32_16x16x32_bf16 v[40:43], v[36:39], a[240:243], v[40:43]
    s_mul_i32 s78, s72, 7282
    v_mfma_f32_16x16x32_bf16 v[44:47], v[36:39], a[244:247], v[44:47]
    ds_read_b64_tr_b16 v[26:27], v3 offset:17408
    s_lshr_b32 s78, s78, 16
    v_mfma_f32_16x16x32_bf16 v[44:47], v[32:35], a[228:231], v[44:47]
    s_add_u32 s64, s63, 0
    v_mfma_f32_16x16x32_bf16 v[48:51], v[32:35], a[232:235], v[48:51]
    ds_read_b64_tr_b16 v[28:29], v3 offset:24576
    s_mul_i32 s74, s78, 9
    s_waitcnt lgkmcnt(9)
    v_mfma_f32_16x16x32_bf16 v[48:51], v[36:39], a[248:251], v[48:51]
    ds_read_b64_tr_b16 v[30:31], v3 offset:25600
    s_waitcnt lgkmcnt(6)
    v_mfma_f32_16x16x32_bf16 v[52:55], v[36:39], a[252:255], v[52:55]
    buffer_load_dwordx4 v8, s[8:11], s64 offen  lds
    s_sub_u32 s74, s72, s74
    v_mfma_f32_16x16x32_bf16 v[52:55], v[32:35], a[236:239], v[52:55]
    s_lshl_b32 s76, s58, 4
    s_waitcnt lgkmcnt(4)
    v_mfma_f32_16x16x32_bf16 v[56:59], v[16:19], a[224:227], v[56:59]
    ds_read_b64_tr_b16 v[32:33], v3 offset:18432
    v_mfma_f32_16x16x32_bf16 v[56:59], v[20:23], a[240:243], v[56:59]
    buffer_load_dwordx4 v8, s[12:15], s64 offen offset:2048  lds
    s_add_u32 s73, s78, s76
    v_mfma_f32_16x16x32_bf16 v[60:63], v[20:23], a[244:247], v[60:63]
    ds_read_b64_tr_b16 v[34:35], v3 offset:19456
    s_add_u32 s76, s73, 48
    v_mfma_f32_16x16x32_bf16 v[60:63], v[16:19], a[228:231], v[60:63]
    s_cmp_ge_u32 s78, 16
    s_cselect_b32 s73, s76, s73
    v_mfma_f32_16x16x32_bf16 v[64:67], v[16:19], a[232:235], v[64:67]
    ds_read_b64_tr_b16 v[36:37], v3 offset:26624
    v_mfma_f32_16x16x32_bf16 v[64:67], v[20:23], a[248:251], v[64:67]
    ds_read_b64_tr_b16 v[38:39], v3 offset:27648
    v_mfma_f32_16x16x32_bf16 v[68:71], v[20:23], a[252:255], v[68:71]
    s_lshl_b32 s76, s58, 2
    s_add_u32 s76, s76, s78
    v_mfma_f32_16x16x32_bf16 v[68:71], v[16:19], a[236:239], v[68:71]
    s_add_u32 s76, s76, 96
    s_waitcnt lgkmcnt(4)
    v_mfma_f32_16x16x32_bf16 v[72:75], v[24:27], a[224:227], v[72:75]
    ds_read_b64_tr_b16 v[16:17], v4 offset:16384
    s_add_u32 m0, s60, 50176
    v_mfma_f32_16x16x32_bf16 v[72:75], v[28:31], a[240:243], v[72:75]
    s_cmp_ge_u32 s78, 32
    s_cselect_b32 s73, s76, s73
    v_mfma_f32_16x16x32_bf16 v[76:79], v[28:31], a[244:247], v[76:79]
    ds_read_b64_tr_b16 v[18:19], v4 offset:17408
    v_mfma_f32_16x16x32_bf16 v[76:79], v[24:27], a[228:231], v[76:79]
    s_add_u32 s64, s63, 589824
    v_mfma_f32_16x16x32_bf16 v[80:83], v[24:27], a[232:235], v[80:83]
    ds_read_b64_tr_b16 v[20:21], v4 offset:24576
    v_mfma_f32_16x16x32_bf16 v[80:83], v[28:31], a[248:251], v[80:83]
    ds_read_b64_tr_b16 v[22:23], v4 offset:25600
    s_add_u32 s76, s76, 12
    v_mfma_f32_16x16x32_bf16 v[84:87], v[28:31], a[252:255], v[84:87]
    buffer_load_dwordx4 v8, s[8:11], s64 offen  lds
    v_mfma_f32_16x16x32_bf16 v[84:87], v[24:27], a[236:239], v[84:87]
    s_cmp_ge_u32 s78, 36
    s_cselect_b32 s73, s76, s73
    s_waitcnt lgkmcnt(4)
    v_mfma_f32_16x16x32_bf16 v[88:91], v[32:35], a[224:227], v[88:91]
    ds_read_b64_tr_b16 v[24:25], v4 offset:18432
    s_add_u32 s76, s58, 160
    v_mfma_f32_16x16x32_bf16 v[88:91], v[36:39], a[240:243], v[88:91]
    buffer_load_dwordx4 v8, s[12:15], s64 offen offset:2048  lds
    v_mfma_f32_16x16x32_bf16 v[92:95], v[36:39], a[244:247], v[92:95]
    ds_read_b64_tr_b16 v[26:27], v4 offset:19456
    v_mfma_f32_16x16x32_bf16 v[92:95], v[32:35], a[228:231], v[92:95]
    s_cmp_ge_u32 s78, 40
    s_cselect_b32 s73, s76, s73
    v_mfma_f32_16x16x32_bf16 v[96:99], v[32:35], a[232:235], v[96:99]
    ds_read_b64_tr_b16 v[28:29], v4 offset:26624
    v_mfma_f32_16x16x32_bf16 v[96:99], v[36:39], a[248:251], v[96:99]
    ds_read_b64_tr_b16 v[30:31], v4 offset:27648
    v_mfma_f32_16x16x32_bf16 v[100:103], v[36:39], a[252:255], v[100:103]
    s_cmp_ge_u32 s78, 41
    s_cselect_b32 s73, 200, s73
    v_mfma_f32_16x16x32_bf16 v[100:103], v[32:35], a[236:239], v[100:103]
    s_mul_i32 s76, s73, 9
    s_waitcnt lgkmcnt(4)
    v_mfma_f32_16x16x32_bf16 v[104:107], v[16:19], a[224:227], v[104:107]
    ds_read_b64_tr_b16 v[32:33], v5 offset:16384
    s_add_u32 m0, s60, 65536
    v_mfma_f32_16x16x32_bf16 v[104:107], v[20:23], a[240:243], v[104:107]
    s_add_u32 s76, s76, s74
    s_lshl_b32 s76, s76, 12
    v_mfma_f32_16x16x32_bf16 v[108:111], v[20:23], a[244:247], v[108:111]
    ds_read_b64_tr_b16 v[34:35], v5 offset:17408
    v_mfma_f32_16x16x32_bf16 v[108:111], v[16:19], a[228:231], v[108:111]
    s_add_u32 s64, s63, 1179648
    s_add_u32 s76, s76, 22020096
    v_mfma_f32_16x16x32_bf16 v[112:115], v[16:19], a[232:235], v[112:115]
    ds_read_b64_tr_b16 v[36:37], v5 offset:24576
    s_lshl_b32 s74, s74, 7
    v_mfma_f32_16x16x32_bf16 v[112:115], v[20:23], a[248:251], v[112:115]
    ds_read_b64_tr_b16 v[38:39], v5 offset:25600
    s_mov_b32 s30, 5308416
    v_mfma_f32_16x16x32_bf16 v[116:119], v[20:23], a[252:255], v[116:119]
    s_waitcnt vmcnt(12)
    ds_read_b128 v[200:203], v234 offset:32768
    v_mfma_f32_16x16x32_bf16 v[116:119], v[16:19], a[236:239], v[116:119]
    buffer_load_dwordx4 v8, s[8:11], s64 offen  lds
    s_waitcnt lgkmcnt(5)
    v_mfma_f32_16x16x32_bf16 v[120:123], v[24:27], a[224:227], v[120:123]
    ds_read_b64_tr_b16 v[16:17], v5 offset:18432
    ds_read_b128 v[216:219], v235 offset:32768
    v_mfma_f32_16x16x32_bf16 v[120:123], v[28:31], a[240:243], v[120:123]
    buffer_load_dwordx4 v8, s[12:15], s64 offen offset:2048  lds
    s_mov_b32 s31, 0x00020000
    v_mfma_f32_16x16x32_bf16 v[124:127], v[28:31], a[244:247], v[124:127]
    ds_read_b64_tr_b16 v[18:19], v5 offset:19456
    s_cmp_ge_u32 s73, 162
    s_cselect_b32 s76, 1073741824, s76
    s_cselect_b32 s74, 1073741824, s74
    v_mfma_f32_16x16x32_bf16 v[124:127], v[24:27], a[228:231], v[124:127]
    s_waitcnt vmcnt(12)
    ds_read_b128 v[204:207], v234 offset:34816
    v_mfma_f32_16x16x32_bf16 v[128:131], v[24:27], a[232:235], v[128:131]
    ds_read_b64_tr_b16 v[20:21], v5 offset:26624
    s_lshl_b32 s72, s73, 5
    v_mfma_f32_16x16x32_bf16 v[128:131], v[28:31], a[248:251], v[128:131]
    ds_read_b64_tr_b16 v[22:23], v5 offset:27648
    s_mul_i32 s78, s73, 36
    v_mfma_f32_16x16x32_bf16 v[132:135], v[28:31], a[252:255], v[132:135]
    ds_read_b128 v[220:223], v235 offset:34816
    s_sub_u32 s78, s78, 5184
    v_mfma_f32_16x16x32_bf16 v[132:135], v[24:27], a[236:239], v[132:135]
    s_barrier
    s_waitcnt lgkmcnt(8)
    v_mfma_f32_16x16x32_bf16 v[136:139], v[32:35], a[224:227], v[136:139]
    ds_read_b64_tr_b16 v[24:25], v2 offset:32768
    s_add_u32 m0, s60, 66560
    v_mfma_f32_16x16x32_bf16 v[136:139], v[36:39], a[240:243], v[136:139]
    s_waitcnt vmcnt(9)
    ds_read_b128 v[208:211], v234 offset:36864
    v_mfma_f32_16x16x32_bf16 v[140:143], v[36:39], a[244:247], v[140:143]
    ds_read_b64_tr_b16 v[26:27], v2 offset:33792
    s_cmp_ge_u32 s73, 144
    s_cselect_b32 s28, s36, s44
    s_cselect_b32 s29, s37, s45
    s_cselect_b32 s30, 663552, s30
    s_cselect_b32 s72, s78, s72
    v_mfma_f32_16x16x32_bf16 v[140:143], v[32:35], a[228:231], v[140:143]
    s_add_u32 s64, s63, 1769472
    s_mul_i32 s78, s73, 288
    v_mfma_f32_16x16x32_bf16 v[144:147], v[32:35], a[232:235], v[144:147]
    ds_read_b64_tr_b16 v[28:29], v2 offset:40960
    s_sub_u32 s78, s78, 46064
    v_mfma_f32_16x16x32_bf16 v[144:147], v[36:39], a[248:251], v[144:147]
    ds_read_b64_tr_b16 v[30:31], v2 offset:41984
    ds_read_b128 v[224:227], v235 offset:36864
    v_mfma_f32_16x16x32_bf16 v[148:151], v[36:39], a[252:255], v[148:151]
    buffer_load_dwordx4 v8, s[8:11], s64 offen  lds
    s_cmp_ge_u32 s73, 160
    s_cselect_b32 s72, s78, s72
    s_cselect_b32 s78, 1, 0
    v_mfma_f32_16x16x32_bf16 v[148:151], v[32:35], a[236:239], v[148:151]
    s_mul_i32 s72, s72, 1152
    s_waitcnt lgkmcnt(7)
    v_mfma_f32_16x16x32_bf16 v[152:155], v[16:19], a[224:227], v[152:155]
    ds_read_b64_tr_b16 v[32:33], v2 offset:34816
    s_add_u32 s72, s72, s74
    v_mfma_f32_16x16x32_bf16 v[152:155], v[20:23], a[240:243], v[152:155]
    s_waitcnt vmcnt(8)
    ds_read_b128 v[212:215], v234 offset:38912
    v_mfma_f32_16x16x32_bf16 v[156:159], v[20:23], a[244:247], v[156:159]
    ds_read_b64_tr_b16 v[34:35], v2 offset:35840
    buffer_load_dwordx4 v8, s[12:15], s64 offen offset:2048  lds
    v_mfma_f32_16x16x32_bf16 v[156:159], v[16:19], a[228:231], v[156:159]
    ds_read_b128 v[228:231], v235 offset:38912
    v_mul_u32_u24 v245, s78, v246
    v_mfma_f32_16x16x32_bf16 v[160:163], v[16:19], a[232:235], v[160:163]
    ds_read_b64_tr_b16 v[36:37], v2 offset:43008
    v_add_u32 v245, v245, v244
    v_mfma_f32_16x16x32_bf16 v[160:163], v[20:23], a[248:251], v[160:163]
    ds_read_b64_tr_b16 v[38:39], v2 offset:44032
    s_mov_b32 s74, 17408
    v_mfma_f32_16x16x32_bf16 v[164:167], v[20:23], a[252:255], v[164:167]
    s_cmp_ge_u32 s73, 144
    s_cselect_b32 s74, 19712, s74
    v_mfma_f32_16x16x32_bf16 v[164:167], v[16:19], a[236:239], v[164:167]
    s_waitcnt lgkmcnt(7)
    v_mfma_f32_16x16x32_bf16 v[40:43], v[24:27], v[200:203], v[40:43]
    ds_read_b64_tr_b16 v[16:17], v3 offset:32768
    s_add_u32 m0, s60, 81920
    v_mfma_f32_16x16x32_bf16 v[40:43], v[28:31], v[216:219], v[40:43]
    s_cmp_ge_u32 s73, 160
    s_cselect_b32 s74, 40448, s74
    v_mfma_f32_16x16x32_bf16 v[44:47], v[28:31], v[220:223], v[44:47]
    ds_read_b64_tr_b16 v[18:19], v3 offset:33792
    v_mfma_f32_16x16x32_bf16 v[44:47], v[24:27], v[204:207], v[44:47]
    s_add_u32 s64, s63, 2359296
    s_mul_i32 s78, s78, 156672
    v_mfma_f32_16x16x32_bf16 v[48:51], v[24:27], v[208:211], v[48:51]
    ds_read_b64_tr_b16 v[20:21], v3 offset:40960
    s_add_u32 s78, s78, 9216
    s_waitcnt lgkmcnt(9)
    v_mfma_f32_16x16x32_bf16 v[48:51], v[28:31], v[224:227], v[48:51]
    ds_read_b64_tr_b16 v[22:23], v3 offset:41984
    s_waitcnt lgkmcnt(6)
    v_mfma_f32_16x16x32_bf16 v[52:55], v[28:31], v[228:231], v[52:55]
    buffer_load_dwordx4 v8, s[8:11], s64 offen  lds
    v_mfma_f32_16x16x32_bf16 v[52:55], v[24:27], v[212:215], v[52:55]
    s_waitcnt lgkmcnt(4)
    v_mfma_f32_16x16x32_bf16 v[56:59], v[32:35], v[200:203], v[56:59]
    ds_read_b64_tr_b16 v[24:25], v3 offset:34816
    v_mfma_f32_16x16x32_bf16 v[56:59], v[36:39], v[216:219], v[56:59]
    buffer_load_dwordx4 v8, s[12:15], s64 offen offset:2048  lds
    v_mfma_f32_16x16x32_bf16 v[60:63], v[36:39], v[220:223], v[60:63]
    ds_read_b64_tr_b16 v[26:27], v3 offset:35840
    v_mfma_f32_16x16x32_bf16 v[60:63], v[32:35], v[204:207], v[60:63]
    v_mfma_f32_16x16x32_bf16 v[64:67], v[32:35], v[208:211], v[64:67]
    ds_read_b64_tr_b16 v[28:29], v3 offset:43008
    v_mfma_f32_16x16x32_bf16 v[64:67], v[36:39], v[224:227], v[64:67]
    ds_read_b64_tr_b16 v[30:31], v3 offset:44032
    v_mul_f32 v40, v40, v56
    v_mfma_f32_16x16x32_bf16 v[68:71], v[36:39], v[228:231], v[68:71]
    v_mul_f32 v41, v41, v57
    v_mfma_f32_16x16x32_bf16 v[68:71], v[32:35], v[212:215], v[68:71]
    v_mul_f32 v44, v44, v60
    s_waitcnt lgkmcnt(4)
    v_mfma_f32_16x16x32_bf16 v[72:75], v[16:19], v[200:203], v[72:75]
    ds_read_b64_tr_b16 v[32:33], v4 offset:32768
    v_mul_f32 v45, v45, v61
    v_mfma_f32_16x16x32_bf16 v[72:75], v[20:23], v[216:219], v[72:75]
    v_mul_f32 v42, v42, v58
    v_mul_f32 v46, v46, v62
    v_mfma_f32_16x16x32_bf16 v[76:79], v[20:23], v[220:223], v[76:79]
    ds_read_b64_tr_b16 v[34:35], v4 offset:33792
    v_mul_f32 v47, v47, v63
    v_mfma_f32_16x16x32_bf16 v[76:79], v[16:19], v[204:207], v[76:79]
    s_add_u32 m0, s60, 82944
    v_cvt_pk_bf16_f32 v172, v44, v45
    v_mfma_f32_16x16x32_bf16 v[80:83], v[16:19], v[208:211], v[80:83]
    ds_read_b64_tr_b16 v[36:37], v4 offset:40960
    v_cvt_pk_bf16_f32 v173, v46, v47
    v_mfma_f32_16x16x32_bf16 v[80:83], v[20:23], v[224:227], v[80:83]
    ds_read_b64_tr_b16 v[38:39], v4 offset:41984
    v_mul_f32 v48, v48, v64
    v_mfma_f32_16x16x32_bf16 v[84:87], v[20:23], v[228:231], v[84:87]
    s_add_u32 s64, s63, 2949120
    v_mul_f32 v49, v49, v65
    v_mfma_f32_16x16x32_bf16 v[84:87], v[16:19], v[212:215], v[84:87]
    v_mul_f32 v50, v50, v66
    s_waitcnt lgkmcnt(4)
    v_mfma_f32_16x16x32_bf16 v[88:91], v[24:27], v[200:203], v[88:91]
    ds_read_b64_tr_b16 v[16:17], v4 offset:34816
    v_mul_f32 v51, v51, v67
    v_mfma_f32_16x16x32_bf16 v[88:91], v[28:31], v[216:219], v[88:91]
    buffer_load_dwordx4 v8, s[8:11], s64 offen  lds
    v_cvt_pk_bf16_f32 v176, v48, v49
    v_mfma_f32_16x16x32_bf16 v[92:95], v[28:31], v[220:223], v[92:95]
    ds_read_b64_tr_b16 v[18:19], v4 offset:35840
    v_cvt_pk_bf16_f32 v177, v50, v51
    v_mfma_f32_16x16x32_bf16 v[92:95], v[24:27], v[204:207], v[92:95]
    v_mul_f32 v43, v43, v59
    v_mul_f32 v52, v52, v68
    v_mfma_f32_16x16x32_bf16 v[96:99], v[24:27], v[208:211], v[96:99]
    ds_read_b64_tr_b16 v[20:21], v4 offset:43008
    v_mul_f32 v53, v53, v69
    v_mfma_f32_16x16x32_bf16 v[96:99], v[28:31], v[224:227], v[96:99]
    ds_read_b64_tr_b16 v[22:23], v4 offset:44032
    buffer_load_dwordx4 v8, s[12:15], s64 offen offset:2048  lds
    v_mfma_f32_16x16x32_bf16 v[100:103], v[28:31], v[228:231], v[100:103]
    v_cvt_pk_bf16_f32 v168, v40, v41
    v_mul_f32 v54, v54, v70
    v_mfma_f32_16x16x32_bf16 v[100:103], v[24:27], v[212:215], v[100:103]
    v_mul_f32 v76, v76, v92
    s_waitcnt lgkmcnt(4)
    v_mfma_f32_16x16x32_bf16 v[104:107], v[32:35], v[200:203], v[104:107]
    ds_read_b64_tr_b16 v[24:25], v5 offset:32768
    v_mul_f32 v77, v77, v93
    v_mfma_f32_16x16x32_bf16 v[104:107], v[36:39], v[216:219], v[104:107]
    v_cvt_pk_bf16_f32 v169, v42, v43
    v_mul_f32 v72, v72, v88
    v_mfma_f32_16x16x32_bf16 v[108:111], v[36:39], v[220:223], v[108:111]
    ds_read_b64_tr_b16 v[26:27], v5 offset:33792
    v_mul_f32 v73, v73, v89
    v_mfma_f32_16x16x32_bf16 v[108:111], v[32:35], v[204:207], v[108:111]
    s_add_u32 m0, s60, 98304
    v_mul_f32 v74, v74, v90
    v_mfma_f32_16x16x32_bf16 v[112:115], v[32:35], v[208:211], v[112:115]
    ds_read_b64_tr_b16 v[28:29], v5 offset:40960
    v_mul_f32 v78, v78, v94
    v_mfma_f32_16x16x32_bf16 v[112:115], v[36:39], v[224:227], v[112:115]
    ds_read_b64_tr_b16 v[30:31], v5 offset:41984
    v_mul_f32 v79, v79, v95
    v_mfma_f32_16x16x32_bf16 v[116:119], v[36:39], v[228:231], v[116:119]
    s_add_u32 s64, s63, 3538944
    v_cvt_pk_bf16_f32 v174, v76, v77
    v_mfma_f32_16x16x32_bf16 v[116:119], v[32:35], v[212:215], v[116:119]
    v_cvt_pk_bf16_f32 v175, v78, v79
    s_waitcnt lgkmcnt(4)
    v_mfma_f32_16x16x32_bf16 v[120:123], v[16:19], v[200:203], v[120:123]
    ds_read_b64_tr_b16 v[32:33], v5 offset:34816
    v_mul_f32 v80, v80, v96
    v_mfma_f32_16x16x32_bf16 v[120:123], v[20:23], v[216:219], v[120:123]
    buffer_load_dwordx4 v8, s[8:11], s64 offen  lds
    v_mul_f32 v81, v81, v97
    v_mfma_f32_16x16x32_bf16 v[124:127], v[20:23], v[220:223], v[124:127]
    ds_read_b64_tr_b16 v[34:35], v5 offset:35840
    v_mul_f32 v82, v82, v98
    v_mfma_f32_16x16x32_bf16 v[124:127], v[16:19], v[204:207], v[124:127]
    v_mul_f32 v75, v75, v91
    v_mul_f32 v83, v83, v99
    v_mfma_f32_16x16x32_bf16 v[128:131], v[16:19], v[208:211], v[128:131]
    ds_read_b64_tr_b16 v[36:37], v5 offset:43008
    v_cvt_pk_bf16_f32 v178, v80, v81
    v_mfma_f32_16x16x32_bf16 v[128:131], v[20:23], v[224:227], v[128:131]
    ds_read_b64_tr_b16 v[38:39], v5 offset:44032
    buffer_load_dwordx4 v8, s[12:15], s64 offen offset:2048  lds
    v_mfma_f32_16x16x32_bf16 v[132:135], v[20:23], v[228:231], v[132:135]
    v_cvt_pk_bf16_f32 v170, v72, v73
    v_mul_f32 v55, v55, v71
    v_mfma_f32_16x16x32_bf16 v[132:135], v[16:19], v[212:215], v[132:135]
    s_waitcnt vmcnt(12)
    s_barrier
    s_waitcnt lgkmcnt(4)
    v_mfma_f32_16x16x32_bf16 v[136:139], v[24:27], v[200:203], v[136:139]
    ds_read_b64_tr_b16 v[16:17], v9 offset:49152
    v_cvt_pk_bf16_f32 v180, v52, v53
    v_mfma_f32_16x16x32_bf16 v[136:139], v[28:31], v[216:219], v[136:139]
    v_cvt_pk_bf16_f32 v171, v74, v75
    v_cvt_pk_bf16_f32 v181, v54, v55
    v_mfma_f32_16x16x32_bf16 v[140:143], v[28:31], v[220:223], v[140:143]
    ds_read_b64_tr_b16 v[18:19], v9 offset:49408
    v_mul_f32 v84, v84, v100
    v_mfma_f32_16x16x32_bf16 v[140:143], v[24:27], v[204:207], v[140:143]
    s_add_u32 m0, s60, 99328
    v_mul_f32 v85, v85, v101
    v_mfma_f32_16x16x32_bf16 v[144:147], v[24:27], v[208:211], v[144:147]
    ds_read_b64_tr_b16 v[20:21], v9 offset:57344
    v_mul_f32 v86, v86, v102
    v_mfma_f32_16x16x32_bf16 v[144:147], v[28:31], v[224:227], v[144:147]
    ds_read_b64_tr_b16 v[22:23], v9 offset:57600
    v_mul_f32 v87, v87, v103
L_wm2:
    s_cbranch_execz L_wm6
    v_mfma_f32_16x16x32_bf16 v[148:151], v[28:31], v[228:231], v[148:151]
    s_add_u32 s64, s63, 4128768
    v_cvt_pk_bf16_f32 v182, v84, v85
    v_mfma_f32_16x16x32_bf16 v[148:151], v[24:27], v[212:215], v[148:151]
    v_cvt_pk_bf16_f32 v183, v86, v87
    s_waitcnt lgkmcnt(4)
    v_mfma_f32_16x16x32_bf16 v[152:155], v[32:35], v[200:203], v[152:155]
    ds_read_b64_tr_b16 v[24:25], v9 offset:51200
    v_mul_f32 v104, v104, v120
    v_mfma_f32_16x16x32_bf16 v[152:155], v[36:39], v[216:219], v[152:155]
    buffer_load_dwordx4 v8, s[8:11], s64 offen  lds
    v_mul_f32 v105, v105, v121
    v_mfma_f32_16x16x32_bf16 v[156:159], v[36:39], v[220:223], v[156:159]
    ds_read_b64_tr_b16 v[26:27], v9 offset:51456
    v_mul_f32 v106, v106, v122
    v_mfma_f32_16x16x32_bf16 v[156:159], v[32:35], v[204:207], v[156:159]
    buffer_load_dwordx4 v8, s[12:15], s64 offen offset:2048  lds
    v_mul_f32 v107, v107, v123
    v_mfma_f32_16x16x32_bf16 v[160:163], v[32:35], v[208:211], v[160:163]
    ds_read_b64_tr_b16 v[28:29], v9 offset:59392
    v_cvt_pk_bf16_f32 v184, v104, v105
    v_mfma_f32_16x16x32_bf16 v[160:163], v[36:39], v[224:227], v[160:163]
    ds_read_b64_tr_b16 v[30:31], v9 offset:59648
    v_cvt_pk_bf16_f32 v185, v106, v107
    v_mfma_f32_16x16x32_bf16 v[164:167], v[36:39], v[228:231], v[164:167]
    v_cvt_pk_bf16_f32 v179, v82, v83
    v_mul_f32 v108, v108, v124
    v_mfma_f32_16x16x32_bf16 v[164:167], v[32:35], v[212:215], v[164:167]
    v_mul_f32 v109, v109, v125
    s_waitcnt lgkmcnt(4)
    v_mfma_f32_16x16x32_bf16 v[40:43], v[16:19], a[0:3], 0
    ds_read_b64_tr_b16 v[32:33], v10 offset:49152
    v_mul_f32 v110, v110, v126
    v_mfma_f32_16x16x32_bf16 v[40:43], v[20:23], a[16:19], v[40:43]
    ds_read_b64_tr_b16 v[34:35], v10 offset:49408
    s_add_u32 m0, s60, 114688
    v_mfma_f32_16x16x32_bf16 v[44:47], v[20:23], a[20:23], 0
    ds_read_b64_tr_b16 v[36:37], v10 offset:57344
    ds_read_b64_tr_b16 v[38:39], v10 offset:57600
    v_mfma_f32_16x16x32_bf16 v[44:47], v[16:19], a[4:7], v[44:47]
    s_lshl_b32 s0, s58, 6
    s_waitcnt lgkmcnt(4)
    v_mfma_f32_16x16x32_bf16 v[56:59], v[24:27], a[0:3], 0
    ds_read_b64_tr_b16 v[16:17], v10 offset:51200
    s_lshl_b32 s0, s0, 7
    s_add_u32 s0, s0, 28311552
    v_mfma_f32_16x16x32_bf16 v[56:59], v[28:31], a[16:19], v[56:59]
    ds_read_b64_tr_b16 v[18:19], v10 offset:51456
    s_cmp_eq_u32 s54, 0
    s_cselect_b32 s0, s0, 1073741824
    v_mfma_f32_16x16x32_bf16 v[60:63], v[28:31], a[20:23], 0
    ds_read_b64_tr_b16 v[20:21], v10 offset:59392
    ds_read_b64_tr_b16 v[22:23], v10 offset:59648
    v_bfe_u32 v1, v11, 4, 6
    v_mfma_f32_16x16x32_bf16 v[60:63], v[24:27], a[4:7], v[60:63]
    s_waitcnt vmcnt(12)
    s_barrier
    buffer_store_dwordx4 v[168:171], v11, s[16:19], s66 offen offset:0 sc1
    s_waitcnt lgkmcnt(4)
    v_mfma_f32_16x16x32_bf16 v[72:75], v[32:35], a[0:3], 0
    ds_read_b64_tr_b16 v[24:25], v9 offset:50176
    v_lshlrev_b32 v1, 7, v1
    buffer_load_dword v1, v1, s[16:19], s0 offen sc1
    v_mfma_f32_16x16x32_bf16 v[72:75], v[36:39], a[16:19], v[72:75]
    ds_read_b64_tr_b16 v[26:27], v9 offset:50432
    s_add_u32 s64, s63, 4718592
    v_mfma_f32_16x16x32_bf16 v[76:79], v[36:39], a[20:23], 0
    ds_read_b64_tr_b16 v[28:29], v9 offset:58368
    ds_read_b64_tr_b16 v[30:31], v9 offset:58624
    v_mfma_f32_16x16x32_bf16 v[76:79], v[32:35], a[4:7], v[76:79]
    buffer_load_dwordx4 v8, s[8:11], s64 offen  lds
    s_waitcnt lgkmcnt(4)
    v_mfma_f32_16x16x32_bf16 v[88:91], v[16:19], a[0:3], 0
    ds_read_b64_tr_b16 v[32:33], v9 offset:52224
    buffer_load_dwordx4 v8, s[12:15], s64 offen offset:2048  lds
    v_mfma_f32_16x16x32_bf16 v[88:91], v[20:23], a[16:19], v[88:91]
    ds_read_b64_tr_b16 v[34:35], v9 offset:52480
    v_mul_f32 v111, v111, v127
    v_mfma_f32_16x16x32_bf16 v[92:95], v[20:23], a[20:23], 0
    ds_read_b64_tr_b16 v[36:37], v9 offset:60416
    ds_read_b64_tr_b16 v[38:39], v9 offset:60672
    v_mfma_f32_16x16x32_bf16 v[92:95], v[16:19], a[4:7], v[92:95]
    s_add_u32 m0, s77, 0
    s_waitcnt lgkmcnt(4)
    v_mfma_f32_16x16x32_bf16 v[40:43], v[24:27], a[32:35], v[40:43]
    ds_read_b64_tr_b16 v[16:17], v10 offset:50176
    s_add_u32 s3, s81, 0
    v_mfma_f32_16x16x32_bf16 v[40:43], v[28:31], a[48:51], v[40:43]
    ds_read_b64_tr_b16 v[18:19], v10 offset:50432
    v_cvt_pk_bf16_f32 v188, v108, v109
    v_mfma_f32_16x16x32_bf16 v[44:47], v[28:31], a[52:55], v[44:47]
    ds_read_b64_tr_b16 v[20:21], v10 offset:58368
    ds_read_b64_tr_b16 v[22:23], v10 offset:58624
    v_mfma_f32_16x16x32_bf16 v[44:47], v[24:27], a[36:39], v[44:47]
    buffer_load_dwordx4 v244, s[24:27], s3 offen  lds
    s_waitcnt lgkmcnt(4)
    v_mfma_f32_16x16x32_bf16 v[56:59], v[32:35], a[32:35], v[56:59]
    ds_read_b64_tr_b16 v[24:25], v10 offset:52224
    s_add_u32 s3, s81, 17408
    v_mfma_f32_16x16x32_bf16 v[56:59], v[36:39], a[48:51], v[56:59]
    ds_read_b64_tr_b16 v[26:27], v10 offset:52480
    buffer_load_dwordx4 v244, s[24:27], s3 offen offset:1024  lds
    v_mfma_f32_16x16x32_bf16 v[60:63], v[36:39], a[52:55], v[60:63]
    ds_read_b64_tr_b16 v[28:29], v10 offset:60416
    ds_read_b64_tr_b16 v[30:31], v10 offset:60672
    v_mfma_f32_16x16x32_bf16 v[60:63], v[32:35], a[36:39], v[60:63]
    s_waitcnt vmcnt(16)
    s_barrier
    s_waitcnt lgkmcnt(4)
    v_mfma_f32_16x16x32_bf16 v[72:75], v[16:19], a[32:35], v[72:75]
    v_xor_b32 v9, 65536, v9
    v_xor_b32 v10, 65536, v10
    v_mfma_f32_16x16x32_bf16 v[72:75], v[20:23], a[48:51], v[72:75]
    ds_read_b64_tr_b16 v[32:33], v9 offset:0
    ds_read_b64_tr_b16 v[34:35], v9 offset:256
    v_mfma_f32_16x16x32_bf16 v[76:79], v[20:23], a[52:55], v[76:79]
    ds_read_b64_tr_b16 v[36:37], v9 offset:8192
    ds_read_b64_tr_b16 v[38:39], v9 offset:8448
    v_mfma_f32_16x16x32_bf16 v[76:79], v[16:19], a[36:39], v[76:79]
    s_add_u32 m0, s77, 4096
    s_waitcnt lgkmcnt(4)
    v_mfma_f32_16x16x32_bf16 v[88:91], v[24:27], a[32:35], v[88:91]
    ds_read_b64_tr_b16 v[16:17], v9 offset:2048
    s_add_u32 s3, s81, 9216
    v_mfma_f32_16x16x32_bf16 v[88:91], v[28:31], a[48:51], v[88:91]
    ds_read_b64_tr_b16 v[18:19], v9 offset:2304
    buffer_load_dwordx4 v244, s[24:27], s3 offen  lds
    v_mfma_f32_16x16x32_bf16 v[92:95], v[28:31], a[52:55], v[92:95]
    ds_read_b64_tr_b16 v[20:21], v9 offset:10240
    ds_read_b64_tr_b16 v[22:23], v9 offset:10496
    v_mfma_f32_16x16x32_bf16 v[92:95], v[24:27], a[36:39], v[92:95]
    v_cvt_pk_bf16_f32 v189, v110, v111
    s_waitcnt lgkmcnt(4)
    v_mfma_f32_16x16x32_bf16 v[40:43], v[32:35], a[64:67], v[40:43]
    ds_read_b64_tr_b16 v[24:25], v10 offset:0
    s_add_u32 s3, s81, 26624
    v_mfma_f32_16x16x32_bf16 v[40:43], v[36:39], a[80:83], v[40:43]
    ds_read_b64_tr_b16 v[26:27], v10 offset:256
    buffer_load_dwordx4 v244, s[24:27], s3 offen offset:1024  lds
    v_mfma_f32_16x16x32_bf16 v[44:47], v[36:39], a[84:87], v[44:47]
    ds_read_b64_tr_b16 v[28:29], v10 offset:8192
    ds_read_b64_tr_b16 v[30:31], v10 offset:8448
    v_mfma_f32_16x16x32_bf16 v[44:47], v[32:35], a[68:71], v[44:47]
    v_mul_f32 v112, v112, v128
    s_waitcnt lgkmcnt(4)
    v_mfma_f32_16x16x32_bf16 v[56:59], v[16:19], a[64:67], v[56:59]
    ds_read_b64_tr_b16 v[32:33], v10 offset:2048
    s_add_u32 m0, s77, 16384
    v_mfma_f32_16x16x32_bf16 v[56:59], v[20:23], a[80:83], v[56:59]
    ds_read_b64_tr_b16 v[34:35], v10 offset:2304
    s_add_u32 s73, s72, s74
    v_mfma_f32_16x16x32_bf16 v[60:63], v[20:23], a[84:87], v[60:63]
    ds_read_b64_tr_b16 v[36:37], v10 offset:10240
    ds_read_b64_tr_b16 v[38:39], v10 offset:10496
    v_mfma_f32_16x16x32_bf16 v[60:63], v[16:19], a[68:71], v[60:63]
    s_waitcnt vmcnt(16)
    s_barrier
    s_waitcnt lgkmcnt(4)
    v_mfma_f32_16x16x32_bf16 v[72:75], v[24:27], a[64:67], v[72:75]
    ds_read_b64_tr_b16 v[16:17], v9 offset:1024
    v_mul_f32 v113, v113, v129
    v_mfma_f32_16x16x32_bf16 v[72:75], v[28:31], a[80:83], v[72:75]
    ds_read_b64_tr_b16 v[18:19], v9 offset:1280
    buffer_load_dwordx4 v245, s[28:31], s72 offen  lds
    v_mfma_f32_16x16x32_bf16 v[76:79], v[28:31], a[84:87], v[76:79]
    ds_read_b64_tr_b16 v[20:21], v9 offset:9216
    ds_read_b64_tr_b16 v[22:23], v9 offset:9472
    v_mfma_f32_16x16x32_bf16 v[76:79], v[24:27], a[68:71], v[76:79]
    buffer_load_dwordx4 v245, s[28:31], s73 offen offset:1024  lds
    s_waitcnt lgkmcnt(4)
    v_mfma_f32_16x16x32_bf16 v[88:91], v[32:35], a[64:67], v[88:91]
    ds_read_b64_tr_b16 v[24:25], v9 offset:3072
    v_mul_f32 v114, v114, v130
    buffer_store_dwordx4 v[172:175], v11, s[16:19], s67 offen offset:0 sc1
    v_mfma_f32_16x16x32_bf16 v[88:91], v[36:39], a[80:83], v[88:91]
    ds_read_b64_tr_b16 v[26:27], v9 offset:3328
    s_add_u32 m0, s77, 20480
    v_mfma_f32_16x16x32_bf16 v[92:95], v[36:39], a[84:87], v[92:95]
    ds_read_b64_tr_b16 v[28:29], v9 offset:11264
    ds_read_b64_tr_b16 v[30:31], v9 offset:11520
    v_mfma_f32_16x16x32_bf16 v[92:95], v[32:35], a[68:71], v[92:95]
    s_add_u32 s72, s72, s78
    s_waitcnt lgkmcnt(4)
    v_mfma_f32_16x16x32_bf16 v[40:43], v[16:19], a[96:99], v[40:43]
    ds_read_b64_tr_b16 v[32:33], v10 offset:1024
    s_add_u32 s73, s72, s74
    v_mfma_f32_16x16x32_bf16 v[40:43], v[20:23], a[112:115], v[40:43]
    ds_read_b64_tr_b16 v[34:35], v10 offset:1280
    buffer_load_dwordx4 v245, s[28:31], s72 offen  lds
    v_mfma_f32_16x16x32_bf16 v[44:47], v[20:23], a[116:119], v[44:47]
    ds_read_b64_tr_b16 v[36:37], v10 offset:9216
    ds_read_b64_tr_b16 v[38:39], v10 offset:9472
    v_mfma_f32_16x16x32_bf16 v[44:47], v[16:19], a[100:103], v[44:47]
    s_waitcnt vmcnt(10)
    v_cmp_ne_u32 vcc, s1, v1
    s_waitcnt lgkmcnt(4)
    v_mfma_f32_16x16x32_bf16 v[56:59], v[24:27], a[96:99], v[56:59]
    ds_read_b64_tr_b16 v[16:17], v10 offset:3072
    buffer_load_dwordx4 v245, s[28:31], s73 offen offset:1024  lds
    v_mfma_f32_16x16x32_bf16 v[56:59], v[28:31], a[112:115], v[56:59]
    ds_read_b64_tr_b16 v[18:19], v10 offset:3328
    s_mov_b32 s0, s0
    s_cbranch_vccnz L_slow_cq
L_ok_cq:
    v_mfma_f32_16x16x32_bf16 v[60:63], v[28:31], a[116:119], v[60:63]
    ds_read_b64_tr_b16 v[20:21], v10 offset:11264
    ds_read_b64_tr_b16 v[22:23], v10 offset:11520
    v_mfma_f32_16x16x32_bf16 v[60:63], v[24:27], a[100:103], v[60:63]
    s_barrier
    s_waitcnt lgkmcnt(4)
    v_mfma_f32_16x16x32_bf16 v[72:75], v[32:35], a[96:99], v[72:75]
    ds_read_b64_tr_b16 v[24:25], v9 offset:16384
    v_mul_f32 v115, v115, v131
    v_mfma_f32_16x16x32_bf16 v[72:75], v[36:39], a[112:115], v[72:75]
    ds_read_b64_tr_b16 v[26:27], v9 offset:16640
    v_cvt_pk_bf16_f32 v192, v112, v113
    v_mfma_f32_16x16x32_bf16 v[76:79], v[36:39], a[116:119], v[76:79]
    ds_read_b64_tr_b16 v[28:29], v9 offset:24576
    ds_read_b64_tr_b16 v[30:31], v9 offset:24832
    v_mfma_f32_16x16x32_bf16 v[76:79], v[32:35], a[100:103], v[76:79]
    s_add_u32 m0, s60, 0
    s_waitcnt lgkmcnt(4)
    v_mfma_f32_16x16x32_bf16 v[88:91], v[16:19], a[96:99], v[88:91]
    ds_read_b64_tr_b16 v[32:33], v9 offset:18432
    v_cvt_pk_bf16_f32 v193, v114, v115
    v_mul_f32 v144, v144, v160
    v_mfma_f32_16x16x32_bf16 v[88:91], v[20:23], a[112:115], v[88:91]
    ds_read_b64_tr_b16 v[34:35], v9 offset:18688
    s_add_u32 s64, s62, 0
    v_mul_f32 v145, v145, v161
    v_mfma_f32_16x16x32_bf16 v[92:95], v[20:23], a[116:119], v[92:95]
    ds_read_b64_tr_b16 v[36:37], v9 offset:26624
    ds_read_b64_tr_b16 v[38:39], v9 offset:26880
    v_mul_f32 v146, v146, v162
    v_mfma_f32_16x16x32_bf16 v[92:95], v[16:19], a[100:103], v[92:95]
    buffer_load_dwordx4 v7, s[16:19], s64 offen sc1 lds
    v_mul_f32 v147, v147, v163
    s_waitcnt lgkmcnt(4)
    v_mfma_f32_16x16x32_bf16 v[40:43], v[24:27], a[128:131], v[40:43]
    ds_read_b64_tr_b16 v[16:17], v10 offset:16384
    s_add_u32 s65, s62, 4294966784
    v_mfma_f32_16x16x32_bf16 v[40:43], v[28:31], a[144:147], v[40:43]
    ds_read_b64_tr_b16 v[18:19], v10 offset:16640
    buffer_load_dwordx4 v7, s[16:19], s65 offen offset:1024 sc1 lds
    v_mfma_f32_16x16x32_bf16 v[44:47], v[28:31], a[148:151], v[44:47]
    ds_read_b64_tr_b16 v[20:21], v10 offset:24576
    ds_read_b64_tr_b16 v[22:23], v10 offset:24832
    v_mfma_f32_16x16x32_bf16 v[44:47], v[24:27], a[132:135], v[44:47]
    v_mul_f32 v116, v116, v132
    s_waitcnt lgkmcnt(4)
    v_mfma_f32_16x16x32_bf16 v[56:59], v[32:35], a[128:131], v[56:59]
    ds_read_b64_tr_b16 v[24:25], v10 offset:18432
    s_add_u32 m0, s60, 2048
    v_mfma_f32_16x16x32_bf16 v[56:59], v[36:39], a[144:147], v[56:59]
    ds_read_b64_tr_b16 v[26:27], v10 offset:18688
    s_add_u32 s64, s62, 8192
    v_mfma_f32_16x16x32_bf16 v[60:63], v[36:39], a[148:151], v[60:63]
    ds_read_b64_tr_b16 v[28:29], v10 offset:26624
    ds_read_b64_tr_b16 v[30:31], v10 offset:26880
    v_mfma_f32_16x16x32_bf16 v[60:63], v[32:35], a[132:135], v[60:63]
    s_barrier
    s_waitcnt lgkmcnt(4)
    v_mfma_f32_16x16x32_bf16 v[72:75], v[16:19], a[128:131], v[72:75]
    ds_read_b64_tr_b16 v[32:33], v9 offset:17408
    buffer_load_dwordx4 v7, s[16:19], s64 offen sc1 lds
    v_mfma_f32_16x16x32_bf16 v[72:75], v[20:23], a[144:147], v[72:75]
    ds_read_b64_tr_b16 v[34:35], v9 offset:17664
    v_mul_f32 v117, v117, v133
    v_mfma_f32_16x16x32_bf16 v[76:79], v[20:23], a[148:151], v[76:79]
    ds_read_b64_tr_b16 v[36:37], v9 offset:25600
    ds_read_b64_tr_b16 v[38:39], v9 offset:25856
    v_mfma_f32_16x16x32_bf16 v[76:79], v[16:19], a[132:135], v[76:79]
    s_add_u32 s65, s62, 7680
    s_waitcnt lgkmcnt(4)
    v_mfma_f32_16x16x32_bf16 v[88:91], v[24:27], a[128:131], v[88:91]
    ds_read_b64_tr_b16 v[16:17], v9 offset:19456
    buffer_load_dwordx4 v7, s[16:19], s65 offen offset:1024 sc1 lds
    v_mfma_f32_16x16x32_bf16 v[88:91], v[28:31], a[144:147], v[88:91]
    ds_read_b64_tr_b16 v[18:19], v9 offset:19712
    v_mul_f32 v118, v118, v134
    v_mfma_f32_16x16x32_bf16 v[92:95], v[28:31], a[148:151], v[92:95]
    ds_read_b64_tr_b16 v[20:21], v9 offset:27648
    ds_read_b64_tr_b16 v[22:23], v9 offset:27904
    v_mfma_f32_16x16x32_bf16 v[92:95], v[24:27], a[132:135], v[92:95]
    v_mul_f32 v119, v119, v135
    s_waitcnt lgkmcnt(4)
    v_mfma_f32_16x16x32_bf16 v[40:43], v[32:35], a[160:163], v[40:43]
    ds_read_b64_tr_b16 v[24:25], v10 offset:17408
    s_add_u32 m0, s60, 16384
    v_mfma_f32_16x16x32_bf16 v[40:43], v[36:39], a[176:179], v[40:43]
    ds_read_b64_tr_b16 v[26:27], v10 offset:17664
    v_cvt_pk_bf16_f32 v196, v116, v117
    v_mfma_f32_16x16x32_bf16 v[44:47], v[36:39], a[180:183], v[44:47]
    ds_read_b64_tr_b16 v[28:29], v10 offset:25600
    ds_read_b64_tr_b16 v[30:31], v10 offset:25856
    buffer_store_dwordx4 v[176:179], v11, s[16:19], s68 offen offset:0 sc1
    v_mfma_f32_16x16x32_bf16 v[44:47], v[32:35], a[164:167], v[44:47]
    s_add_u32 s64, s62, 16384
    s_waitcnt lgkmcnt(4)
    v_mfma_f32_16x16x32_bf16 v[56:59], v[16:19], a[160:163], v[56:59]
    ds_read_b64_tr_b16 v[32:33], v10 offset:19456
    buffer_load_dwordx4 v7, s[16:19], s64 offen sc1 lds
    v_mfma_f32_16x16x32_bf16 v[56:59], v[20:23], a[176:179], v[56:59]
    ds_read_b64_tr_b16 v[34:35], v10 offset:19712
    v_cvt_pk_bf16_f32 v197, v118, v119
    v_mul_f32 v148, v148, v164
    v_mfma_f32_16x16x32_bf16 v[60:63], v[20:23], a[180:183], v[60:63]
    ds_read_b64_tr_b16 v[36:37], v10 offset:27648
    ds_read_b64_tr_b16 v[38:39], v10 offset:27904
    v_mul_f32 v149, v149, v165
    v_mfma_f32_16x16x32_bf16 v[60:63], v[16:19], a[164:167], v[60:63]
    s_barrier
    s_waitcnt lgkmcnt(4)
    v_mfma_f32_16x16x32_bf16 v[72:75], v[24:27], a[160:163], v[72:75]
    ds_read_b64_tr_b16 v[16:17], v9 offset:32768
    s_add_u32 s65, s62, 15872
    v_mul_f32 v150, v150, v166
    v_mfma_f32_16x16x32_bf16 v[72:75], v[28:31], a[176:179], v[72:75]
    ds_read_b64_tr_b16 v[18:19], v9 offset:33024
    buffer_load_dwordx4 v7, s[16:19], s65 offen offset:1024 sc1 lds
    v_mul_f32 v151, v151, v167
    v_mfma_f32_16x16x32_bf16 v[76:79], v[28:31], a[180:183], v[76:79]
    ds_read_b64_tr_b16 v[20:21], v9 offset:40960
    ds_read_b64_tr_b16 v[22:23], v9 offset:41216
    v_cvt_pk_bf16_f32 v198, v148, v149
    v_mfma_f32_16x16x32_bf16 v[76:79], v[24:27], a[164:167], v[76:79]
    v_mul_f32 v136, v136, v152
    v_cvt_pk_bf16_f32 v199, v150, v151
    s_waitcnt lgkmcnt(4)
    v_mfma_f32_16x16x32_bf16 v[88:91], v[32:35], a[160:163], v[88:91]
    ds_read_b64_tr_b16 v[24:25], v9 offset:34816
    s_add_u32 m0, s60, 18432
    v_mfma_f32_16x16x32_bf16 v[88:91], v[36:39], a[176:179], v[88:91]
    ds_read_b64_tr_b16 v[26:27], v9 offset:35072
    v_mul_f32 v137, v137, v153
    v_mfma_f32_16x16x32_bf16 v[92:95], v[36:39], a[180:183], v[92:95]
    ds_read_b64_tr_b16 v[28:29], v9 offset:43008
    ds_read_b64_tr_b16 v[30:31], v9 offset:43264
    v_mfma_f32_16x16x32_bf16 v[92:95], v[32:35], a[164:167], v[92:95]
    s_add_u32 s64, s62, 24576
    s_waitcnt lgkmcnt(4)
    v_mfma_f32_16x16x32_bf16 v[40:43], v[16:19], a[192:195], v[40:43]
    ds_read_b64_tr_b16 v[32:33], v10 offset:32768
    v_mul_f32 v138, v138, v154
    v_mfma_f32_16x16x32_bf16 v[40:43], v[20:23], a[208:211], v[40:43]
    ds_read_b64_tr_b16 v[34:35], v10 offset:33024
    buffer_load_dwordx4 v7, s[16:19], s64 offen sc1 lds
    v_mfma_f32_16x16x32_bf16 v[44:47], v[20:23], a[212:215], v[44:47]
    ds_read_b64_tr_b16 v[36:37], v10 offset:40960
    ds_read_b64_tr_b16 v[38:39], v10 offset:41216
    v_mfma_f32_16x16x32_bf16 v[44:47], v[16:19], a[196:199], v[44:47]
    s_add_u32 s65, s62, 24064
    s_waitcnt lgkmcnt(4)
    v_mfma_f32_16x16x32_bf16 v[56:59], v[24:27], a[192:195], v[56:59]
    ds_read_b64_tr_b16 v[16:17], v10 offset:34816
    v_mul_f32 v139, v139, v155
    v_mfma_f32_16x16x32_bf16 v[56:59], v[28:31], a[208:211], v[56:59]
    ds_read_b64_tr_b16 v[18:19], v10 offset:35072
    buffer_load_dwordx4 v7, s[16:19], s65 offen offset:1024 sc1 lds
    v_mfma_f32_16x16x32_bf16 v[60:63], v[28:31], a[212:215], v[60:63]
    ds_read_b64_tr_b16 v[20:21], v10 offset:43008
    ds_read_b64_tr_b16 v[22:23], v10 offset:43264
    v_mfma_f32_16x16x32_bf16 v[60:63], v[24:27], a[196:199], v[60:63]
    s_barrier
    s_waitcnt lgkmcnt(4)
    v_mfma_f32_16x16x32_bf16 v[72:75], v[32:35], a[192:195], v[72:75]
    ds_read_b64_tr_b16 v[24:25], v9 offset:33792
    v_cvt_pk_bf16_f32 v186, v136, v137
    v_mfma_f32_16x16x32_bf16 v[72:75], v[36:39], a[208:211], v[72:75]
    ds_read_b64_tr_b16 v[26:27], v9 offset:34048
    s_add_u32 m0, s60, 32768
    v_mfma_f32_16x16x32_bf16 v[76:79], v[36:39], a[212:215], v[76:79]
    ds_read_b64_tr_b16 v[28:29], v9 offset:41984
    ds_read_b64_tr_b16 v[30:31], v9 offset:42240
    v_mfma_f32_16x16x32_bf16 v[76:79], v[32:35], a[196:199], v[76:79]
    v_cvt_pk_bf16_f32 v187, v138, v139
    s_waitcnt lgkmcnt(4)
    v_mfma_f32_16x16x32_bf16 v[88:91], v[16:19], a[192:195], v[88:91]
    ds_read_b64_tr_b16 v[32:33], v9 offset:35840
    s_add_u32 s64, s62, 32768
    v_mfma_f32_16x16x32_bf16 v[88:91], v[20:23], a[208:211], v[88:91]
    ds_read_b64_tr_b16 v[34:35], v9 offset:36096
    v_mul_f32 v140, v140, v156
    v_mfma_f32_16x16x32_bf16 v[92:95], v[20:23], a[212:215], v[92:95]
    ds_read_b64_tr_b16 v[36:37], v9 offset:44032
    ds_read_b64_tr_b16 v[38:39], v9 offset:44288
    v_mfma_f32_16x16x32_bf16 v[92:95], v[16:19], a[196:199], v[92:95]
    buffer_load_dwordx4 v7, s[16:19], s64 offen sc1 lds
    s_waitcnt lgkmcnt(4)
    v_mfma_f32_16x16x32_bf16 v[40:43], v[24:27], a[224:227], v[40:43]
    ds_read_b64_tr_b16 v[16:17], v10 offset:33792
    v_mul_f32 v141, v141, v157
    v_mfma_f32_16x16x32_bf16 v[40:43], v[28:31], a[240:243], v[40:43]
    ds_read_b64_tr_b16 v[18:19], v10 offset:34048
    s_add_u32 s65, s62, 32256
    v_mfma_f32_16x16x32_bf16 v[44:47], v[28:31], a[244:247], v[44:47]
    ds_read_b64_tr_b16 v[20:21], v10 offset:41984
    ds_read_b64_tr_b16 v[22:23], v10 offset:42240
    v_mfma_f32_16x16x32_bf16 v[44:47], v[24:27], a[228:231], v[44:47]
    buffer_load_dwordx4 v7, s[16:19], s65 offen offset:1024 sc1 lds
    s_waitcnt lgkmcnt(4)
    v_mfma_f32_16x16x32_bf16 v[56:59], v[32:35], a[224:227], v[56:59]
    ds_read_b64_tr_b16 v[24:25], v10 offset:35840
    v_mul_f32 v142, v142, v158
    v_mfma_f32_16x16x32_bf16 v[56:59], v[36:39], a[240:243], v[56:59]
    ds_read_b64_tr_b16 v[26:27], v10 offset:36096
    v_mul_f32 v143, v143, v159
    v_mfma_f32_16x16x32_bf16 v[60:63], v[36:39], a[244:247], v[60:63]
    ds_read_b64_tr_b16 v[28:29], v10 offset:44032
    ds_read_b64_tr_b16 v[30:31], v10 offset:44288
    v_mfma_f32_16x16x32_bf16 v[60:63], v[32:35], a[228:231], v[60:63]
    s_waitcnt vmcnt(20)
    s_barrier
    s_waitcnt lgkmcnt(4)
    v_mfma_f32_16x16x32_bf16 v[72:75], v[16:19], a[224:227], v[72:75]
    ds_read_b64_tr_b16 v[32:33], v9 offset:49152
    s_add_u32 m0, s60, 34816
    buffer_store_dwordx4 v[180:183], v11, s[16:19], s69 offen offset:0 sc1
    v_mfma_f32_16x16x32_bf16 v[72:75], v[20:23], a[240:243], v[72:75]
    ds_read_b64_tr_b16 v[34:35], v9 offset:49408
    v_cvt_pk_bf16_f32 v190, v140, v141
    v_mfma_f32_16x16x32_bf16 v[76:79], v[20:23], a[244:247], v[76:79]
    ds_read_b64_tr_b16 v[36:37], v9 offset:57344
    ds_read_b64_tr_b16 v[38:39], v9 offset:57600
    v_mfma_f32_16x16x32_bf16 v[76:79], v[16:19], a[228:231], v[76:79]
    s_add_u32 s64, s62, 40960
    s_waitcnt lgkmcnt(4)
    v_mfma_f32_16x16x32_bf16 v[88:91], v[24:27], a[224:227], v[88:91]
    ds_read_b64_tr_b16 v[16:17], v9 offset:51200
    buffer_load_dwordx4 v7, s[16:19], s64 offen sc1 lds
    v_mfma_f32_16x16x32_bf16 v[88:91], v[28:31], a[240:243], v[88:91]
    ds_read_b64_tr_b16 v[18:19], v9 offset:51456
    v_cvt_pk_bf16_f32 v191, v142, v143
    v_mfma_f32_16x16x32_bf16 v[92:95], v[28:31], a[244:247], v[92:95]
    ds_read_b64_tr_b16 v[20:21], v9 offset:59392
    ds_read_b64_tr_b16 v[22:23], v9 offset:59648
    v_mfma_f32_16x16x32_bf16 v[92:95], v[24:27], a[228:231], v[92:95]
    s_add_u32 s65, s62, 40448
    s_waitcnt lgkmcnt(4)
    v_mfma_f32_16x16x32_bf16 v[40:43], v[32:35], v[200:203], v[40:43]
    ds_read_b64_tr_b16 v[24:25], v10 offset:49152
    v_cvt_pk_bf16_f32 v194, v144, v145
    v_mfma_f32_16x16x32_bf16 v[40:43], v[36:39], v[216:219], v[40:43]
    ds_read_b64_tr_b16 v[26:27], v10 offset:49408
    buffer_load_dwordx4 v7, s[16:19], s65 offen offset:1024 sc1 lds
    v_mfma_f32_16x16x32_bf16 v[44:47], v[36:39], v[220:223], v[44:47]
    ds_read_b64_tr_b16 v[28:29], v10 offset:57344
    ds_read_b64_tr_b16 v[30:31], v10 offset:57600
    v_mfma_f32_16x16x32_bf16 v[44:47], v[32:35], v[204:207], v[44:47]
    v_cvt_pk_bf16_f32 v195, v146, v147
    s_waitcnt lgkmcnt(4)
    v_mfma_f32_16x16x32_bf16 v[56:59], v[16:19], v[200:203], v[56:59]
    ds_read_b64_tr_b16 v[32:33], v10 offset:51200
    s_add_u32 m0, s60, 49152
    v_mfma_f32_16x16x32_bf16 v[56:59], v[20:23], v[216:219], v[56:59]
    ds_read_b64_tr_b16 v[34:35], v10 offset:51456
    s_add_u32 s64, s62, 49152
    v_mfma_f32_16x16x32_bf16 v[60:63], v[20:23], v[220:223], v[60:63]
    ds_read_b64_tr_b16 v[36:37], v10 offset:59392
    ds_read_b64_tr_b16 v[38:39], v10 offset:59648
    v_mfma_f32_16x16x32_bf16 v[60:63], v[16:19], v[204:207], v[60:63]
    s_waitcnt vmcnt(12)
    s_barrier
    s_waitcnt lgkmcnt(4)
    v_mfma_f32_16x16x32_bf16 v[72:75], v[24:27], v[200:203], v[72:75]
    ds_read_b64_tr_b16 v[16:17], v2 offset:0
    buffer_load_dwordx4 v7, s[16:19], s64 offen sc1 lds
    v_mfma_f32_16x16x32_bf16 v[72:75], v[28:31], v[216:219], v[72:75]
    ds_read_b64_tr_b16 v[18:19], v2 offset:1024
    v_mul_f32 v40, v40, v56
    v_mfma_f32_16x16x32_bf16 v[76:79], v[28:31], v[220:223], v[76:79]
    ds_read_b64_tr_b16 v[20:21], v2 offset:8192
    ds_read_b64_tr_b16 v[22:23], v2 offset:9216
    v_mfma_f32_16x16x32_bf16 v[76:79], v[24:27], v[204:207], v[76:79]
    s_add_u32 s65, s62, 48640
    s_waitcnt lgkmcnt(4)
    v_mfma_f32_16x16x32_bf16 v[88:91], v[32:35], v[200:203], v[88:91]
    ds_read_b64_tr_b16 v[24:25], v3 offset:0
    v_mul_f32 v41, v41, v57
    v_mfma_f32_16x16x32_bf16 v[88:91], v[36:39], v[216:219], v[88:91]
    ds_read_b64_tr_b16 v[26:27], v3 offset:1024
    buffer_load_dwordx4 v7, s[16:19], s65 offen offset:1024 sc1 lds
    v_mfma_f32_16x16x32_bf16 v[92:95], v[36:39], v[220:223], v[92:95]
    ds_read_b64_tr_b16 v[28:29], v3 offset:8192
    ds_read_b64_tr_b16 v[30:31], v3 offset:9216
    v_mfma_f32_16x16x32_bf16 v[92:95], v[32:35], v[204:207], v[92:95]
    v_mul_f32 v42, v42, v58
    s_waitcnt lgkmcnt(4)
    v_mfma_f32_16x16x32_bf16 v[104:107], a[0:3], v[16:19], 0
    ds_read_b64_tr_b16 v[32:33], v4 offset:0
    v_mul_f32 v44, v44, v60
    v_mfma_f32_16x16x32_bf16 v[104:107], a[16:19], v[20:23], v[104:107]
    v_mul_f32 v43, v43, v59
    v_mul_f32 v45, v45, v61
    v_mfma_f32_16x16x32_bf16 v[108:111], a[20:23], v[20:23], 0
    ds_read_b64_tr_b16 v[34:35], v4 offset:1024
    v_mul_f32 v46, v46, v62
    v_mfma_f32_16x16x32_bf16 v[108:111], a[4:7], v[16:19], v[108:111]
    s_add_u32 m0, s60, 51200
    v_mul_f32 v47, v47, v63
    v_mfma_f32_16x16x32_bf16 v[112:115], a[8:11], v[16:19], 0
    ds_read_b64_tr_b16 v[36:37], v4 offset:8192
    v_cvt_pk_bf16_f32 v60, v44, v45
    v_mfma_f32_16x16x32_bf16 v[112:115], a[24:27], v[20:23], v[112:115]
    ds_read_b64_tr_b16 v[38:39], v4 offset:9216
    v_and_b32 v250, 0xffff, v2
    v_mfma_f32_16x16x32_bf16 v[116:119], a[28:31], v[20:23], 0
    s_add_u32 s64, s62, 57344
    v_cvt_pk_bf16_f32 v61, v46, v47
    v_mfma_f32_16x16x32_bf16 v[116:119], a[12:15], v[16:19], v[116:119]
    v_add_u32 v250, s77, v250
    s_waitcnt lgkmcnt(4)
    v_mfma_f32_16x16x32_bf16 v[120:123], a[0:3], v[24:27], 0
    ds_read_b64_tr_b16 v[16:17], v5 offset:0
    buffer_load_dwordx4 v7, s[16:19], s64 offen sc1 lds
    v_mfma_f32_16x16x32_bf16 v[120:123], a[16:19], v[28:31], v[120:123]
    ds_read_b64_tr_b16 v[248:249], v250 offset:0
    v_mfma_f32_16x16x32_bf16 v[124:127], a[20:23], v[28:31], 0
    ds_read_b64_tr_b16 v[18:19], v5 offset:1024
    ds_read_b64_tr_b16 v[250:251], v250 offset:1024
    v_mfma_f32_16x16x32_bf16 v[124:127], a[4:7], v[24:27], v[124:127]
    s_add_u32 s65, s62, 56832
    v_mul_f32 v76, v76, v92
    v_mfma_f32_16x16x32_bf16 v[128:131], a[8:11], v[24:27], 0
    ds_read_b64_tr_b16 v[20:21], v5 offset:8192
    v_mul_f32 v77, v77, v93
    v_mfma_f32_16x16x32_bf16 v[128:131], a[24:27], v[28:31], v[128:131]
    ds_read_b64_tr_b16 v[22:23], v5 offset:9216
    buffer_store_dwordx4 v[184:187], v11, s[16:19], s66 offen offset:1024 sc1
    v_mfma_f32_16x16x32_bf16 v[132:135], a[28:31], v[28:31], 0
    buffer_load_dwordx4 v7, s[16:19], s65 offen offset:1024 sc1 lds
    v_mul_f32 v78, v78, v94
    v_mfma_f32_16x16x32_bf16 v[132:135], a[12:15], v[24:27], v[132:135]
    s_waitcnt vmcnt(15)
    s_barrier
    s_waitcnt lgkmcnt(6)
    v_mfma_f32_16x16x32_bf16 v[136:139], v[32:35], a[0:3], 0
    ds_read_b64_tr_b16 v[24:25], v2 offset:2048
    v_mul_f32 v79, v79, v95
    v_mfma_f32_16x16x32_bf16 v[136:139], v[36:39], a[16:19], v[136:139]
    v_cvt_pk_bf16_f32 v56, v40, v41
    v_cvt_pk_bf16_f32 v62, v76, v77
    v_mfma_f32_16x16x32_bf16 v[140:143], v[36:39], a[20:23], 0
    ds_read_b64_tr_b16 v[26:27], v2 offset:3072
    v_cvt_pk_bf16_f32 v63, v78, v79
    v_mfma_f32_16x16x32_bf16 v[140:143], v[32:35], a[4:7], v[140:143]
    v_cvt_pk_bf16_f32 v57, v42, v43
    v_mul_f32 v72, v72, v88
    v_mfma_f32_16x16x32_bf16 v[144:147], v[32:35], a[8:11], 0
    ds_read_b64_tr_b16 v[28:29], v2 offset:10240
    s_waitcnt lgkmcnt(5)
    buffer_store_dwordx4 v[248:251], v11, s[16:19], s75 offen offset:0 sc1
    v_mfma_f32_16x16x32_bf16 v[144:147], v[36:39], a[24:27], v[144:147]
    ds_read_b64_tr_b16 v[30:31], v2 offset:11264
    v_mul_f32 v73, v73, v89
    v_mfma_f32_16x16x32_bf16 v[148:151], v[36:39], a[28:31], 0
    v_mul_f32 v74, v74, v90
    v_mfma_f32_16x16x32_bf16 v[148:151], v[32:35], a[12:15], v[148:151]
    s_waitcnt lgkmcnt(4)
    v_mfma_f32_16x16x32_bf16 v[152:155], a[0:3], v[16:19], 0
    ds_read_b64_tr_b16 v[32:33], v3 offset:2048
    v_mfma_f32_16x16x32_bf16 v[152:155], a[16:19], v[20:23], v[152:155]
    v_mul_f32 v75, v75, v91
    v_mfma_f32_16x16x32_bf16 v[156:159], a[20:23], v[20:23], 0
    ds_read_b64_tr_b16 v[34:35], v3 offset:3072
    v_mfma_f32_16x16x32_bf16 v[156:159], a[4:7], v[16:19], v[156:159]
    v_cvt_pk_bf16_f32 v58, v72, v73
    v_mfma_f32_16x16x32_bf16 v[160:163], a[8:11], v[16:19], 0
    ds_read_b64_tr_b16 v[36:37], v3 offset:10240
    v_mfma_f32_16x16x32_bf16 v[160:163], a[24:27], v[20:23], v[160:163]
    ds_read_b64_tr_b16 v[38:39], v3 offset:11264
    v_mfma_f32_16x16x32_bf16 v[164:167], a[28:31], v[20:23], 0
    v_cvt_pk_bf16_f32 v59, v74, v75
L_wm3:
    s_cbranch_execz L_wm7
    v_mfma_f32_16x16x32_bf16 v[164:167], a[12:15], v[16:19], v[164:167]
    v_and_b32 v254, 0xffff, v3
    s_waitcnt lgkmcnt(4)
    v_mfma_f32_16x16x32_bf16 v[104:107], a[32:35], v[24:27], v[104:107]
    ds_read_b64_tr_b16 v[16:17], v4 offset:2048
    v_add_u32 v254, s77, v254
    v_mfma_f32_16x16x32_bf16 v[104:107], a[48:51], v[28:31], v[104:107]
    ds_read_b64_tr_b16 v[252:253], v254 offset:0
    v_mfma_f32_16x16x32_bf16 v[108:111], a[52:55], v[28:31], v[108:111]
    ds_read_b64_tr_b16 v[18:19], v4 offset:3072
    v_mfma_f32_16x16x32_bf16 v[108:111], a[36:39], v[24:27], v[108:111]
    s_add_u32 m0, s60, 65536
    v_mfma_f32_16x16x32_bf16 v[112:115], a[40:43], v[24:27], v[112:115]
    ds_read_b64_tr_b16 v[20:21], v4 offset:10240
    ds_read_b64_tr_b16 v[254:255], v254 offset:1024
    v_mfma_f32_16x16x32_bf16 v[112:115], a[56:59], v[28:31], v[112:115]
    ds_read_b64_tr_b16 v[22:23], v4 offset:11264
    v_mfma_f32_16x16x32_bf16 v[116:119], a[60:63], v[28:31], v[116:119]
    s_add_u32 s64, s62, 65536
    v_mfma_f32_16x16x32_bf16 v[116:119], a[44:47], v[24:27], v[116:119]
    s_waitcnt lgkmcnt(6)
    v_mfma_f32_16x16x32_bf16 v[120:123], a[32:35], v[32:35], v[120:123]
    ds_read_b64_tr_b16 v[24:25], v5 offset:2048
    buffer_load_dwordx4 v7, s[16:19], s64 offen sc1 lds
    v_mfma_f32_16x16x32_bf16 v[120:123], a[48:51], v[36:39], v[120:123]
    v_mfma_f32_16x16x32_bf16 v[124:127], a[52:55], v[36:39], v[124:127]
    ds_read_b64_tr_b16 v[26:27], v5 offset:3072
    v_mfma_f32_16x16x32_bf16 v[124:127], a[36:39], v[32:35], v[124:127]
    s_add_u32 s65, s62, 65024
    v_mfma_f32_16x16x32_bf16 v[128:131], a[40:43], v[32:35], v[128:131]
    ds_read_b64_tr_b16 v[28:29], v5 offset:10240
    v_mfma_f32_16x16x32_bf16 v[128:131], a[56:59], v[36:39], v[128:131]
    ds_read_b64_tr_b16 v[30:31], v5 offset:11264
    v_mfma_f32_16x16x32_bf16 v[132:135], a[60:63], v[36:39], v[132:135]
    buffer_load_dwordx4 v7, s[16:19], s65 offen offset:1024 sc1 lds
    s_waitcnt lgkmcnt(5)
    buffer_store_dwordx4 v[252:255], v11, s[16:19], s75 offen offset:1024 sc1
    v_mfma_f32_16x16x32_bf16 v[132:135], a[44:47], v[32:35], v[132:135]
    s_waitcnt vmcnt(16)
    s_barrier
    s_waitcnt lgkmcnt(4)
    v_mfma_f32_16x16x32_bf16 v[136:139], v[16:19], a[32:35], v[136:139]
    ds_read_b64_tr_b16 v[32:33], v2 offset:16384
    v_mfma_f32_16x16x32_bf16 v[136:139], v[20:23], a[48:51], v[136:139]
    v_mfma_f32_16x16x32_bf16 v[140:143], v[20:23], a[52:55], v[140:143]
    ds_read_b64_tr_b16 v[34:35], v2 offset:17408
    v_mfma_f32_16x16x32_bf16 v[140:143], v[16:19], a[36:39], v[140:143]
    buffer_store_dwordx4 v[188:191], v11, s[16:19], s67 offen offset:1024 sc1
    v_mfma_f32_16x16x32_bf16 v[144:147], v[16:19], a[40:43], v[144:147]
    ds_read_b64_tr_b16 v[36:37], v2 offset:24576
    v_mfma_f32_16x16x32_bf16 v[144:147], v[20:23], a[56:59], v[144:147]
    ds_read_b64_tr_b16 v[38:39], v2 offset:25600
    v_mfma_f32_16x16x32_bf16 v[148:151], v[20:23], a[60:63], v[148:151]
    v_mfma_f32_16x16x32_bf16 v[148:151], v[16:19], a[44:47], v[148:151]
    s_waitcnt lgkmcnt(4)
    v_mfma_f32_16x16x32_bf16 v[152:155], a[32:35], v[24:27], v[152:155]
    ds_read_b64_tr_b16 v[16:17], v3 offset:16384
    v_mfma_f32_16x16x32_bf16 v[152:155], a[48:51], v[28:31], v[152:155]
    v_mfma_f32_16x16x32_bf16 v[156:159], a[52:55], v[28:31], v[156:159]
    ds_read_b64_tr_b16 v[18:19], v3 offset:17408
    v_and_b32 v250, 0xffff, v4
    v_mfma_f32_16x16x32_bf16 v[156:159], a[36:39], v[24:27], v[156:159]
    v_mfma_f32_16x16x32_bf16 v[160:163], a[40:43], v[24:27], v[160:163]
    ds_read_b64_tr_b16 v[20:21], v3 offset:24576
    v_add_u32 v250, s77, v250
    v_mfma_f32_16x16x32_bf16 v[160:163], a[56:59], v[28:31], v[160:163]
    ds_read_b64_tr_b16 v[22:23], v3 offset:25600
    v_mfma_f32_16x16x32_bf16 v[164:167], a[60:63], v[28:31], v[164:167]
    ds_read_b64_tr_b16 v[248:249], v250 offset:0
    v_mfma_f32_16x16x32_bf16 v[164:167], a[44:47], v[24:27], v[164:167]
    ds_read_b64_tr_b16 v[250:251], v250 offset:1024
    s_waitcnt lgkmcnt(6)
    v_mfma_f32_16x16x32_bf16 v[104:107], a[64:67], v[32:35], v[104:107]
    ds_read_b64_tr_b16 v[24:25], v4 offset:16384
    buffer_store_dwordx4 v[56:59], v11, s[16:19], s70 offen offset:0 sc1
    v_mfma_f32_16x16x32_bf16 v[104:107], a[80:83], v[36:39], v[104:107]
    v_mfma_f32_16x16x32_bf16 v[108:111], a[84:87], v[36:39], v[108:111]
    ds_read_b64_tr_b16 v[26:27], v4 offset:17408
    v_mfma_f32_16x16x32_bf16 v[108:111], a[68:71], v[32:35], v[108:111]
    v_mfma_f32_16x16x32_bf16 v[112:115], a[72:75], v[32:35], v[112:115]
    ds_read_b64_tr_b16 v[28:29], v4 offset:24576
    v_mfma_f32_16x16x32_bf16 v[112:115], a[88:91], v[36:39], v[112:115]
    ds_read_b64_tr_b16 v[30:31], v4 offset:25600
    v_mfma_f32_16x16x32_bf16 v[116:119], a[92:95], v[36:39], v[116:119]
    v_mfma_f32_16x16x32_bf16 v[116:119], a[76:79], v[32:35], v[116:119]
    s_waitcnt lgkmcnt(6)
    v_mfma_f32_16x16x32_bf16 v[120:123], a[64:67], v[16:19], v[120:123]
    ds_read_b64_tr_b16 v[32:33], v5 offset:16384
    v_mfma_f32_16x16x32_bf16 v[120:123], a[80:83], v[20:23], v[120:123]
    s_waitcnt lgkmcnt(5)
    buffer_store_dwordx4 v[248:251], v11, s[16:19], s75 offen offset:2048 sc1
    v_mfma_f32_16x16x32_bf16 v[124:127], a[84:87], v[20:23], v[124:127]
    ds_read_b64_tr_b16 v[34:35], v5 offset:17408
    v_mfma_f32_16x16x32_bf16 v[124:127], a[68:71], v[16:19], v[124:127]
    v_mfma_f32_16x16x32_bf16 v[128:131], a[72:75], v[16:19], v[128:131]
    ds_read_b64_tr_b16 v[36:37], v5 offset:24576
    v_mfma_f32_16x16x32_bf16 v[128:131], a[88:91], v[20:23], v[128:131]
    ds_read_b64_tr_b16 v[38:39], v5 offset:25600
    v_mfma_f32_16x16x32_bf16 v[132:135], a[92:95], v[20:23], v[132:135]
    v_mfma_f32_16x16x32_bf16 v[132:135], a[76:79], v[16:19], v[132:135]
    s_waitcnt vmcnt(17)
    s_barrier
    s_waitcnt lgkmcnt(4)
    v_mfma_f32_16x16x32_bf16 v[136:139], v[24:27], a[64:67], v[136:139]
    ds_read_b64_tr_b16 v[16:17], v2 offset:18432
    v_mfma_f32_16x16x32_bf16 v[136:139], v[28:31], a[80:83], v[136:139]
    v_mfma_f32_16x16x32_bf16 v[140:143], v[28:31], a[84:87], v[140:143]
    ds_read_b64_tr_b16 v[18:19], v2 offset:19456
    v_mfma_f32_16x16x32_bf16 v[140:143], v[24:27], a[68:71], v[140:143]
    v_mfma_f32_16x16x32_bf16 v[144:147], v[24:27], a[72:75], v[144:147]
    ds_read_b64_tr_b16 v[20:21], v2 offset:26624
    v_and_b32 v254, 0xffff, v5
    v_mfma_f32_16x16x32_bf16 v[144:147], v[28:31], a[88:91], v[144:147]
    ds_read_b64_tr_b16 v[22:23], v2 offset:27648
    v_mfma_f32_16x16x32_bf16 v[148:151], v[28:31], a[92:95], v[148:151]
    v_add_u32 v254, s77, v254
    v_mfma_f32_16x16x32_bf16 v[148:151], v[24:27], a[76:79], v[148:151]
    s_waitcnt lgkmcnt(4)
    v_mfma_f32_16x16x32_bf16 v[152:155], a[64:67], v[32:35], v[152:155]
    ds_read_b64_tr_b16 v[24:25], v3 offset:18432
    v_mfma_f32_16x16x32_bf16 v[152:155], a[80:83], v[36:39], v[152:155]
    ds_read_b64_tr_b16 v[252:253], v254 offset:0
    buffer_store_dwordx4 v[192:195], v11, s[16:19], s68 offen offset:1024 sc1
    v_mfma_f32_16x16x32_bf16 v[156:159], a[84:87], v[36:39], v[156:159]
    ds_read_b64_tr_b16 v[26:27], v3 offset:19456
    ds_read_b64_tr_b16 v[254:255], v254 offset:1024
    v_mfma_f32_16x16x32_bf16 v[156:159], a[68:71], v[32:35], v[156:159]
    v_mfma_f32_16x16x32_bf16 v[160:163], a[72:75], v[32:35], v[160:163]
    ds_read_b64_tr_b16 v[28:29], v3 offset:26624
    v_mfma_f32_16x16x32_bf16 v[160:163], a[88:91], v[36:39], v[160:163]
    ds_read_b64_tr_b16 v[30:31], v3 offset:27648
    v_mfma_f32_16x16x32_bf16 v[164:167], a[92:95], v[36:39], v[164:167]
    v_mfma_f32_16x16x32_bf16 v[164:167], a[76:79], v[32:35], v[164:167]
    s_and_b32 s85, s58, 1
    s_waitcnt lgkmcnt(6)
    v_mfma_f32_16x16x32_bf16 v[104:107], a[96:99], v[16:19], v[104:107]
    ds_read_b64_tr_b16 v[32:33], v4 offset:18432
    v_mfma_f32_16x16x32_bf16 v[104:107], a[112:115], v[20:23], v[104:107]
    v_mfma_f32_16x16x32_bf16 v[108:111], a[116:119], v[20:23], v[108:111]
    ds_read_b64_tr_b16 v[34:35], v4 offset:19456
    v_mfma_f32_16x16x32_bf16 v[108:111], a[100:103], v[16:19], v[108:111]
    s_bfe_u32 s84, s55, 131073
    v_mfma_f32_16x16x32_bf16 v[112:115], a[104:107], v[16:19], v[112:115]
    ds_read_b64_tr_b16 v[36:37], v4 offset:26624
    s_waitcnt lgkmcnt(5)
    buffer_store_dwordx4 v[252:255], v11, s[16:19], s75 offen offset:3072 sc1
    v_mfma_f32_16x16x32_bf16 v[112:115], a[120:123], v[20:23], v[112:115]
    ds_read_b64_tr_b16 v[38:39], v4 offset:27648
    v_mfma_f32_16x16x32_bf16 v[116:119], a[124:127], v[20:23], v[116:119]
    s_lshl_b32 s31, s56, 4
    v_mfma_f32_16x16x32_bf16 v[116:119], a[108:111], v[16:19], v[116:119]
    s_waitcnt lgkmcnt(4)
    v_mfma_f32_16x16x32_bf16 v[120:123], a[96:99], v[24:27], v[120:123]
    ds_read_b64_tr_b16 v[16:17], v5 offset:18432
    v_mfma_f32_16x16x32_bf16 v[120:123], a[112:115], v[28:31], v[120:123]
    v_mfma_f32_16x16x32_bf16 v[124:127], a[116:119], v[28:31], v[124:127]
    ds_read_b64_tr_b16 v[18:19], v5 offset:19456
    s_bfe_u32 s81, s55, 65536
    v_mfma_f32_16x16x32_bf16 v[124:127], a[100:103], v[24:27], v[124:127]
    v_mfma_f32_16x16x32_bf16 v[128:131], a[104:107], v[24:27], v[128:131]
    ds_read_b64_tr_b16 v[20:21], v5 offset:26624
    v_mfma_f32_16x16x32_bf16 v[128:131], a[120:123], v[28:31], v[128:131]
    ds_read_b64_tr_b16 v[22:23], v5 offset:27648
    v_mfma_f32_16x16x32_bf16 v[132:135], a[124:127], v[28:31], v[132:135]
    s_lshl_b32 s81, s81, 3
    v_mfma_f32_16x16x32_bf16 v[132:135], a[108:111], v[24:27], v[132:135]
    s_waitcnt vmcnt(17)
    s_barrier
    s_waitcnt lgkmcnt(4)
    v_mfma_f32_16x16x32_bf16 v[136:139], v[32:35], a[96:99], v[136:139]
    ds_read_b64_tr_b16 v[24:25], v2 offset:32768
    v_mfma_f32_16x16x32_bf16 v[136:139], v[36:39], a[112:115], v[136:139]
    s_add_u32 s31, s31, s81
    v_mfma_f32_16x16x32_bf16 v[140:143], v[36:39], a[116:119], v[140:143]
    ds_read_b64_tr_b16 v[26:27], v2 offset:33792
    v_and_b32 v250, 0xffff, v2
    v_mfma_f32_16x16x32_bf16 v[140:143], v[32:35], a[100:103], v[140:143]
    v_mfma_f32_16x16x32_bf16 v[144:147], v[32:35], a[104:107], v[144:147]
    ds_read_b64_tr_b16 v[28:29], v2 offset:40960
    v_add_u32 v250, s77, v250
    v_mfma_f32_16x16x32_bf16 v[144:147], v[36:39], a[120:123], v[144:147]
    ds_read_b64_tr_b16 v[30:31], v2 offset:41984
    s_lshl_b32 s81, s54, 1
    v_mfma_f32_16x16x32_bf16 v[148:151], v[36:39], a[124:127], v[148:151]
    ds_read_b64_tr_b16 v[248:249], v250 offset:16384
    v_mfma_f32_16x16x32_bf16 v[148:151], v[32:35], a[108:111], v[148:151]
    ds_read_b64_tr_b16 v[250:251], v250 offset:17408
    s_waitcnt lgkmcnt(6)
    v_mfma_f32_16x16x32_bf16 v[152:155], a[96:99], v[16:19], v[152:155]
    ds_read_b64_tr_b16 v[32:33], v3 offset:32768
    v_mfma_f32_16x16x32_bf16 v[152:155], a[112:115], v[20:23], v[152:155]
    s_add_u32 s31, s31, s81
    v_mfma_f32_16x16x32_bf16 v[156:159], a[116:119], v[20:23], v[156:159]
    ds_read_b64_tr_b16 v[34:35], v3 offset:33792
    v_mfma_f32_16x16x32_bf16 v[156:159], a[100:103], v[16:19], v[156:159]
    v_mfma_f32_16x16x32_bf16 v[160:163], a[104:107], v[16:19], v[160:163]
    ds_read_b64_tr_b16 v[36:37], v3 offset:40960
    s_lshr_b32 s81, s58, 1
    v_mfma_f32_16x16x32_bf16 v[160:163], a[120:123], v[20:23], v[160:163]
    ds_read_b64_tr_b16 v[38:39], v3 offset:41984
    v_mfma_f32_16x16x32_bf16 v[164:167], a[124:127], v[20:23], v[164:167]
    v_mfma_f32_16x16x32_bf16 v[164:167], a[108:111], v[16:19], v[164:167]
    buffer_store_dwordx4 v[196:199], v11, s[16:19], s69 offen offset:1024 sc1
    s_waitcnt lgkmcnt(6)
    v_mfma_f32_16x16x32_bf16 v[104:107], a[128:131], v[24:27], v[104:107]
    ds_read_b64_tr_b16 v[16:17], v4 offset:32768
    s_add_u32 s82, s31, s81
    v_mfma_f32_16x16x32_bf16 v[104:107], a[144:147], v[28:31], v[104:107]
    s_waitcnt lgkmcnt(5)
    buffer_store_dwordx4 v[248:251], v11, s[16:19], s76 offen offset:0 sc1
    v_mfma_f32_16x16x32_bf16 v[108:111], a[148:151], v[28:31], v[108:111]
    ds_read_b64_tr_b16 v[18:19], v4 offset:33792
    v_mfma_f32_16x16x32_bf16 v[108:111], a[132:135], v[24:27], v[108:111]
    s_add_u32 m0, s60, 81920
    v_mfma_f32_16x16x32_bf16 v[112:115], a[136:139], v[24:27], v[112:115]
    ds_read_b64_tr_b16 v[20:21], v4 offset:40960
    s_xor_b32 s83, s82, 1
    v_mfma_f32_16x16x32_bf16 v[112:115], a[152:155], v[28:31], v[112:115]
    ds_read_b64_tr_b16 v[22:23], v4 offset:41984
    v_mfma_f32_16x16x32_bf16 v[116:119], a[156:159], v[28:31], v[116:119]
    s_add_u32 s64, s61, 4096
    v_mfma_f32_16x16x32_bf16 v[116:119], a[140:143], v[24:27], v[116:119]
    s_lshl_b32 s31, s58, 14
    s_waitcnt lgkmcnt(4)
    v_mfma_f32_16x16x32_bf16 v[120:123], a[128:131], v[32:35], v[120:123]
    ds_read_b64_tr_b16 v[24:25], v5 offset:32768
    buffer_store_dwordx4 v[60:63], v11, s[16:19], s71 offen offset:0 sc1
    v_mfma_f32_16x16x32_bf16 v[120:123], a[144:147], v[36:39], v[120:123]
    v_mfma_f32_16x16x32_bf16 v[124:127], a[148:151], v[36:39], v[124:127]
    ds_read_b64_tr_b16 v[26:27], v5 offset:33792
    buffer_load_dwordx4 v6, s[8:11], s64 offen  lds
    v_mfma_f32_16x16x32_bf16 v[124:127], a[132:135], v[32:35], v[124:127]
    s_mul_i32 s20, s82, 147456
    v_mfma_f32_16x16x32_bf16 v[128:131], a[136:139], v[32:35], v[128:131]
    ds_read_b64_tr_b16 v[28:29], v5 offset:40960
    v_mfma_f32_16x16x32_bf16 v[128:131], a[152:155], v[36:39], v[128:131]
    ds_read_b64_tr_b16 v[30:31], v5 offset:41984
    v_and_b32 v254, 0xffff, v3
    v_mfma_f32_16x16x32_bf16 v[132:135], a[156:159], v[36:39], v[132:135]
    s_add_u32 s65, s61, 39936
    v_add_u32 v254, s77, v254
    v_mfma_f32_16x16x32_bf16 v[132:135], a[140:143], v[32:35], v[132:135]
    s_waitcnt vmcnt(18)
    s_barrier
    s_waitcnt lgkmcnt(4)
    v_mfma_f32_16x16x32_bf16 v[136:139], v[16:19], a[128:131], v[136:139]
    ds_read_b64_tr_b16 v[32:33], v2 offset:34816
    s_add_u32 s20, s20, s31
    v_mfma_f32_16x16x32_bf16 v[136:139], v[20:23], a[144:147], v[136:139]
    buffer_load_dwordx4 v6, s[12:15], s64 offen offset:2048  lds
    ds_read_b64_tr_b16 v[252:253], v254 offset:16384
    v_mfma_f32_16x16x32_bf16 v[140:143], v[20:23], a[148:151], v[140:143]
    ds_read_b64_tr_b16 v[34:35], v2 offset:35840
    s_mul_i32 s21, s83, 147456
    v_mfma_f32_16x16x32_bf16 v[140:143], v[16:19], a[132:135], v[140:143]
    ds_read_b64_tr_b16 v[254:255], v254 offset:17408
    v_mfma_f32_16x16x32_bf16 v[144:147], v[16:19], a[136:139], v[144:147]
    ds_read_b64_tr_b16 v[36:37], v2 offset:43008
    v_mfma_f32_16x16x32_bf16 v[144:147], v[20:23], a[152:155], v[144:147]
    ds_read_b64_tr_b16 v[38:39], v2 offset:44032
    buffer_load_dwordx4 v6, s[8:11], s65 offen offset:1024  lds
    v_mfma_f32_16x16x32_bf16 v[148:151], v[20:23], a[156:159], v[148:151]
    s_add_u32 s21, s21, s31
    v_mfma_f32_16x16x32_bf16 v[148:151], v[16:19], a[140:143], v[148:151]
    s_waitcnt lgkmcnt(6)
    v_mfma_f32_16x16x32_bf16 v[152:155], a[128:131], v[24:27], v[152:155]
    ds_read_b64_tr_b16 v[16:17], v3 offset:34816
    v_mfma_f32_16x16x32_bf16 v[152:155], a[144:147], v[28:31], v[152:155]
    buffer_load_dwordx4 v6, s[12:15], s65 offen offset:3072  lds
    s_mul_i32 s26, s54, 9216
    v_mfma_f32_16x16x32_bf16 v[156:159], a[148:151], v[28:31], v[156:159]
    ds_read_b64_tr_b16 v[18:19], v3 offset:35840
    v_mfma_f32_16x16x32_bf16 v[156:159], a[132:135], v[24:27], v[156:159]
    v_mfma_f32_16x16x32_bf16 v[160:163], a[136:139], v[24:27], v[160:163]
    ds_read_b64_tr_b16 v[20:21], v3 offset:43008
    v_mfma_f32_16x16x32_bf16 v[160:163], a[152:155], v[28:31], v[160:163]
    ds_read_b64_tr_b16 v[22:23], v3 offset:44032
    s_waitcnt lgkmcnt(6)
    buffer_store_dwordx4 v[252:255], v11, s[16:19], s76 offen offset:1024 sc1
    v_mfma_f32_16x16x32_bf16 v[164:167], a[156:159], v[28:31], v[164:167]
    s_mul_i32 s23, s85, 4294965248
    v_mfma_f32_16x16x32_bf16 v[164:167], a[140:143], v[24:27], v[164:167]
    s_waitcnt lgkmcnt(4)
    v_mfma_f32_16x16x32_bf16 v[104:107], a[160:163], v[32:35], v[104:107]
    ds_read_b64_tr_b16 v[24:25], v4 offset:34816
    v_mfma_f32_16x16x32_bf16 v[104:107], a[176:179], v[36:39], v[104:107]
    s_add_u32 s24, s23, 4096
    v_mfma_f32_16x16x32_bf16 v[108:111], a[180:183], v[36:39], v[108:111]
    ds_read_b64_tr_b16 v[26:27], v4 offset:35840
    v_mfma_f32_16x16x32_bf16 v[108:111], a[164:167], v[32:35], v[108:111]
    v_mfma_f32_16x16x32_bf16 v[112:115], a[168:171], v[32:35], v[112:115]
    ds_read_b64_tr_b16 v[28:29], v4 offset:43008
    s_mul_i32 s27, s58, 4294524928
    v_mfma_f32_16x16x32_bf16 v[112:115], a[184:187], v[36:39], v[112:115]
    ds_read_b64_tr_b16 v[30:31], v4 offset:44032
    v_mfma_f32_16x16x32_bf16 v[116:119], a[188:191], v[36:39], v[116:119]
    v_mfma_f32_16x16x32_bf16 v[116:119], a[172:175], v[32:35], v[116:119]
    s_waitcnt lgkmcnt(4)
    v_mfma_f32_16x16x32_bf16 v[120:123], a[160:163], v[16:19], v[120:123]
    ds_read_b64_tr_b16 v[32:33], v5 offset:34816
    v_and_b32 v250, 0xffff, v4
    v_mfma_f32_16x16x32_bf16 v[120:123], a[176:179], v[20:23], v[120:123]
    s_add_u32 s27, s27, 4276224
    v_mfma_f32_16x16x32_bf16 v[124:127], a[180:183], v[20:23], v[124:127]
    ds_read_b64_tr_b16 v[34:35], v5 offset:35840
    v_add_u32 v250, s77, v250
    v_mfma_f32_16x16x32_bf16 v[124:127], a[164:167], v[16:19], v[124:127]
    ds_read_b64_tr_b16 v[248:249], v250 offset:16384
    v_mfma_f32_16x16x32_bf16 v[128:131], a[168:171], v[16:19], v[128:131]
    ds_read_b64_tr_b16 v[36:37], v5 offset:43008
    s_lshl_b32 s22, s58, 4
    v_mfma_f32_16x16x32_bf16 v[128:131], a[184:187], v[20:23], v[128:131]
    ds_read_b64_tr_b16 v[38:39], v5 offset:44032
    v_mfma_f32_16x16x32_bf16 v[132:135], a[188:191], v[20:23], v[132:135]
    ds_read_b64_tr_b16 v[250:251], v250 offset:17408
    v_mfma_f32_16x16x32_bf16 v[132:135], a[172:175], v[16:19], v[132:135]
    s_waitcnt vmcnt(20)
    s_barrier
    s_waitcnt lgkmcnt(6)
    v_mfma_f32_16x16x32_bf16 v[136:139], v[24:27], a[160:163], v[136:139]
    ds_read_b64_tr_b16 v[16:17], v2 offset:49152
    s_add_u32 s22, s22, s54
    v_mfma_f32_16x16x32_bf16 v[136:139], v[28:31], a[176:179], v[136:139]
    v_mfma_f32_16x16x32_bf16 v[140:143], v[28:31], a[180:183], v[140:143]
    ds_read_b64_tr_b16 v[18:19], v2 offset:50176
    v_mfma_f32_16x16x32_bf16 v[140:143], v[24:27], a[164:167], v[140:143]
    s_add_u32 m0, s60, 98304
    s_mul_i32 s22, s22, 36
    v_mfma_f32_16x16x32_bf16 v[144:147], v[24:27], a[168:171], v[144:147]
    ds_read_b64_tr_b16 v[20:21], v2 offset:57344
    v_mfma_f32_16x16x32_bf16 v[144:147], v[28:31], a[184:187], v[144:147]
    ds_read_b64_tr_b16 v[22:23], v2 offset:58368
    v_mfma_f32_16x16x32_bf16 v[148:151], v[28:31], a[188:191], v[148:151]
    s_add_u32 s64, s61, 593920
    v_mfma_f32_16x16x32_bf16 v[148:151], v[24:27], a[172:175], v[148:151]
    s_mul_i32 s31, s84, 9
    s_waitcnt lgkmcnt(5)
    v_mfma_f32_16x16x32_bf16 v[152:155], a[160:163], v[32:35], v[152:155]
    ds_read_b64_tr_b16 v[24:25], v3 offset:49152
    s_waitcnt lgkmcnt(5)
    buffer_store_dwordx4 v[248:251], v11, s[16:19], s76 offen offset:2048 sc1
    v_mfma_f32_16x16x32_bf16 v[152:155], a[176:179], v[36:39], v[152:155]
    v_mfma_f32_16x16x32_bf16 v[156:159], a[180:183], v[36:39], v[156:159]
    ds_read_b64_tr_b16 v[26:27], v3 offset:50176
    buffer_load_dwordx4 v6, s[8:11], s64 offen  lds
    v_mfma_f32_16x16x32_bf16 v[156:159], a[164:167], v[32:35], v[156:159]
    s_lshl_b32 s81, s85, 3
    v_mfma_f32_16x16x32_bf16 v[160:163], a[168:171], v[32:35], v[160:163]
    ds_read_b64_tr_b16 v[28:29], v3 offset:57344
    v_mfma_f32_16x16x32_bf16 v[160:163], a[184:187], v[36:39], v[160:163]
    ds_read_b64_tr_b16 v[30:31], v3 offset:58368
    v_mfma_f32_16x16x32_bf16 v[164:167], a[188:191], v[36:39], v[164:167]
    s_add_u32 s65, s61, 629760
    s_add_u32 s31, s31, s81
    v_mfma_f32_16x16x32_bf16 v[164:167], a[172:175], v[32:35], v[164:167]
    s_waitcnt lgkmcnt(4)
    v_mfma_f32_16x16x32_bf16 v[104:107], a[192:195], v[16:19], v[104:107]
    ds_read_b64_tr_b16 v[32:33], v4 offset:49152
    v_mfma_f32_16x16x32_bf16 v[104:107], a[208:211], v[20:23], v[104:107]
    buffer_load_dwordx4 v6, s[12:15], s64 offen offset:2048  lds
    v_mfma_f32_16x16x32_bf16 v[108:111], a[212:215], v[20:23], v[108:111]
    ds_read_b64_tr_b16 v[34:35], v4 offset:50176
    s_add_u32 s22, s22, s31
    v_mfma_f32_16x16x32_bf16 v[108:111], a[196:199], v[16:19], v[108:111]
    v_and_b32 v254, 0xffff, v5
    v_mfma_f32_16x16x32_bf16 v[112:115], a[200:203], v[16:19], v[112:115]
    ds_read_b64_tr_b16 v[36:37], v4 offset:57344
    v_add_u32 v254, s77, v254
    v_mfma_f32_16x16x32_bf16 v[112:115], a[216:219], v[20:23], v[112:115]
    ds_read_b64_tr_b16 v[38:39], v4 offset:58368
    buffer_load_dwordx4 v6, s[8:11], s65 offen offset:1024  lds
    v_mfma_f32_16x16x32_bf16 v[116:119], a[220:223], v[20:23], v[116:119]
    ds_read_b64_tr_b16 v[252:253], v254 offset:16384
    v_mfma_f32_16x16x32_bf16 v[116:119], a[204:207], v[16:19], v[116:119]
    s_lshl_b32 s22, s22, 10
    s_waitcnt lgkmcnt(5)
    v_mfma_f32_16x16x32_bf16 v[120:123], a[192:195], v[24:27], v[120:123]
    ds_read_b64_tr_b16 v[16:17], v5 offset:49152
    ds_read_b64_tr_b16 v[254:255], v254 offset:17408
    v_mfma_f32_16x16x32_bf16 v[120:123], a[208:211], v[28:31], v[120:123]
    buffer_load_dwordx4 v6, s[12:15], s65 offen offset:3072  lds
    s_add_u32 s30, s58, 160
    v_mfma_f32_16x16x32_bf16 v[124:127], a[212:215], v[28:31], v[124:127]
    ds_read_b64_tr_b16 v[18:19], v5 offset:50176
    v_mfma_f32_16x16x32_bf16 v[124:127], a[196:199], v[24:27], v[124:127]
    v_mfma_f32_16x16x32_bf16 v[128:131], a[200:203], v[24:27], v[128:131]
    ds_read_b64_tr_b16 v[20:21], v5 offset:57344
    v_mfma_f32_16x16x32_bf16 v[128:131], a[216:219], v[28:31], v[128:131]
    ds_read_b64_tr_b16 v[22:23], v5 offset:58368
    s_mul_i32 s30, s30, 36
    v_mfma_f32_16x16x32_bf16 v[132:135], a[220:223], v[28:31], v[132:135]
    v_mfma_f32_16x16x32_bf16 v[132:135], a[204:207], v[24:27], v[132:135]
    s_waitcnt vmcnt(22)
    s_barrier
    s_waitcnt lgkmcnt(6)
    v_mfma_f32_16x16x32_bf16 v[136:139], v[32:35], a[192:195], v[136:139]
    ds_read_b64_tr_b16 v[24:25], v2 offset:51200
    s_add_u32 s30, s30, s31
    v_mfma_f32_16x16x32_bf16 v[136:139], v[36:39], a[208:211], v[136:139]
    v_mfma_f32_16x16x32_bf16 v[140:143], v[36:39], a[212:215], v[140:143]
    ds_read_b64_tr_b16 v[26:27], v2 offset:52224
    s_waitcnt lgkmcnt(5)
    buffer_store_dwordx4 v[252:255], v11, s[16:19], s76 offen offset:3072 sc1
    v_mfma_f32_16x16x32_bf16 v[140:143], v[32:35], a[196:199], v[140:143]
    v_mfma_f32_16x16x32_bf16 v[144:147], v[32:35], a[200:203], v[144:147]
    ds_read_b64_tr_b16 v[28:29], v2 offset:59392
    s_lshl_b32 s30, s30, 10
    v_mfma_f32_16x16x32_bf16 v[144:147], v[36:39], a[216:219], v[144:147]
    ds_read_b64_tr_b16 v[30:31], v2 offset:60416
    v_mfma_f32_16x16x32_bf16 v[148:151], v[36:39], a[220:223], v[148:151]
    v_mfma_f32_16x16x32_bf16 v[148:151], v[32:35], a[204:207], v[148:151]
    s_add_u32 s81, s23, 1024
    s_waitcnt lgkmcnt(4)
    v_mfma_f32_16x16x32_bf16 v[152:155], a[192:195], v[16:19], v[152:155]
    ds_read_b64_tr_b16 v[32:33], v3 offset:51200
    v_mfma_f32_16x16x32_bf16 v[152:155], a[208:211], v[20:23], v[152:155]
    v_mfma_f32_16x16x32_bf16 v[156:159], a[212:215], v[20:23], v[156:159]
    ds_read_b64_tr_b16 v[34:35], v3 offset:52224
    v_mfma_f32_16x16x32_bf16 v[156:159], a[196:199], v[16:19], v[156:159]
    s_mul_i32 s81, s81, s54
    v_mfma_f32_16x16x32_bf16 v[160:163], a[200:203], v[16:19], v[160:163]
    ds_read_b64_tr_b16 v[36:37], v3 offset:59392
    v_mfma_f32_16x16x32_bf16 v[160:163], a[216:219], v[20:23], v[160:163]
    ds_read_b64_tr_b16 v[38:39], v3 offset:60416
    v_mfma_f32_16x16x32_bf16 v[164:167], a[220:223], v[20:23], v[164:167]
    v_mfma_f32_16x16x32_bf16 v[164:167], a[204:207], v[16:19], v[164:167]
    s_mul_i32 s81, s81, 3
    s_waitcnt lgkmcnt(4)
    v_mfma_f32_16x16x32_bf16 v[104:107], a[224:227], v[24:27], v[104:107]
    ds_read_b64_tr_b16 v[16:17], v4 offset:51200
    v_mfma_f32_16x16x32_bf16 v[104:107], a[240:243], v[28:31], v[104:107]
    v_mfma_f32_16x16x32_bf16 v[108:111], a[244:247], v[28:31], v[108:111]
    ds_read_b64_tr_b16 v[18:19], v4 offset:52224
    s_add_u32 s30, s30, s81
    v_mfma_f32_16x16x32_bf16 v[108:111], a[228:231], v[24:27], v[108:111]
    s_add_u32 m0, s60, 114688
    v_mfma_f32_16x16x32_bf16 v[112:115], a[232:235], v[24:27], v[112:115]
    ds_read_b64_tr_b16 v[20:21], v4 offset:59392
    v_mfma_f32_16x16x32_bf16 v[112:115], a[248:251], v[28:31], v[112:115]
    ds_read_b64_tr_b16 v[22:23], v4 offset:60416
    v_mfma_f32_16x16x32_bf16 v[116:119], a[252:255], v[28:31], v[116:119]
    s_add_u32 s64, s61, 1183744
    s_mul_i32 s28, s58, 4294955008
    v_mfma_f32_16x16x32_bf16 v[116:119], a[236:239], v[24:27], v[116:119]
    s_waitcnt lgkmcnt(4)
    v_mfma_f32_16x16x32_bf16 v[120:123], a[224:227], v[32:35], v[120:123]
    ds_read_b64_tr_b16 v[24:25], v5 offset:51200
    s_add_u32 s28, s28, 116736
    v_mfma_f32_16x16x32_bf16 v[120:123], a[240:243], v[36:39], v[120:123]
    s_cmp_ge_u32 s58, 2
    s_cselect_b32 s30, 1073741824, s30
    v_mfma_f32_16x16x32_bf16 v[124:127], a[244:247], v[36:39], v[124:127]
    ds_read_b64_tr_b16 v[26:27], v5 offset:52224
    buffer_load_dwordx4 v6, s[8:11], s64 offen  lds
    v_mfma_f32_16x16x32_bf16 v[124:127], a[228:231], v[32:35], v[124:127]
    s_add_u32 s4, s52, 22020096
    s_addc_u32 s5, s53, 0
    v_mfma_f32_16x16x32_bf16 v[128:131], a[232:235], v[32:35], v[128:131]
    ds_read_b64_tr_b16 v[28:29], v5 offset:59392
    v_mfma_f32_16x16x32_bf16 v[128:131], a[248:251], v[36:39], v[128:131]
    ds_read_b64_tr_b16 v[30:31], v5 offset:60416
    v_mfma_f32_16x16x32_bf16 v[132:135], a[252:255], v[36:39], v[132:135]
    s_add_u32 s65, s61, 1219584
    v_mfma_f32_16x16x32_bf16 v[132:135], a[236:239], v[32:35], v[132:135]
    s_waitcnt vmcnt(21)
    s_barrier
    s_waitcnt lgkmcnt(4)
    v_mfma_f32_16x16x32_bf16 v[136:139], v[16:19], a[224:227], v[136:139]
    v_xor_b32 v2, 65536, v2
    v_mfma_f32_16x16x32_bf16 v[136:139], v[20:23], a[240:243], v[136:139]
    v_xor_b32 v3, 65536, v3
    buffer_load_dwordx4 v6, s[12:15], s64 offen offset:2048  lds
    v_mfma_f32_16x16x32_bf16 v[140:143], v[20:23], a[244:247], v[140:143]
    v_xor_b32 v4, 65536, v4
    v_mfma_f32_16x16x32_bf16 v[140:143], v[16:19], a[228:231], v[140:143]
    v_xor_b32 v5, 65536, v5
    v_mfma_f32_16x16x32_bf16 v[144:147], v[16:19], a[232:235], v[144:147]
    ds_read_b64_tr_b16 v[32:33], v2 offset:0
    ds_read_b64_tr_b16 v[34:35], v2 offset:1024
    v_mfma_f32_16x16x32_bf16 v[144:147], v[20:23], a[248:251], v[144:147]
    ds_read_b64_tr_b16 v[36:37], v2 offset:8192
    buffer_load_dwordx4 v6, s[8:11], s65 offen offset:1024  lds
    v_mfma_f32_16x16x32_bf16 v[148:151], v[20:23], a[252:255], v[148:151]
    ds_read_b64_tr_b16 v[38:39], v2 offset:9216
    s_mov_b32 s6, 5971968
    v_mfma_f32_16x16x32_bf16 v[148:151], v[16:19], a[236:239], v[148:151]
    s_waitcnt lgkmcnt(4)
    v_mfma_f32_16x16x32_bf16 v[152:155], a[224:227], v[24:27], v[152:155]
    ds_read_b64_tr_b16 v[16:17], v3 offset:0
    s_mov_b32 s7, 0x00020000
    v_mfma_f32_16x16x32_bf16 v[152:155], a[240:243], v[28:31], v[152:155]
    buffer_load_dwordx4 v6, s[12:15], s65 offen offset:3072  lds
    v_mfma_f32_16x16x32_bf16 v[156:159], a[244:247], v[28:31], v[156:159]
    ds_read_b64_tr_b16 v[18:19], v3 offset:1024
    v_mfma_f32_16x16x32_bf16 v[156:159], a[228:231], v[24:27], v[156:159]
    v_mfma_f32_16x16x32_bf16 v[160:163], a[232:235], v[24:27], v[160:163]
    ds_read_b64_tr_b16 v[20:21], v3 offset:8192
    v_mfma_f32_16x16x32_bf16 v[160:163], a[248:251], v[28:31], v[160:163]
    ds_read_b64_tr_b16 v[22:23], v3 offset:9216
    v_mfma_f32_16x16x32_bf16 v[164:167], a[252:255], v[28:31], v[164:167]
    v_mfma_f32_16x16x32_bf16 v[164:167], a[236:239], v[24:27], v[164:167]
    s_waitcnt lgkmcnt(4)
    v_mfma_f32_16x16x32_bf16 v[104:107], v[200:203], v[32:35], v[104:107]
    ds_read_b64_tr_b16 v[24:25], v4 offset:0
    v_mfma_f32_16x16x32_bf16 v[104:107], v[216:219], v[36:39], v[104:107]
    v_mfma_f32_16x16x32_bf16 v[108:111], v[220:223], v[36:39], v[108:111]
    ds_read_b64_tr_b16 v[26:27], v4 offset:1024
    v_mfma_f32_16x16x32_bf16 v[108:111], v[204:207], v[32:35], v[108:111]
    v_mfma_f32_16x16x32_bf16 v[112:115], v[208:211], v[32:35], v[112:115]
    ds_read_b64_tr_b16 v[28:29], v4 offset:8192
    v_mfma_f32_16x16x32_bf16 v[112:115], v[224:227], v[36:39], v[112:115]
    ds_read_b64_tr_b16 v[30:31], v4 offset:9216
    s_nop 0
    v_cvt_pk_bf16_f32 v168, v104, v105
    v_mfma_f32_16x16x32_bf16 v[116:119], v[228:231], v[36:39], v[116:119]
    v_cvt_pk_bf16_f32 v169, v106, v107
    v_mfma_f32_16x16x32_bf16 v[116:119], v[212:215], v[32:35], v[116:119]
    v_cvt_pk_bf16_f32 v170, v108, v109
    s_waitcnt lgkmcnt(4)
    v_mfma_f32_16x16x32_bf16 v[120:123], v[200:203], v[16:19], v[120:123]
    ds_read_b64_tr_b16 v[32:33], v5 offset:0
    v_mfma_f32_16x16x32_bf16 v[120:123], v[216:219], v[20:23], v[120:123]
    v_cvt_pk_bf16_f32 v171, v110, v111
    v_cvt_pk_bf16_f32 v172, v112, v113
    v_mfma_f32_16x16x32_bf16 v[124:127], v[220:223], v[20:23], v[124:127]
    ds_read_b64_tr_b16 v[34:35], v5 offset:1024
    v_mfma_f32_16x16x32_bf16 v[124:127], v[204:207], v[16:19], v[124:127]
    v_cvt_pk_bf16_f32 v173, v114, v115
    v_cvt_pk_bf16_f32 v174, v116, v117
    v_mfma_f32_16x16x32_bf16 v[128:131], v[208:211], v[16:19], v[128:131]
    ds_read_b64_tr_b16 v[36:37], v5 offset:8192
    v_mfma_f32_16x16x32_bf16 v[128:131], v[224:227], v[20:23], v[128:131]
    ds_read_b64_tr_b16 v[38:39], v5 offset:9216
    v_cvt_pk_bf16_f32 v175, v118, v119
    v_mfma_f32_16x16x32_bf16 v[132:135], v[228:231], v[20:23], v[132:135]
    v_cvt_pk_bf16_f32 v176, v120, v121
    v_cvt_pk_bf16_f32 v177, v122, v123
    v_mfma_f32_16x16x32_bf16 v[132:135], v[212:215], v[16:19], v[132:135]
    s_waitcnt vmcnt(11)
    s_barrier
    s_waitcnt lgkmcnt(4)
    v_mfma_f32_16x16x32_bf16 v[136:139], v[24:27], v[200:203], v[136:139]
    ds_read_b64_tr_b16 v[16:17], v2 offset:16384
    v_cvt_pk_bf16_f32 v178, v124, v125
    v_mfma_f32_16x16x32_bf16 v[136:139], v[28:31], v[216:219], v[136:139]
    v_cvt_pk_bf16_f32 v179, v126, v127
    v_cvt_pk_bf16_f32 v180, v128, v129
    v_mfma_f32_16x16x32_bf16 v[140:143], v[28:31], v[220:223], v[140:143]
    ds_read_b64_tr_b16 v[18:19], v2 offset:17408
    v_mfma_f32_16x16x32_bf16 v[140:143], v[24:27], v[204:207], v[140:143]
    v_cvt_pk_bf16_f32 v181, v130, v131
    v_cvt_pk_bf16_f32 v182, v132, v133
    v_mfma_f32_16x16x32_bf16 v[144:147], v[24:27], v[208:211], v[144:147]
    ds_read_b64_tr_b16 v[20:21], v2 offset:24576
    v_mfma_f32_16x16x32_bf16 v[144:147], v[28:31], v[224:227], v[144:147]
    ds_read_b64_tr_b16 v[22:23], v2 offset:25600
    v_cvt_pk_bf16_f32 v183, v134, v135
L_wm4:
    s_cbranch_execz L_wm8
    v_mfma_f32_16x16x32_bf16 v[148:151], v[28:31], v[228:231], v[148:151]
    v_cvt_pk_bf16_f32 v232, v136, v137
    v_mfma_f32_16x16x32_bf16 v[148:151], v[24:27], v[212:215], v[148:151]
    v_cvt_pk_bf16_f32 v233, v138, v139
    s_waitcnt lgkmcnt(4)
    v_mfma_f32_16x16x32_bf16 v[152:155], v[200:203], v[32:35], v[152:155]
    ds_read_b64_tr_b16 v[24:25], v2 offset:18432
    v_cvt_pk_bf16_f32 v236, v140, v141
    v_mfma_f32_16x16x32_bf16 v[152:155], v[216:219], v[36:39], v[152:155]
    v_cvt_pk_bf16_f32 v237, v142, v143
    v_cvt_pk_bf16_f32 v240, v144, v145
    v_mfma_f32_16x16x32_bf16 v[156:159], v[220:223], v[36:39], v[156:159]
    ds_read_b64_tr_b16 v[26:27], v2 offset:19456
    v_mfma_f32_16x16x32_bf16 v[156:159], v[204:207], v[32:35], v[156:159]
    v_cvt_pk_bf16_f32 v241, v146, v147
    v_cvt_pk_bf16_f32 v244, v148, v149
    v_mfma_f32_16x16x32_bf16 v[160:163], v[208:211], v[32:35], v[160:163]
    ds_read_b64_tr_b16 v[28:29], v2 offset:26624
    v_mfma_f32_16x16x32_bf16 v[160:163], v[224:227], v[36:39], v[160:163]
    ds_read_b64_tr_b16 v[30:31], v2 offset:27648
    v_cvt_pk_bf16_f32 v245, v150, v151
    v_mfma_f32_16x16x32_bf16 v[164:167], v[228:231], v[36:39], v[164:167]
    v_cvt_pk_bf16_f32 v184, v152, v153
    v_mfma_f32_16x16x32_bf16 v[164:167], v[212:215], v[32:35], v[164:167]
    v_cvt_pk_bf16_f32 v185, v154, v155
    s_add_u32 s66, s66, 65536
    s_waitcnt lgkmcnt(4)
    v_mfma_f32_16x16x32_bf16 v[40:43], v[16:19], a[0:3], 0
    ds_read_b64_tr_b16 v[32:33], v3 offset:16384
    s_add_u32 m0, s60, 0
    v_mfma_f32_16x16x32_bf16 v[40:43], v[20:23], a[16:19], v[40:43]
    v_cvt_pk_bf16_f32 v186, v156, v157
    v_cvt_pk_bf16_f32 v187, v158, v159
    v_mfma_f32_16x16x32_bf16 v[44:47], v[20:23], a[20:23], 0
    ds_read_b64_tr_b16 v[34:35], v3 offset:17408
    v_cvt_pk_bf16_f32 v188, v160, v161
    v_mfma_f32_16x16x32_bf16 v[44:47], v[16:19], a[4:7], v[44:47]
    s_add_u32 s64, s61, 1773568
    v_cvt_pk_bf16_f32 v189, v162, v163
    v_mfma_f32_16x16x32_bf16 v[48:51], v[16:19], a[8:11], 0
    ds_read_b64_tr_b16 v[36:37], v3 offset:24576
    v_cvt_pk_bf16_f32 v190, v164, v165
    s_add_u32 s67, s67, 65536
    v_mfma_f32_16x16x32_bf16 v[48:51], v[20:23], a[24:27], v[48:51]
    ds_read_b64_tr_b16 v[38:39], v3 offset:25600
    v_cvt_pk_bf16_f32 v191, v166, v167
    v_mfma_f32_16x16x32_bf16 v[52:55], v[20:23], a[28:31], 0
    v_lshlrev_b32 v12, 16, v184
    v_and_b32 v13, 0xffff0000, v184
    v_mfma_f32_16x16x32_bf16 v[52:55], v[16:19], a[12:15], v[52:55]
    buffer_load_dwordx4 v6, s[8:11], s64 offen  lds
    s_waitcnt lgkmcnt(4)
    v_mfma_f32_16x16x32_bf16 v[56:59], v[24:27], a[0:3], 0
    ds_read_b64_tr_b16 v[16:17], v3 offset:18432
    v_mul_f32 v14, 1069066811, v12
    s_add_u32 s68, s68, 65536
    v_mfma_f32_16x16x32_bf16 v[56:59], v[28:31], a[16:19], v[56:59]
    v_mul_f32 v15, 1069066811, v13
    v_exp_f32_e64 v14, v14 clamp
    v_mfma_f32_16x16x32_bf16 v[60:63], v[28:31], a[20:23], 0
    ds_read_b64_tr_b16 v[18:19], v3 offset:19456
    v_exp_f32_e64 v15, v15 clamp
    v_mfma_f32_16x16x32_bf16 v[60:63], v[24:27], a[4:7], v[60:63]
    s_add_u32 s65, s61, 1809408
    v_max_f32 v12, 897988541, v12
    v_mfma_f32_16x16x32_bf16 v[64:67], v[24:27], a[8:11], 0
    ds_read_b64_tr_b16 v[20:21], v3 offset:26624
    v_max_f32 v13, 897988541, v13
    v_mfma_f32_16x16x32_bf16 v[64:67], v[28:31], a[24:27], v[64:67]
    ds_read_b64_tr_b16 v[22:23], v3 offset:27648
    v_add_f32 v12, v12, v14
    v_mfma_f32_16x16x32_bf16 v[68:71], v[28:31], a[28:31], 0
    buffer_load_dwordx4 v6, s[12:15], s64 offen offset:2048  lds
    v_add_f32 v13, v13, v15
    s_add_u32 s69, s69, 65536
    v_mfma_f32_16x16x32_bf16 v[68:71], v[24:27], a[12:15], v[68:71]
    v_cvt_pk_bf16_f32 v12, v12, v13
    s_waitcnt lgkmcnt(4)
    v_mfma_f32_16x16x32_bf16 v[72:75], v[32:35], a[0:3], 0
    ds_read_b64_tr_b16 v[24:25], v4 offset:16384
    v_cndmask_b32 v184, v184, v12, s[42:43]
    v_mfma_f32_16x16x32_bf16 v[72:75], v[36:39], a[16:19], v[72:75]
    v_lshlrev_b32 v12, 16, v185
    v_and_b32 v13, 0xffff0000, v185
    v_mfma_f32_16x16x32_bf16 v[76:79], v[36:39], a[20:23], 0
    ds_read_b64_tr_b16 v[26:27], v4 offset:17408
    buffer_load_dwordx4 v6, s[8:11], s65 offen offset:1024  lds
    v_mfma_f32_16x16x32_bf16 v[76:79], v[32:35], a[4:7], v[76:79]
    v_mul_f32 v14, 1069066811, v12
    v_mul_f32 v15, 1069066811, v13
    v_mfma_f32_16x16x32_bf16 v[80:83], v[32:35], a[8:11], 0
    ds_read_b64_tr_b16 v[28:29], v4 offset:24576
    v_exp_f32_e64 v14, v14 clamp
    v_mfma_f32_16x16x32_bf16 v[80:83], v[36:39], a[24:27], v[80:83]
    ds_read_b64_tr_b16 v[30:31], v4 offset:25600
    v_exp_f32_e64 v15, v15 clamp
    v_mfma_f32_16x16x32_bf16 v[84:87], v[36:39], a[28:31], 0
    buffer_load_dwordx4 v6, s[12:15], s65 offen offset:3072  lds
    v_max_f32 v12, 897988541, v12
    v_mfma_f32_16x16x32_bf16 v[84:87], v[32:35], a[12:15], v[84:87]
    v_max_f32 v13, 897988541, v13
    s_waitcnt lgkmcnt(4)
    v_mfma_f32_16x16x32_bf16 v[88:91], v[16:19], a[0:3], 0
    ds_read_b64_tr_b16 v[32:33], v4 offset:18432
    v_add_f32 v12, v12, v14
    v_mfma_f32_16x16x32_bf16 v[88:91], v[20:23], a[16:19], v[88:91]
    v_add_f32 v13, v13, v15
    v_cvt_pk_bf16_f32 v12, v12, v13
    v_mfma_f32_16x16x32_bf16 v[92:95], v[20:23], a[20:23], 0
    ds_read_b64_tr_b16 v[34:35], v4 offset:19456
    v_cndmask_b32 v185, v185, v12, s[42:43]
    v_mfma_f32_16x16x32_bf16 v[92:95], v[16:19], a[4:7], v[92:95]
    v_lshlrev_b32 v12, 16, v186
    v_and_b32 v13, 0xffff0000, v186
    v_mfma_f32_16x16x32_bf16 v[96:99], v[16:19], a[8:11], 0
    ds_read_b64_tr_b16 v[36:37], v4 offset:26624
    v_mul_f32 v14, 1069066811, v12
    v_mfma_f32_16x16x32_bf16 v[96:99], v[20:23], a[24:27], v[96:99]
    ds_read_b64_tr_b16 v[38:39], v4 offset:27648
    v_mul_f32 v15, 1069066811, v13
    v_mfma_f32_16x16x32_bf16 v[100:103], v[20:23], a[28:31], 0
    v_exp_f32_e64 v14, v14 clamp
    v_mfma_f32_16x16x32_bf16 v[100:103], v[16:19], a[12:15], v[100:103]
    v_exp_f32_e64 v15, v15 clamp
    s_waitcnt lgkmcnt(4)
    v_mfma_f32_16x16x32_bf16 v[104:107], v[24:27], a[0:3], 0
    ds_read_b64_tr_b16 v[16:17], v5 offset:16384
    v_max_f32 v12, 897988541, v12
    v_mfma_f32_16x16x32_bf16 v[104:107], v[28:31], a[16:19], v[104:107]
    v_max_f32 v13, 897988541, v13
    v_add_f32 v12, v12, v14
    v_mfma_f32_16x16x32_bf16 v[108:111], v[28:31], a[20:23], 0
    ds_read_b64_tr_b16 v[18:19], v5 offset:17408
    v_add_f32 v13, v13, v15
    v_mfma_f32_16x16x32_bf16 v[108:111], v[24:27], a[4:7], v[108:111]
    v_cvt_pk_bf16_f32 v12, v12, v13
    v_cndmask_b32 v186, v186, v12, s[42:43]
    v_mfma_f32_16x16x32_bf16 v[112:115], v[24:27], a[8:11], 0
    ds_read_b64_tr_b16 v[20:21], v5 offset:24576
    v_lshlrev_b32 v12, 16, v187
    v_mfma_f32_16x16x32_bf16 v[112:115], v[28:31], a[24:27], v[112:115]
    ds_read_b64_tr_b16 v[22:23], v5 offset:25600
    v_and_b32 v13, 0xffff0000, v187
    v_mfma_f32_16x16x32_bf16 v[116:119], v[28:31], a[28:31], 0
    s_add_u32 m0, s60, 16384
    v_mul_f32 v14, 1069066811, v12
    v_mfma_f32_16x16x32_bf16 v[116:119], v[24:27], a[12:15], v[116:119]
    v_mul_f32 v15, 1069066811, v13
    s_waitcnt lgkmcnt(4)
    v_mfma_f32_16x16x32_bf16 v[120:123], v[32:35], a[0:3], 0
    ds_read_b64_tr_b16 v[24:25], v5 offset:18432
    v_exp_f32_e64 v14, v14 clamp
    v_mfma_f32_16x16x32_bf16 v[120:123], v[36:39], a[16:19], v[120:123]
    v_exp_f32_e64 v15, v15 clamp
    v_mfma_f32_16x16x32_bf16 v[124:127], v[36:39], a[20:23], 0
    ds_read_b64_tr_b16 v[26:27], v5 offset:19456
    v_max_f32 v12, 897988541, v12
    s_lshl_b32 s38, s58, 8
    v_mfma_f32_16x16x32_bf16 v[124:127], v[32:35], a[4:7], v[124:127]
    s_add_u32 s64, s61, 2363392
    v_max_f32 v13, 897988541, v13
    s_add_u32 s38, s38, s59
    v_mfma_f32_16x16x32_bf16 v[128:131], v[32:35], a[8:11], 0
    ds_read_b64_tr_b16 v[28:29], v5 offset:26624
    v_add_f32 v12, v12, v14
    s_lshr_b32 s38, s38, 2
    v_mfma_f32_16x16x32_bf16 v[128:131], v[36:39], a[24:27], v[128:131]
    ds_read_b64_tr_b16 v[30:31], v5 offset:27648
    v_add_f32 v13, v13, v15
    s_lshl_b32 s38, s38, 7
    s_add_u32 s38, s38, 28344320
    v_mfma_f32_16x16x32_bf16 v[132:135], v[36:39], a[28:31], 0
    v_cvt_pk_bf16_f32 v12, v12, v13
    v_cndmask_b32 v187, v187, v12, s[42:43]
    v_mov_b32 v1, s80
    v_mfma_f32_16x16x32_bf16 v[132:135], v[32:35], a[12:15], v[132:135]
    s_waitcnt vmcnt(8)
    s_barrier
    buffer_store_dword v1, v0, s[16:19], s38 offen sc1
    s_waitcnt lgkmcnt(4)
    v_mfma_f32_16x16x32_bf16 v[136:139], v[16:19], a[0:3], 0
    ds_read_b64_tr_b16 v[32:33], v2 offset:32768
    v_lshlrev_b32 v12, 16, v188
    v_mfma_f32_16x16x32_bf16 v[136:139], v[20:23], a[16:19], v[136:139]
    buffer_load_dwordx4 v6, s[8:11], s64 offen  lds
    v_and_b32 v13, 0xffff0000, v188
    v_mfma_f32_16x16x32_bf16 v[140:143], v[20:23], a[20:23], 0
    ds_read_b64_tr_b16 v[34:35], v2 offset:33792
    v_mul_f32 v14, 1069066811, v12
    v_mfma_f32_16x16x32_bf16 v[140:143], v[16:19], a[4:7], v[140:143]
    v_mul_f32 v15, 1069066811, v13
    v_exp_f32_e64 v14, v14 clamp
    v_mfma_f32_16x16x32_bf16 v[144:147], v[16:19], a[8:11], 0
    ds_read_b64_tr_b16 v[36:37], v2 offset:40960
    v_exp_f32_e64 v15, v15 clamp
    v_mfma_f32_16x16x32_bf16 v[144:147], v[20:23], a[24:27], v[144:147]
    ds_read_b64_tr_b16 v[38:39], v2 offset:41984
    v_max_f32 v12, 897988541, v12
    v_mfma_f32_16x16x32_bf16 v[148:151], v[20:23], a[28:31], 0
    s_add_u32 s65, s61, 2399232
    v_max_f32 v13, 897988541, v13
    v_mfma_f32_16x16x32_bf16 v[148:151], v[16:19], a[12:15], v[148:151]
    v_add_f32 v12, v12, v14
    s_waitcnt lgkmcnt(4)
    v_mfma_f32_16x16x32_bf16 v[152:155], v[24:27], a[0:3], 0
    ds_read_b64_tr_b16 v[16:17], v2 offset:34816
    v_add_f32 v13, v13, v15
    v_mfma_f32_16x16x32_bf16 v[152:155], v[28:31], a[16:19], v[152:155]
    v_cvt_pk_bf16_f32 v12, v12, v13
    v_cndmask_b32 v188, v188, v12, s[42:43]
    v_mfma_f32_16x16x32_bf16 v[156:159], v[28:31], a[20:23], 0
    ds_read_b64_tr_b16 v[18:19], v2 offset:35840
    v_lshlrev_b32 v12, 16, v189
    v_mfma_f32_16x16x32_bf16 v[156:159], v[24:27], a[4:7], v[156:159]
    buffer_load_dwordx4 v6, s[12:15], s64 offen offset:2048  lds
    v_and_b32 v13, 0xffff0000, v189
    v_mfma_f32_16x16x32_bf16 v[160:163], v[24:27], a[8:11], 0
    ds_read_b64_tr_b16 v[20:21], v2 offset:43008
    v_mul_f32 v14, 1069066811, v12
    v_mfma_f32_16x16x32_bf16 v[160:163], v[28:31], a[24:27], v[160:163]
    ds_read_b64_tr_b16 v[22:23], v2 offset:44032
    v_mul_f32 v15, 1069066811, v13
    s_mov_b32 s92, 589824
    v_mfma_f32_16x16x32_bf16 v[164:167], v[28:31], a[28:31], 0
    v_exp_f32_e64 v14, v14 clamp
    v_lshrrev_b32 v1, 8, v11
    v_mul_lo_u32 v1, v1, s92
    v_mfma_f32_16x16x32_bf16 v[164:167], v[24:27], a[12:15], v[164:167]
    v_exp_f32_e64 v15, v15 clamp
    s_bfe_u32 s92, s2, 0x10001
    s_waitcnt lgkmcnt(4)
    v_mfma_f32_16x16x32_bf16 v[40:43], v[32:35], a[32:35], v[40:43]
    ds_read_b64_tr_b16 v[24:25], v3 offset:32768
    v_max_f32 v12, 897988541, v12
    s_lshl_b32 s92, s92, 8
    v_mfma_f32_16x16x32_bf16 v[40:43], v[36:39], a[48:51], v[40:43]
    buffer_load_dwordx4 v6, s[8:11], s65 offen offset:1024  lds
    v_max_f32 v13, 897988541, v13
    s_mov_b32 s93, 0xf0
    v_mfma_f32_16x16x32_bf16 v[44:47], v[36:39], a[52:55], v[44:47]
    ds_read_b64_tr_b16 v[26:27], v3 offset:33792
    v_add_f32 v12, v12, v14
    v_lshrrev_b32 v1, 3, v1
    v_and_or_b32 v1, v11, s93, v1
    v_mfma_f32_16x16x32_bf16 v[44:47], v[32:35], a[36:39], v[44:47]
    v_add_f32 v13, v13, v15
    v_cvt_pk_bf16_f32 v12, v12, v13
    v_add_lshl_u32 v1, v1, s92, 3
    s_add_u32 s87, s86, 2953216
    v_mfma_f32_16x16x32_bf16 v[48:51], v[32:35], a[40:43], v[48:51]
    ds_read_b64_tr_b16 v[28:29], v3 offset:40960
    v_cndmask_b32 v189, v189, v12, s[42:43]
    s_cmp_eq_u32 s54, 0
    s_cselect_b32 s87, s87, 1073741824
    v_mfma_f32_16x16x32_bf16 v[48:51], v[36:39], a[56:59], v[48:51]
    ds_read_b64_tr_b16 v[30:31], v3 offset:41984
    v_lshlrev_b32 v12, 16, v190
    buffer_load_dword v1, v1, s[88:91], s87 offen
    v_mfma_f32_16x16x32_bf16 v[52:55], v[36:39], a[60:63], v[52:55]
    buffer_load_dwordx4 v6, s[12:15], s65 offen offset:3072  lds
    v_and_b32 v13, 0xffff0000, v190
    v_mfma_f32_16x16x32_bf16 v[52:55], v[32:35], a[44:47], v[52:55]
    v_mul_f32 v14, 1069066811, v12
    s_waitcnt lgkmcnt(4)
    v_mfma_f32_16x16x32_bf16 v[56:59], v[16:19], a[32:35], v[56:59]
    ds_read_b64_tr_b16 v[32:33], v3 offset:34816
    v_mul_f32 v15, 1069066811, v13
    v_mfma_f32_16x16x32_bf16 v[56:59], v[20:23], a[48:51], v[56:59]
    v_exp_f32_e64 v14, v14 clamp
    v_mfma_f32_16x16x32_bf16 v[60:63], v[20:23], a[52:55], v[60:63]
    ds_read_b64_tr_b16 v[34:35], v3 offset:35840
    v_mfma_f32_16x16x32_bf16 v[60:63], v[16:19], a[36:39], v[60:63]
    v_exp_f32_e64 v15, v15 clamp
    v_mfma_f32_16x16x32_bf16 v[64:67], v[16:19], a[40:43], v[64:67]
    ds_read_b64_tr_b16 v[36:37], v3 offset:43008
    v_max_f32 v12, 897988541, v12
    v_mfma_f32_16x16x32_bf16 v[64:67], v[20:23], a[56:59], v[64:67]
    ds_read_b64_tr_b16 v[38:39], v3 offset:44032
    v_max_f32 v13, 897988541, v13
    v_mfma_f32_16x16x32_bf16 v[68:71], v[20:23], a[60:63], v[68:71]
    v_add_f32 v12, v12, v14
    v_mfma_f32_16x16x32_bf16 v[68:71], v[16:19], a[44:47], v[68:71]
    v_add_f32 v13, v13, v15
    s_waitcnt lgkmcnt(4)
    v_mfma_f32_16x16x32_bf16 v[72:75], v[24:27], a[32:35], v[72:75]
    ds_read_b64_tr_b16 v[16:17], v4 offset:32768
    v_cvt_pk_bf16_f32 v12, v12, v13
    v_mfma_f32_16x16x32_bf16 v[72:75], v[28:31], a[48:51], v[72:75]
    v_cndmask_b32 v190, v190, v12, s[42:43]
    v_lshlrev_b32 v12, 16, v191
    v_mfma_f32_16x16x32_bf16 v[76:79], v[28:31], a[52:55], v[76:79]
    ds_read_b64_tr_b16 v[18:19], v4 offset:33792
    v_and_b32 v13, 0xffff0000, v191
    v_mfma_f32_16x16x32_bf16 v[76:79], v[24:27], a[36:39], v[76:79]
    v_mul_f32 v14, 1069066811, v12
    v_mfma_f32_16x16x32_bf16 v[80:83], v[24:27], a[40:43], v[80:83]
    ds_read_b64_tr_b16 v[20:21], v4 offset:40960
    v_mul_f32 v15, 1069066811, v13
    v_mfma_f32_16x16x32_bf16 v[80:83], v[28:31], a[56:59], v[80:83]
    ds_read_b64_tr_b16 v[22:23], v4 offset:41984
    v_exp_f32_e64 v14, v14 clamp
    v_mfma_f32_16x16x32_bf16 v[84:87], v[28:31], a[60:63], v[84:87]
    v_exp_f32_e64 v15, v15 clamp
    v_mfma_f32_16x16x32_bf16 v[84:87], v[24:27], a[44:47], v[84:87]
    v_max_f32 v12, 897988541, v12
    s_waitcnt lgkmcnt(4)
    v_mfma_f32_16x16x32_bf16 v[88:91], v[32:35], a[32:35], v[88:91]
    ds_read_b64_tr_b16 v[24:25], v4 offset:34816
    v_max_f32 v13, 897988541, v13
    v_mfma_f32_16x16x32_bf16 v[88:91], v[36:39], a[48:51], v[88:91]
    v_add_f32 v12, v12, v14
    v_add_f32 v13, v13, v15
    v_mfma_f32_16x16x32_bf16 v[92:95], v[36:39], a[52:55], v[92:95]
    ds_read_b64_tr_b16 v[26:27], v4 offset:35840
    v_cvt_pk_bf16_f32 v12, v12, v13
    v_mfma_f32_16x16x32_bf16 v[92:95], v[32:35], a[36:39], v[92:95]
    v_cndmask_b32 v191, v191, v12, s[42:43]
    v_mov_b32 v12, 0x3f803f80
    v_mfma_f32_16x16x32_bf16 v[96:99], v[32:35], a[40:43], v[96:99]
    ds_read_b64_tr_b16 v[28:29], v4 offset:43008
    v_cndmask_b32 v192, v184, v12, s[46:47]
    v_mfma_f32_16x16x32_bf16 v[96:99], v[36:39], a[56:59], v[96:99]
    ds_read_b64_tr_b16 v[30:31], v4 offset:44032
    v_cndmask_b32 v193, v185, v12, s[46:47]
    v_mfma_f32_16x16x32_bf16 v[100:103], v[36:39], a[60:63], v[100:103]
    v_cndmask_b32 v194, v186, v12, s[46:47]
    v_cndmask_b32 v195, v187, v12, s[46:47]
    v_mfma_f32_16x16x32_bf16 v[100:103], v[32:35], a[44:47], v[100:103]
    v_cndmask_b32 v196, v188, v12, s[46:47]
    s_waitcnt lgkmcnt(4)
    v_mfma_f32_16x16x32_bf16 v[104:107], v[16:19], a[32:35], v[104:107]
    ds_read_b64_tr_b16 v[32:33], v5 offset:32768
    v_cndmask_b32 v197, v189, v12, s[46:47]
    v_mfma_f32_16x16x32_bf16 v[104:107], v[20:23], a[48:51], v[104:107]
    v_cndmask_b32 v198, v190, v12, s[46:47]
    v_cndmask_b32 v199, v191, v12, s[46:47]
    v_mfma_f32_16x16x32_bf16 v[108:111], v[20:23], a[52:55], v[108:111]
    ds_read_b64_tr_b16 v[34:35], v5 offset:33792
    v_lshlrev_b32 v12, 16, v168
    v_mfma_f32_16x16x32_bf16 v[108:111], v[16:19], a[36:39], v[108:111]
    v_and_b32 v13, 0xffff0000, v168
    v_mul_f32 v14, 1069066811, v12
    v_mfma_f32_16x16x32_bf16 v[112:115], v[16:19], a[40:43], v[112:115]
    ds_read_b64_tr_b16 v[36:37], v5 offset:40960
    v_mul_f32 v15, 1069066811, v13
    v_mfma_f32_16x16x32_bf16 v[112:115], v[20:23], a[56:59], v[112:115]
    ds_read_b64_tr_b16 v[38:39], v5 offset:41984
    v_exp_f32_e64 v14, v14 clamp
    v_mfma_f32_16x16x32_bf16 v[116:119], v[20:23], a[60:63], v[116:119]
    v_exp_f32_e64 v15, v15 clamp
    v_mfma_f32_16x16x32_bf16 v[116:119], v[16:19], a[44:47], v[116:119]
    v_max_f32 v12, 897988541, v12
    s_waitcnt lgkmcnt(4)
    v_mfma_f32_16x16x32_bf16 v[120:123], v[24:27], a[32:35], v[120:123]
    ds_read_b64_tr_b16 v[16:17], v5 offset:34816
    v_max_f32 v13, 897988541, v13
    v_mfma_f32_16x16x32_bf16 v[120:123], v[28:31], a[48:51], v[120:123]
    v_add_f32 v12, v12, v14
    v_add_f32 v13, v13, v15
    v_mfma_f32_16x16x32_bf16 v[124:127], v[28:31], a[52:55], v[124:127]
    ds_read_b64_tr_b16 v[18:19], v5 offset:35840
    v_cvt_pk_bf16_f32 v168, v12, v13
    v_mfma_f32_16x16x32_bf16 v[124:127], v[24:27], a[36:39], v[124:127]
    v_lshlrev_b32 v12, 16, v169
    v_and_b32 v13, 0xffff0000, v169
    v_mfma_f32_16x16x32_bf16 v[128:131], v[24:27], a[40:43], v[128:131]
    ds_read_b64_tr_b16 v[20:21], v5 offset:43008
    v_mul_f32 v14, 1069066811, v12
    v_mfma_f32_16x16x32_bf16 v[128:131], v[28:31], a[56:59], v[128:131]
    ds_read_b64_tr_b16 v[22:23], v5 offset:44032
    v_mul_f32 v15, 1069066811, v13
    v_mfma_f32_16x16x32_bf16 v[132:135], v[28:31], a[60:63], v[132:135]
    v_exp_f32_e64 v14, v14 clamp
    v_mfma_f32_16x16x32_bf16 v[132:135], v[24:27], a[44:47], v[132:135]
    s_waitcnt vmcnt(10)
    s_barrier
    s_waitcnt lgkmcnt(4)
    v_mfma_f32_16x16x32_bf16 v[136:139], v[32:35], a[32:35], v[136:139]
    ds_read_b64_tr_b16 v[24:25], v2 offset:49152
    v_mfma_f32_16x16x32_bf16 v[136:139], v[36:39], a[48:51], v[136:139]
    v_exp_f32_e64 v15, v15 clamp
    v_mfma_f32_16x16x32_bf16 v[140:143], v[36:39], a[52:55], v[140:143]
    ds_read_b64_tr_b16 v[26:27], v2 offset:50176
    v_mfma_f32_16x16x32_bf16 v[140:143], v[32:35], a[36:39], v[140:143]
    s_add_u32 m0, s60, 81920
    v_max_f32 v12, 897988541, v12
    v_mfma_f32_16x16x32_bf16 v[144:147], v[32:35], a[40:43], v[144:147]
    ds_read_b64_tr_b16 v[28:29], v2 offset:57344
    v_max_f32 v13, 897988541, v13
    v_mfma_f32_16x16x32_bf16 v[144:147], v[36:39], a[56:59], v[144:147]
    ds_read_b64_tr_b16 v[30:31], v2 offset:58368
    v_add_f32 v12, v12, v14
    v_mfma_f32_16x16x32_bf16 v[148:151], v[36:39], a[60:63], v[148:151]
    v_add_f32 v13, v13, v15
    v_cvt_pk_bf16_f32 v169, v12, v13
    v_mfma_f32_16x16x32_bf16 v[148:151], v[32:35], a[44:47], v[148:151]
    v_lshlrev_b32 v12, 16, v170
    s_waitcnt lgkmcnt(4)
    v_mfma_f32_16x16x32_bf16 v[152:155], v[16:19], a[32:35], v[152:155]
    ds_read_b64_tr_b16 v[32:33], v2 offset:51200
    v_and_b32 v13, 0xffff0000, v170
    v_mfma_f32_16x16x32_bf16 v[152:155], v[20:23], a[48:51], v[152:155]
    s_add_u32 s64, s61, 2953216
    v_mul_f32 v14, 1069066811, v12
    v_mfma_f32_16x16x32_bf16 v[156:159], v[20:23], a[52:55], v[156:159]
    ds_read_b64_tr_b16 v[34:35], v2 offset:52224
    v_mul_f32 v15, 1069066811, v13
    v_mfma_f32_16x16x32_bf16 v[156:159], v[16:19], a[36:39], v[156:159]
    v_exp_f32_e64 v14, v14 clamp
    v_mfma_f32_16x16x32_bf16 v[160:163], v[16:19], a[40:43], v[160:163]
    ds_read_b64_tr_b16 v[36:37], v2 offset:59392
    v_exp_f32_e64 v15, v15 clamp
    v_mfma_f32_16x16x32_bf16 v[160:163], v[20:23], a[56:59], v[160:163]
    ds_read_b64_tr_b16 v[38:39], v2 offset:60416
    v_max_f32 v12, 897988541, v12
    v_mfma_f32_16x16x32_bf16 v[164:167], v[20:23], a[60:63], v[164:167]
    buffer_load_dwordx4 v6, s[8:11], s64 offen  lds
    v_max_f32 v13, 897988541, v13
    v_mfma_f32_16x16x32_bf16 v[164:167], v[16:19], a[44:47], v[164:167]
    v_add_f32 v12, v12, v14
    s_waitcnt lgkmcnt(4)
    v_mfma_f32_16x16x32_bf16 v[40:43], v[24:27], a[64:67], v[40:43]
    ds_read_b64_tr_b16 v[16:17], v3 offset:49152
    v_add_f32 v13, v13, v15
    v_mfma_f32_16x16x32_bf16 v[40:43], v[28:31], a[80:83], v[40:43]
    v_cvt_pk_bf16_f32 v170, v12, v13
    v_lshlrev_b32 v12, 16, v171
    v_mfma_f32_16x16x32_bf16 v[44:47], v[28:31], a[84:87], v[44:47]
    ds_read_b64_tr_b16 v[18:19], v3 offset:50176
    v_and_b32 v13, 0xffff0000, v171
    v_mfma_f32_16x16x32_bf16 v[44:47], v[24:27], a[68:71], v[44:47]
    s_add_u32 s65, s61, 2989056
    v_mul_f32 v14, 1069066811, v12
    v_mfma_f32_16x16x32_bf16 v[48:51], v[24:27], a[72:75], v[48:51]
    ds_read_b64_tr_b16 v[20:21], v3 offset:57344
    v_mul_f32 v15, 1069066811, v13
    v_mfma_f32_16x16x32_bf16 v[48:51], v[28:31], a[88:91], v[48:51]
    ds_read_b64_tr_b16 v[22:23], v3 offset:58368
    v_exp_f32_e64 v14, v14 clamp
    v_mfma_f32_16x16x32_bf16 v[52:55], v[28:31], a[92:95], v[52:55]
    v_exp_f32_e64 v15, v15 clamp
    v_mfma_f32_16x16x32_bf16 v[52:55], v[24:27], a[76:79], v[52:55]
    v_max_f32 v12, 897988541, v12
    s_waitcnt lgkmcnt(4)
    v_mfma_f32_16x16x32_bf16 v[56:59], v[32:35], a[64:67], v[56:59]
    ds_read_b64_tr_b16 v[24:25], v3 offset:51200
    v_max_f32 v13, 897988541, v13
    v_mfma_f32_16x16x32_bf16 v[56:59], v[36:39], a[80:83], v[56:59]
    buffer_load_dwordx4 v6, s[12:15], s64 offen offset:2048  lds
    v_add_f32 v12, v12, v14
    v_mfma_f32_16x16x32_bf16 v[60:63], v[36:39], a[84:87], v[60:63]
    ds_read_b64_tr_b16 v[26:27], v3 offset:52224
    v_add_f32 v13, v13, v15
    v_mfma_f32_16x16x32_bf16 v[60:63], v[32:35], a[68:71], v[60:63]
    v_cvt_pk_bf16_f32 v171, v12, v13
    v_lshlrev_b32 v12, 16, v172
    v_mfma_f32_16x16x32_bf16 v[64:67], v[32:35], a[72:75], v[64:67]
    ds_read_b64_tr_b16 v[28:29], v3 offset:59392
    v_and_b32 v13, 0xffff0000, v172
    v_mfma_f32_16x16x32_bf16 v[64:67], v[36:39], a[88:91], v[64:67]
    ds_read_b64_tr_b16 v[30:31], v3 offset:60416
    v_mul_f32 v14, 1069066811, v12
    v_mfma_f32_16x16x32_bf16 v[68:71], v[36:39], a[92:95], v[68:71]
    buffer_load_dwordx4 v6, s[8:11], s65 offen offset:1024  lds
    v_mul_f32 v15, 1069066811, v13
    v_mfma_f32_16x16x32_bf16 v[68:71], v[32:35], a[76:79], v[68:71]
    v_exp_f32_e64 v14, v14 clamp
    s_waitcnt lgkmcnt(4)
    v_mfma_f32_16x16x32_bf16 v[72:75], v[16:19], a[64:67], v[72:75]
    ds_read_b64_tr_b16 v[32:33], v4 offset:49152
    v_exp_f32_e64 v15, v15 clamp
    v_mfma_f32_16x16x32_bf16 v[72:75], v[20:23], a[80:83], v[72:75]
    v_max_f32 v12, 897988541, v12
    v_max_f32 v13, 897988541, v13
    v_mfma_f32_16x16x32_bf16 v[76:79], v[20:23], a[84:87], v[76:79]
    ds_read_b64_tr_b16 v[34:35], v4 offset:50176
    v_add_f32 v12, v12, v14
    v_mfma_f32_16x16x32_bf16 v[76:79], v[16:19], a[68:71], v[76:79]
    buffer_load_dwordx4 v6, s[12:15], s65 offen offset:3072  lds
    v_add_f32 v13, v13, v15
    v_mfma_f32_16x16x32_bf16 v[80:83], v[16:19], a[72:75], v[80:83]
    ds_read_b64_tr_b16 v[36:37], v4 offset:57344
    v_cvt_pk_bf16_f32 v172, v12, v13
    v_mfma_f32_16x16x32_bf16 v[80:83], v[20:23], a[88:91], v[80:83]
    ds_read_b64_tr_b16 v[38:39], v4 offset:58368
    v_lshlrev_b32 v12, 16, v173
    v_mfma_f32_16x16x32_bf16 v[84:87], v[20:23], a[92:95], v[84:87]
    v_and_b32 v13, 0xffff0000, v173
    v_mul_f32 v14, 1069066811, v12
    v_mfma_f32_16x16x32_bf16 v[84:87], v[16:19], a[76:79], v[84:87]
    v_mul_f32 v15, 1069066811, v13
    s_waitcnt lgkmcnt(4)
    v_mfma_f32_16x16x32_bf16 v[88:91], v[24:27], a[64:67], v[88:91]
    ds_read_b64_tr_b16 v[16:17], v4 offset:51200
    v_exp_f32_e64 v14, v14 clamp
    v_mfma_f32_16x16x32_bf16 v[88:91], v[28:31], a[80:83], v[88:91]
    v_exp_f32_e64 v15, v15 clamp
    v_mfma_f32_16x16x32_bf16 v[92:95], v[28:31], a[84:87], v[92:95]
    ds_read_b64_tr_b16 v[18:19], v4 offset:52224
    v_max_f32 v12, 897988541, v12
    v_mfma_f32_16x16x32_bf16 v[92:95], v[24:27], a[68:71], v[92:95]
    v_max_f32 v13, 897988541, v13
    v_add_f32 v12, v12, v14
    v_mfma_f32_16x16x32_bf16 v[96:99], v[24:27], a[72:75], v[96:99]
    ds_read_b64_tr_b16 v[20:21], v4 offset:59392
    v_add_f32 v13, v13, v15
    v_mfma_f32_16x16x32_bf16 v[96:99], v[28:31], a[88:91], v[96:99]
    ds_read_b64_tr_b16 v[22:23], v4 offset:60416
    v_cvt_pk_bf16_f32 v173, v12, v13
    v_mfma_f32_16x16x32_bf16 v[100:103], v[28:31], a[92:95], v[100:103]
    v_lshlrev_b32 v12, 16, v174
    v_and_b32 v13, 0xffff0000, v174
    v_mfma_f32_16x16x32_bf16 v[100:103], v[24:27], a[76:79], v[100:103]
    v_mul_f32 v14, 1069066811, v12
    s_waitcnt lgkmcnt(4)
    v_mfma_f32_16x16x32_bf16 v[104:107], v[32:35], a[64:67], v[104:107]
    ds_read_b64_tr_b16 v[24:25], v5 offset:49152
    v_mul_f32 v15, 1069066811, v13
    v_mfma_f32_16x16x32_bf16 v[104:107], v[36:39], a[80:83], v[104:107]
    v_exp_f32_e64 v14, v14 clamp
    v_mfma_f32_16x16x32_bf16 v[108:111], v[36:39], a[84:87], v[108:111]
    ds_read_b64_tr_b16 v[26:27], v5 offset:50176
    v_mfma_f32_16x16x32_bf16 v[108:111], v[32:35], a[68:71], v[108:111]
    v_exp_f32_e64 v15, v15 clamp
    v_mfma_f32_16x16x32_bf16 v[112:115], v[32:35], a[72:75], v[112:115]
    ds_read_b64_tr_b16 v[28:29], v5 offset:57344
    v_max_f32 v12, 897988541, v12
    v_mfma_f32_16x16x32_bf16 v[112:115], v[36:39], a[88:91], v[112:115]
    ds_read_b64_tr_b16 v[30:31], v5 offset:58368
    v_max_f32 v13, 897988541, v13
    v_mfma_f32_16x16x32_bf16 v[116:119], v[36:39], a[92:95], v[116:119]
    v_add_f32 v12, v12, v14
    v_add_f32 v13, v13, v15
    v_mfma_f32_16x16x32_bf16 v[116:119], v[32:35], a[76:79], v[116:119]
    v_cvt_pk_bf16_f32 v174, v12, v13
    s_waitcnt lgkmcnt(4)
    v_mfma_f32_16x16x32_bf16 v[120:123], v[16:19], a[64:67], v[120:123]
    ds_read_b64_tr_b16 v[32:33], v5 offset:51200
    v_lshlrev_b32 v12, 16, v175
    v_mfma_f32_16x16x32_bf16 v[120:123], v[20:23], a[80:83], v[120:123]
    v_and_b32 v13, 0xffff0000, v175
    v_mul_f32 v14, 1069066811, v12
    v_mfma_f32_16x16x32_bf16 v[124:127], v[20:23], a[84:87], v[124:127]
    ds_read_b64_tr_b16 v[34:35], v5 offset:52224
    v_mul_f32 v15, 1069066811, v13
    v_mfma_f32_16x16x32_bf16 v[124:127], v[16:19], a[68:71], v[124:127]
    v_exp_f32_e64 v14, v14 clamp
    v_mfma_f32_16x16x32_bf16 v[128:131], v[16:19], a[72:75], v[128:131]
    ds_read_b64_tr_b16 v[36:37], v5 offset:59392
    v_mfma_f32_16x16x32_bf16 v[128:131], v[20:23], a[88:91], v[128:131]
    ds_read_b64_tr_b16 v[38:39], v5 offset:60416
    v_exp_f32_e64 v15, v15 clamp
    v_mfma_f32_16x16x32_bf16 v[132:135], v[20:23], a[92:95], v[132:135]
    v_max_f32 v12, 897988541, v12
    v_max_f32 v13, 897988541, v13
L_wm5:
    s_cbranch_execz L_wm9
    v_mfma_f32_16x16x32_bf16 v[132:135], v[16:19], a[76:79], v[132:135]
    s_waitcnt vmcnt(10)
    s_barrier
    s_waitcnt lgkmcnt(4)
    v_mfma_f32_16x16x32_bf16 v[136:139], v[24:27], a[64:67], v[136:139]
    v_xor_b32 v2, 65536, v2
    v_add_f32 v12, v12, v14
    v_mfma_f32_16x16x32_bf16 v[136:139], v[28:31], a[80:83], v[136:139]
    v_xor_b32 v3, 65536, v3
    v_add_f32 v13, v13, v15
    v_mfma_f32_16x16x32_bf16 v[140:143], v[28:31], a[84:87], v[140:143]
    v_xor_b32 v4, 65536, v4
    v_cvt_pk_bf16_f32 v175, v12, v13
    v_mfma_f32_16x16x32_bf16 v[140:143], v[24:27], a[68:71], v[140:143]
    v_xor_b32 v5, 65536, v5
    s_add_u32 m0, s60, 98304
    v_mfma_f32_16x16x32_bf16 v[248:251], v[168:171], v[176:179], 0
    v_mfma_f32_16x16x32_bf16 v[144:147], v[24:27], a[72:75], v[144:147]
    ds_read_b64_tr_b16 v[16:17], v2 offset:0
    ds_read_b64_tr_b16 v[18:19], v2 offset:1024
    v_mfma_f32_16x16x32_bf16 v[144:147], v[28:31], a[88:91], v[144:147]
    ds_read_b64_tr_b16 v[20:21], v2 offset:8192
    v_mfma_f32_16x16x32_bf16 v[248:251], v[172:175], v[180:183], v[248:251]
    v_mfma_f32_16x16x32_bf16 v[148:151], v[28:31], a[92:95], v[148:151]
    ds_read_b64_tr_b16 v[22:23], v2 offset:9216
    v_mfma_f32_16x16x32_bf16 v[252:255], v[184:187], v[176:179], 0
    v_mfma_f32_16x16x32_bf16 v[148:151], v[24:27], a[76:79], v[148:151]
    v_mfma_f32_16x16x32_bf16 v[252:255], v[188:191], v[180:183], v[252:255]
    s_waitcnt lgkmcnt(4)
    v_mfma_f32_16x16x32_bf16 v[152:155], v[32:35], a[64:67], v[152:155]
    ds_read_b64_tr_b16 v[24:25], v2 offset:2048
    v_mfma_f32_16x16x32_bf16 v[176:179], v[168:171], v[192:195], 0
    v_mfma_f32_16x16x32_bf16 v[152:155], v[36:39], a[80:83], v[152:155]
    s_add_u32 s64, s61, 3543040
    v_mfma_f32_16x16x32_bf16 v[176:179], v[172:175], v[196:199], v[176:179]
    v_mfma_f32_16x16x32_bf16 v[156:159], v[36:39], a[84:87], v[156:159]
    ds_read_b64_tr_b16 v[26:27], v2 offset:3072
    v_mfma_f32_16x16x32_bf16 v[180:183], v[184:187], v[192:195], 0
    v_mfma_f32_16x16x32_bf16 v[156:159], v[32:35], a[68:71], v[156:159]
    v_mfma_f32_16x16x32_bf16 v[180:183], v[188:191], v[196:199], v[180:183]
    v_mfma_f32_16x16x32_bf16 v[160:163], v[32:35], a[72:75], v[160:163]
    ds_read_b64_tr_b16 v[28:29], v2 offset:10240
    v_add_u32 v12, s60, v11
    v_mfma_f32_16x16x32_bf16 v[160:163], v[36:39], a[88:91], v[160:163]
    ds_read_b64_tr_b16 v[30:31], v2 offset:11264
    s_lshr_b32 s3, s60, 2
    s_add_u32 s3, s3, 131072
    v_mfma_f32_16x16x32_bf16 v[164:167], v[36:39], a[92:95], v[164:167]
    buffer_load_dwordx4 v6, s[8:11], s64 offen  lds
    v_add_u32 v13, s3, v11
    v_add_u32 v12, 131072, v12
    v_mfma_f32_16x16x32_bf16 v[164:167], v[32:35], a[76:79], v[164:167]
    v_and_b32 v14, 0xf0, v11
    s_waitcnt lgkmcnt(4)
    v_mfma_f32_16x16x32_bf16 v[40:43], v[16:19], a[96:99], v[40:43]
    ds_read_b64_tr_b16 v[32:33], v3 offset:0
    v_lshlrev_b32 v14, 1, v14
    v_mfma_f32_16x16x32_bf16 v[40:43], v[20:23], a[112:115], v[40:43]
    v_lshrrev_b32 v15, 8, v11
    v_lshl_add_u32 v14, v15, 3, v14
    v_mfma_f32_16x16x32_bf16 v[44:47], v[20:23], a[116:119], v[44:47]
    ds_read_b64_tr_b16 v[34:35], v3 offset:1024
    v_add_u32 v14, s3, v14
    ds_write_b64 v14, v[184:185] offset:0
    v_mfma_f32_16x16x32_bf16 v[44:47], v[16:19], a[100:103], v[44:47]
    s_add_u32 s65, s61, 3578880
    ds_write_b64 v14, v[186:187] offset:512
    v_mfma_f32_16x16x32_bf16 v[48:51], v[16:19], a[104:107], v[48:51]
    ds_read_b64_tr_b16 v[36:37], v3 offset:8192
    ds_write_b64 v14, v[188:189] offset:4096
    ds_write_b64 v14, v[190:191] offset:4608
    v_mfma_f32_16x16x32_bf16 v[48:51], v[20:23], a[120:123], v[48:51]
    ds_read_b64_tr_b16 v[38:39], v3 offset:9216
    v_bfe_u32 v15, v11, 6, 2
    v_mfma_f32_16x16x32_bf16 v[52:55], v[20:23], a[124:127], v[52:55]
    v_lshlrev_b32 v15, 5, v15
    v_bfe_u32 v14, v11, 4, 2
    s_lshl_b32 s0, s58, 6
    v_mfma_f32_16x16x32_bf16 v[52:55], v[16:19], a[108:111], v[52:55]
    v_lshl_add_u32 v15, v14, 3, v15
    s_lshl_b32 s0, s0, 7
    s_waitcnt lgkmcnt(8)
    v_mfma_f32_16x16x32_bf16 v[56:59], v[24:27], a[96:99], v[56:59]
    ds_read_b64_tr_b16 v[16:17], v3 offset:2048
    v_add_u32 v15, s3, v15
    ds_read_b64_tr_b16 v[234:235], v15 offset:320
    s_add_u32 s0, s0, 28344320
    v_mfma_f32_16x16x32_bf16 v[56:59], v[28:31], a[112:115], v[56:59]
    buffer_load_dwordx4 v6, s[12:15], s64 offen offset:2048  lds
    ds_read_b64_tr_b16 v[238:239], v15 offset:832
    s_cmp_eq_u32 s54, 0
    s_cselect_b32 s0, s0, 1073741824
    v_mfma_f32_16x16x32_bf16 v[60:63], v[28:31], a[116:119], v[60:63]
    ds_read_b64_tr_b16 v[18:19], v3 offset:3072
    ds_read_b64_tr_b16 v[242:243], v15 offset:4416
    ds_read_b64_tr_b16 v[246:247], v15 offset:4928
    s_waitcnt vmcnt(7)
    v_bfe_u32 v1, v11, 4, 6
    v_mfma_f32_16x16x32_bf16 v[60:63], v[24:27], a[100:103], v[60:63]
    ds_write_b128 v13, v[248:251] offset:0
    v_lshlrev_b32 v1, 7, v1
    buffer_load_dword v1, v1, s[16:19], s0 offen sc1
    v_mfma_f32_16x16x32_bf16 v[64:67], v[24:27], a[104:107], v[64:67]
    ds_read_b64_tr_b16 v[20:21], v3 offset:10240
    ds_write_b128 v13, v[252:255] offset:4096
    v_mfma_f32_16x16x32_bf16 v[64:67], v[28:31], a[120:123], v[64:67]
    ds_read_b64_tr_b16 v[22:23], v3 offset:11264
    ds_write_b128 v13, v[176:179] offset:8192
    v_mfma_f32_16x16x32_bf16 v[68:71], v[28:31], a[124:127], v[68:71]
    buffer_load_dwordx4 v6, s[8:11], s65 offen offset:1024  lds
    ds_write_b128 v13, v[180:183] offset:12288
    v_mfma_f32_16x16x32_bf16 v[68:71], v[24:27], a[108:111], v[68:71]
    s_waitcnt lgkmcnt(12)
    v_mfma_f32_16x16x32_bf16 v[72:75], v[32:35], a[96:99], v[72:75]
    ds_read_b64_tr_b16 v[24:25], v4 offset:0
    v_mfma_f32_16x16x32_bf16 v[72:75], v[36:39], a[112:115], v[72:75]
    v_mfma_f32_16x16x32_bf16 v[76:79], v[36:39], a[116:119], v[76:79]
    ds_read_b64_tr_b16 v[26:27], v4 offset:1024
    v_mfma_f32_16x16x32_bf16 v[76:79], v[32:35], a[100:103], v[76:79]
    buffer_load_dwordx4 v6, s[12:15], s65 offen offset:3072  lds
    v_mfma_f32_16x16x32_bf16 v[80:83], v[32:35], a[104:107], v[80:83]
    ds_read_b64_tr_b16 v[28:29], v4 offset:8192
    s_waitcnt lgkmcnt(3)
    s_barrier
    v_mfma_f32_16x16x32_bf16 v[80:83], v[36:39], a[120:123], v[80:83]
    ds_read_b64_tr_b16 v[30:31], v4 offset:9216
    ds_read_b128 v[168:171], v12 offset:0
    v_mfma_f32_16x16x32_bf16 v[84:87], v[36:39], a[124:127], v[84:87]
    ds_read_b128 v[172:175], v12 offset:1024
    ds_read_b128 v[176:179], v12 offset:2048
    v_mfma_f32_16x16x32_bf16 v[84:87], v[32:35], a[108:111], v[84:87]
    ds_read_b128 v[180:183], v12 offset:3072
    s_lshl_b32 s3, s55, 2
    v_mfma_f32_16x16x32_bf16 v[88:91], v[16:19], a[96:99], v[88:91]
    ds_read_b64_tr_b16 v[32:33], v4 offset:2048
    s_add_u32 s3, s3, s54
    s_lshl_b32 s3, s3, 3
    v_mfma_f32_16x16x32_bf16 v[88:91], v[20:23], a[112:115], v[88:91]
    s_add_u32 s3, s3, s56
    s_lshl_b32 s3, s3, 10
    v_mfma_f32_16x16x32_bf16 v[92:95], v[20:23], a[116:119], v[92:95]
    ds_read_b64_tr_b16 v[34:35], v4 offset:3072
    s_add_u32 s3, s3, 29360128
    s_waitcnt lgkmcnt(4)
    v_add_f32 v168, v168, v172
    v_mfma_f32_16x16x32_bf16 v[92:95], v[16:19], a[100:103], v[92:95]
    v_add_f32 v169, v169, v173
    v_add_f32 v170, v170, v174
    v_mfma_f32_16x16x32_bf16 v[96:99], v[16:19], a[104:107], v[96:99]
    ds_read_b64_tr_b16 v[36:37], v4 offset:10240
    v_add_f32 v171, v171, v175
    s_waitcnt lgkmcnt(3)
    v_add_f32 v176, v176, v180
    v_mfma_f32_16x16x32_bf16 v[96:99], v[20:23], a[120:123], v[96:99]
    ds_read_b64_tr_b16 v[38:39], v4 offset:11264
    v_add_f32 v177, v177, v181
    v_mfma_f32_16x16x32_bf16 v[100:103], v[20:23], a[124:127], v[100:103]
    v_add_f32 v178, v178, v182
    v_add_f32 v179, v179, v183
    v_mfma_f32_16x16x32_bf16 v[100:103], v[16:19], a[108:111], v[100:103]
    v_add_f32 v168, v168, v176
    v_add_f32 v169, v169, v177
    v_mfma_f32_16x16x32_bf16 v[104:107], v[24:27], a[96:99], v[104:107]
    ds_read_b64_tr_b16 v[16:17], v5 offset:0
    v_add_f32 v170, v170, v178
    v_add_f32 v171, v171, v179
    v_mfma_f32_16x16x32_bf16 v[104:107], v[28:31], a[112:115], v[104:107]
    s_mov_b32 s31, 117835011
    v_perm_b32 v168, v168, v171, s31
    v_mfma_f32_16x16x32_bf16 v[108:111], v[28:31], a[116:119], v[108:111]
    ds_read_b64_tr_b16 v[18:19], v5 offset:1024
    s_mov_b32 s31, 117835010
    v_perm_b32 v169, v169, v171, s31
    v_mfma_f32_16x16x32_bf16 v[108:111], v[24:27], a[100:103], v[108:111]
    s_mov_b32 s31, 117835009
    v_perm_b32 v170, v170, v171, s31
    v_mfma_f32_16x16x32_bf16 v[112:115], v[24:27], a[104:107], v[112:115]
    ds_read_b64_tr_b16 v[20:21], v5 offset:8192
    v_mov_b32 v171, s80
    buffer_store_dwordx4 v[168:171], v11, s[16:19], s3 offen sc1
    v_mfma_f32_16x16x32_bf16 v[112:115], v[28:31], a[120:123], v[112:115]
    ds_read_b64_tr_b16 v[22:23], v5 offset:9216
    v_lshlrev_b32 v12, 16, v232
    v_mfma_f32_16x16x32_bf16 v[116:119], v[28:31], a[124:127], v[116:119]
    v_and_b32 v13, 0xffff0000, v232
    v_mfma_f32_16x16x32_bf16 v[116:119], v[24:27], a[108:111], v[116:119]
    s_waitcnt lgkmcnt(4)
    v_mfma_f32_16x16x32_bf16 v[120:123], v[32:35], a[96:99], v[120:123]
    ds_read_b64_tr_b16 v[24:25], v5 offset:2048
    v_mul_f32 v14, 1069066811, v12
    v_mfma_f32_16x16x32_bf16 v[120:123], v[36:39], a[112:115], v[120:123]
    v_mul_f32 v15, 1069066811, v13
    v_mfma_f32_16x16x32_bf16 v[124:127], v[36:39], a[116:119], v[124:127]
    ds_read_b64_tr_b16 v[26:27], v5 offset:3072
    v_mfma_f32_16x16x32_bf16 v[124:127], v[32:35], a[100:103], v[124:127]
    v_exp_f32_e64 v14, v14 clamp
    v_mfma_f32_16x16x32_bf16 v[128:131], v[32:35], a[104:107], v[128:131]
    ds_read_b64_tr_b16 v[28:29], v5 offset:10240
    v_mfma_f32_16x16x32_bf16 v[128:131], v[36:39], a[120:123], v[128:131]
    ds_read_b64_tr_b16 v[30:31], v5 offset:11264
    v_mfma_f32_16x16x32_bf16 v[132:135], v[36:39], a[124:127], v[132:135]
    v_exp_f32_e64 v15, v15 clamp
    v_mfma_f32_16x16x32_bf16 v[132:135], v[32:35], a[108:111], v[132:135]
    s_waitcnt vmcnt(10)
    s_barrier
    s_waitcnt lgkmcnt(4)
    v_mfma_f32_16x16x32_bf16 v[136:139], v[16:19], a[96:99], v[136:139]
    ds_read_b64_tr_b16 v[32:33], v2 offset:16384
    v_max_f32 v12, 897988541, v12
    v_mfma_f32_16x16x32_bf16 v[136:139], v[20:23], a[112:115], v[136:139]
    v_max_f32 v13, 897988541, v13
    v_add_f32 v12, v12, v14
    v_mfma_f32_16x16x32_bf16 v[140:143], v[20:23], a[116:119], v[140:143]
    ds_read_b64_tr_b16 v[34:35], v2 offset:17408
    v_add_f32 v13, v13, v15
    v_mfma_f32_16x16x32_bf16 v[140:143], v[16:19], a[100:103], v[140:143]
    s_add_u32 m0, s60, 114688
    v_mfma_f32_16x16x32_bf16 v[144:147], v[16:19], a[104:107], v[144:147]
    ds_read_b64_tr_b16 v[36:37], v2 offset:24576
    v_cvt_pk_bf16_f32 v232, v12, v13
    v_mfma_f32_16x16x32_bf16 v[144:147], v[20:23], a[120:123], v[144:147]
    ds_read_b64_tr_b16 v[38:39], v2 offset:25600
    v_lshlrev_b32 v12, 16, v233
    v_mfma_f32_16x16x32_bf16 v[148:151], v[20:23], a[124:127], v[148:151]
    s_add_u32 s64, s61, 4132864
    v_mfma_f32_16x16x32_bf16 v[148:151], v[16:19], a[108:111], v[148:151]
    v_and_b32 v13, 0xffff0000, v233
    s_waitcnt lgkmcnt(4)
    v_mfma_f32_16x16x32_bf16 v[152:155], v[24:27], a[96:99], v[152:155]
    ds_read_b64_tr_b16 v[16:17], v2 offset:18432
    v_mul_f32 v14, 1069066811, v12
    v_mfma_f32_16x16x32_bf16 v[152:155], v[28:31], a[112:115], v[152:155]
    buffer_load_dwordx4 v6, s[8:11], s64 offen  lds
    v_mfma_f32_16x16x32_bf16 v[156:159], v[28:31], a[116:119], v[156:159]
    ds_read_b64_tr_b16 v[18:19], v2 offset:19456
    v_mul_f32 v15, 1069066811, v13
    v_mfma_f32_16x16x32_bf16 v[156:159], v[24:27], a[100:103], v[156:159]
    s_add_u32 s65, s61, 4168704
    v_exp_f32_e64 v14, v14 clamp
    v_mfma_f32_16x16x32_bf16 v[160:163], v[24:27], a[104:107], v[160:163]
    ds_read_b64_tr_b16 v[20:21], v2 offset:26624
    v_exp_f32_e64 v15, v15 clamp
    v_mfma_f32_16x16x32_bf16 v[160:163], v[28:31], a[120:123], v[160:163]
    ds_read_b64_tr_b16 v[22:23], v2 offset:27648
    v_mfma_f32_16x16x32_bf16 v[164:167], v[28:31], a[124:127], v[164:167]
    buffer_load_dwordx4 v6, s[12:15], s64 offen offset:2048  lds
    v_max_f32 v12, 897988541, v12
    v_mfma_f32_16x16x32_bf16 v[164:167], v[24:27], a[108:111], v[164:167]
    v_max_f32 v13, 897988541, v13
    s_waitcnt lgkmcnt(4)
    v_mfma_f32_16x16x32_bf16 v[40:43], v[32:35], a[128:131], v[40:43]
    ds_read_b64_tr_b16 v[24:25], v3 offset:16384
    v_mfma_f32_16x16x32_bf16 v[40:43], v[36:39], a[144:147], v[40:43]
    buffer_load_dwordx4 v6, s[8:11], s65 offen offset:1024  lds
    v_add_f32 v12, v12, v14
    v_mfma_f32_16x16x32_bf16 v[44:47], v[36:39], a[148:151], v[44:47]
    ds_read_b64_tr_b16 v[26:27], v3 offset:17408
    v_add_f32 v13, v13, v15
    v_mfma_f32_16x16x32_bf16 v[44:47], v[32:35], a[132:135], v[44:47]
    buffer_load_dwordx4 v6, s[12:15], s65 offen offset:3072  lds
    v_mfma_f32_16x16x32_bf16 v[48:51], v[32:35], a[136:139], v[48:51]
    ds_read_b64_tr_b16 v[28:29], v3 offset:24576
    v_cvt_pk_bf16_f32 v233, v12, v13
    v_mfma_f32_16x16x32_bf16 v[48:51], v[36:39], a[152:155], v[48:51]
    ds_read_b64_tr_b16 v[30:31], v3 offset:25600
    v_lshlrev_b32 v12, 16, v236
    v_mfma_f32_16x16x32_bf16 v[52:55], v[36:39], a[156:159], v[52:55]
    v_and_b32 v13, 0xffff0000, v236
    v_mfma_f32_16x16x32_bf16 v[52:55], v[32:35], a[140:143], v[52:55]
    v_mul_f32 v14, 1069066811, v12
    s_waitcnt lgkmcnt(4)
    v_mfma_f32_16x16x32_bf16 v[56:59], v[16:19], a[128:131], v[56:59]
    ds_read_b64_tr_b16 v[32:33], v3 offset:18432
    v_mul_f32 v15, 1069066811, v13
    v_mfma_f32_16x16x32_bf16 v[56:59], v[20:23], a[144:147], v[56:59]
    v_exp_f32_e64 v14, v14 clamp
    v_mfma_f32_16x16x32_bf16 v[60:63], v[20:23], a[148:151], v[60:63]
    ds_read_b64_tr_b16 v[34:35], v3 offset:19456
    v_mfma_f32_16x16x32_bf16 v[60:63], v[16:19], a[132:135], v[60:63]
    s_waitcnt vmcnt(7)
    v_cmp_ne_u32 vcc, s1, v1
    v_mfma_f32_16x16x32_bf16 v[64:67], v[16:19], a[136:139], v[64:67]
    ds_read_b64_tr_b16 v[36:37], v3 offset:26624
    v_mfma_f32_16x16x32_bf16 v[64:67], v[20:23], a[152:155], v[64:67]
    ds_read_b64_tr_b16 v[38:39], v3 offset:27648
    s_mov_b32 s0, s0
    s_cbranch_vccnz L_slow_m1
L_ok_m1:
    v_mfma_f32_16x16x32_bf16 v[68:71], v[20:23], a[156:159], v[68:71]
    s_barrier
    v_mfma_f32_16x16x32_bf16 v[68:71], v[16:19], a[140:143], v[68:71]
    s_waitcnt lgkmcnt(4)
    v_mfma_f32_16x16x32_bf16 v[72:75], v[24:27], a[128:131], v[72:75]
    ds_read_b64_tr_b16 v[16:17], v4 offset:16384
    v_mfma_f32_16x16x32_bf16 v[72:75], v[28:31], a[144:147], v[72:75]
    v_exp_f32_e64 v15, v15 clamp
    v_mfma_f32_16x16x32_bf16 v[76:79], v[28:31], a[148:151], v[76:79]
    ds_read_b64_tr_b16 v[18:19], v4 offset:17408
    v_max_f32 v12, 897988541, v12
    v_mfma_f32_16x16x32_bf16 v[76:79], v[24:27], a[132:135], v[76:79]
    v_max_f32 v13, 897988541, v13
    v_add_f32 v12, v12, v14
    v_mfma_f32_16x16x32_bf16 v[80:83], v[24:27], a[136:139], v[80:83]
    ds_read_b64_tr_b16 v[20:21], v4 offset:24576
    v_add_f32 v13, v13, v15
    v_mfma_f32_16x16x32_bf16 v[80:83], v[28:31], a[152:155], v[80:83]
    ds_read_b64_tr_b16 v[22:23], v4 offset:25600
    v_cvt_pk_bf16_f32 v236, v12, v13
    v_mfma_f32_16x16x32_bf16 v[84:87], v[28:31], a[156:159], v[84:87]
    v_lshlrev_b32 v12, 16, v237
    v_mfma_f32_16x16x32_bf16 v[84:87], v[24:27], a[140:143], v[84:87]
    v_and_b32 v13, 0xffff0000, v237
    s_waitcnt lgkmcnt(4)
    v_mfma_f32_16x16x32_bf16 v[88:91], v[32:35], a[128:131], v[88:91]
    ds_read_b64_tr_b16 v[24:25], v4 offset:18432
    v_mfma_f32_16x16x32_bf16 v[88:91], v[36:39], a[144:147], v[88:91]
    v_mul_f32 v14, 1069066811, v12
    v_mfma_f32_16x16x32_bf16 v[92:95], v[36:39], a[148:151], v[92:95]
    ds_read_b64_tr_b16 v[26:27], v4 offset:19456
    v_mul_f32 v15, 1069066811, v13
    v_mfma_f32_16x16x32_bf16 v[92:95], v[32:35], a[132:135], v[92:95]
    v_exp_f32_e64 v14, v14 clamp
    v_mfma_f32_16x16x32_bf16 v[96:99], v[32:35], a[136:139], v[96:99]
    ds_read_b64_tr_b16 v[28:29], v4 offset:26624
    s_add_u32 m0, s26, 36864
    v_mfma_f32_16x16x32_bf16 v[96:99], v[36:39], a[152:155], v[96:99]
    ds_read_b64_tr_b16 v[30:31], v4 offset:27648
    s_mov_b32 s25, s22
    v_mfma_f32_16x16x32_bf16 v[100:103], v[36:39], a[156:159], v[100:103]
    v_exp_f32_e64 v15, v15 clamp
    v_mfma_f32_16x16x32_bf16 v[100:103], v[32:35], a[140:143], v[100:103]
    v_max_f32 v12, 897988541, v12
    s_waitcnt lgkmcnt(4)
    v_mfma_f32_16x16x32_bf16 v[104:107], v[16:19], a[128:131], v[104:107]
    ds_read_b64_tr_b16 v[32:33], v5 offset:16384
    v_max_f32 v13, 897988541, v13
    v_mfma_f32_16x16x32_bf16 v[104:107], v[20:23], a[144:147], v[104:107]
    v_add_f32 v12, v12, v14
    buffer_load_dwordx4 a[0:3], v11, s[16:19], s20 offen offset:0 sc1
    v_mfma_f32_16x16x32_bf16 v[108:111], v[20:23], a[148:151], v[108:111]
    ds_read_b64_tr_b16 v[34:35], v5 offset:17408
    buffer_load_dwordx4 v11, s[4:7], s25 offen offset:0 sc1 lds
    v_mfma_f32_16x16x32_bf16 v[108:111], v[16:19], a[132:135], v[108:111]
    v_add_f32 v13, v13, v15
    buffer_load_dwordx4 a[4:7], v11, s[16:19], s20 offen offset:1024 sc1
    v_mfma_f32_16x16x32_bf16 v[112:115], v[16:19], a[136:139], v[112:115]
    ds_read_b64_tr_b16 v[36:37], v5 offset:24576
    v_cvt_pk_bf16_f32 v237, v12, v13
    v_mfma_f32_16x16x32_bf16 v[112:115], v[20:23], a[152:155], v[112:115]
    ds_read_b64_tr_b16 v[38:39], v5 offset:25600
    s_add_u32 s25, s25, s23
    v_mfma_f32_16x16x32_bf16 v[116:119], v[20:23], a[156:159], v[116:119]
    v_lshlrev_b32 v12, 16, v240
    buffer_load_dwordx4 v11, s[4:7], s25 offen offset:1024 sc1 lds
    v_mfma_f32_16x16x32_bf16 v[116:119], v[16:19], a[140:143], v[116:119]
    v_and_b32 v13, 0xffff0000, v240
    s_waitcnt lgkmcnt(4)
    v_mfma_f32_16x16x32_bf16 v[120:123], v[24:27], a[128:131], v[120:123]
    ds_read_b64_tr_b16 v[16:17], v5 offset:18432
    s_add_u32 s25, s25, s23
    buffer_load_dwordx4 a[8:11], v11, s[16:19], s21 offen offset:0 sc1
    v_mfma_f32_16x16x32_bf16 v[120:123], v[28:31], a[144:147], v[120:123]
    v_mul_f32 v14, 1069066811, v12
    buffer_load_dwordx4 v11, s[4:7], s25 offen offset:2048 sc1 lds
    v_mfma_f32_16x16x32_bf16 v[124:127], v[28:31], a[148:151], v[124:127]
    ds_read_b64_tr_b16 v[18:19], v5 offset:19456
    v_mul_f32 v15, 1069066811, v13
    v_mfma_f32_16x16x32_bf16 v[124:127], v[24:27], a[132:135], v[124:127]
    v_exp_f32_e64 v14, v14 clamp
    v_mfma_f32_16x16x32_bf16 v[128:131], v[24:27], a[136:139], v[128:131]
    ds_read_b64_tr_b16 v[20:21], v5 offset:26624
    s_add_u32 s25, s25, s23
    v_mfma_f32_16x16x32_bf16 v[128:131], v[28:31], a[152:155], v[128:131]
    ds_read_b64_tr_b16 v[22:23], v5 offset:27648
    buffer_load_dwordx4 v11, s[4:7], s25 offen offset:3072 sc1 lds
    buffer_load_dwordx4 a[12:15], v11, s[16:19], s21 offen offset:1024 sc1
    v_mfma_f32_16x16x32_bf16 v[132:135], v[28:31], a[156:159], v[132:135]
    v_exp_f32_e64 v15, v15 clamp
    v_mfma_f32_16x16x32_bf16 v[132:135], v[24:27], a[140:143], v[132:135]
    s_barrier
    s_waitcnt lgkmcnt(4)
    v_mfma_f32_16x16x32_bf16 v[136:139], v[32:35], a[128:131], v[136:139]
    v_xor_b32 v2, 65536, v2
    v_max_f32 v12, 897988541, v12
    v_mfma_f32_16x16x32_bf16 v[136:139], v[36:39], a[144:147], v[136:139]
    v_xor_b32 v3, 65536, v3
    v_max_f32 v13, 897988541, v13
    s_add_u32 s20, s20, 2048
    v_mfma_f32_16x16x32_bf16 v[140:143], v[36:39], a[148:151], v[140:143]
    v_xor_b32 v4, 65536, v4
    v_add_f32 v12, v12, v14
    v_mfma_f32_16x16x32_bf16 v[140:143], v[32:35], a[132:135], v[140:143]
    v_xor_b32 v5, 65536, v5
    v_add_f32 v13, v13, v15
    v_mfma_f32_16x16x32_bf16 v[144:147], v[32:35], a[136:139], v[144:147]
    ds_read_b64_tr_b16 v[24:25], v2 offset:16384
    ds_read_b64_tr_b16 v[26:27], v2 offset:17408
    v_mfma_f32_16x16x32_bf16 v[144:147], v[36:39], a[152:155], v[144:147]
    ds_read_b64_tr_b16 v[28:29], v2 offset:24576
    v_cvt_pk_bf16_f32 v240, v12, v13
    s_add_u32 s21, s21, 2048
    v_mfma_f32_16x16x32_bf16 v[148:151], v[36:39], a[156:159], v[148:151]
    ds_read_b64_tr_b16 v[30:31], v2 offset:25600
    v_lshlrev_b32 v12, 16, v241
    v_mfma_f32_16x16x32_bf16 v[148:151], v[32:35], a[140:143], v[148:151]
    v_and_b32 v13, 0xffff0000, v241
    s_waitcnt lgkmcnt(4)
    v_mfma_f32_16x16x32_bf16 v[152:155], v[16:19], a[128:131], v[152:155]
    ds_read_b64_tr_b16 v[32:33], v2 offset:18432
    s_add_u32 m0, s26, 40960
    v_mfma_f32_16x16x32_bf16 v[152:155], v[20:23], a[144:147], v[152:155]
    v_mul_f32 v14, 1069066811, v12
    s_add_u32 s25, s25, s24
    v_mfma_f32_16x16x32_bf16 v[156:159], v[20:23], a[148:151], v[156:159]
    ds_read_b64_tr_b16 v[34:35], v2 offset:19456
    v_mul_f32 v15, 1069066811, v13
    v_mfma_f32_16x16x32_bf16 v[156:159], v[16:19], a[132:135], v[156:159]
    v_exp_f32_e64 v14, v14 clamp
    v_mfma_f32_16x16x32_bf16 v[160:163], v[16:19], a[136:139], v[160:163]
    ds_read_b64_tr_b16 v[36:37], v2 offset:26624
    buffer_load_dwordx4 v11, s[4:7], s25 offen offset:0 sc1 lds
    v_mfma_f32_16x16x32_bf16 v[160:163], v[20:23], a[152:155], v[160:163]
    ds_read_b64_tr_b16 v[38:39], v2 offset:27648
    s_add_u32 s25, s25, s23
    v_mfma_f32_16x16x32_bf16 v[164:167], v[20:23], a[156:159], v[164:167]
    v_exp_f32_e64 v15, v15 clamp
    v_mfma_f32_16x16x32_bf16 v[164:167], v[16:19], a[140:143], v[164:167]
    v_max_f32 v12, 897988541, v12
    s_waitcnt lgkmcnt(4)
    v_mfma_f32_16x16x32_bf16 v[40:43], v[24:27], a[160:163], v[40:43]
    ds_read_b64_tr_b16 v[16:17], v3 offset:16384
    v_max_f32 v13, 897988541, v13
    v_mfma_f32_16x16x32_bf16 v[40:43], v[28:31], a[176:179], v[40:43]
    v_add_f32 v12, v12, v14
    buffer_load_dwordx4 v11, s[4:7], s25 offen offset:1024 sc1 lds
    v_mfma_f32_16x16x32_bf16 v[44:47], v[28:31], a[180:183], v[44:47]
    ds_read_b64_tr_b16 v[18:19], v3 offset:17408
    buffer_load_dwordx4 a[16:19], v11, s[16:19], s20 offen offset:0 sc1
    v_mfma_f32_16x16x32_bf16 v[44:47], v[24:27], a[164:167], v[44:47]
    v_add_f32 v13, v13, v15
    s_add_u32 s25, s25, s23
    v_mfma_f32_16x16x32_bf16 v[48:51], v[24:27], a[168:171], v[48:51]
    ds_read_b64_tr_b16 v[20:21], v3 offset:24576
    v_cvt_pk_bf16_f32 v241, v12, v13
    v_mfma_f32_16x16x32_bf16 v[48:51], v[28:31], a[184:187], v[48:51]
    ds_read_b64_tr_b16 v[22:23], v3 offset:25600
    buffer_load_dwordx4 a[20:23], v11, s[16:19], s20 offen offset:1024 sc1
    v_mfma_f32_16x16x32_bf16 v[52:55], v[28:31], a[188:191], v[52:55]
    v_lshlrev_b32 v12, 16, v244
    buffer_load_dwordx4 v11, s[4:7], s25 offen offset:2048 sc1 lds
    v_mfma_f32_16x16x32_bf16 v[52:55], v[24:27], a[172:175], v[52:55]
    v_and_b32 v13, 0xffff0000, v244
    s_waitcnt lgkmcnt(4)
    v_mfma_f32_16x16x32_bf16 v[56:59], v[32:35], a[160:163], v[56:59]
    ds_read_b64_tr_b16 v[24:25], v3 offset:18432
    s_add_u32 s25, s25, s23
    v_mfma_f32_16x16x32_bf16 v[56:59], v[36:39], a[176:179], v[56:59]
    v_mul_f32 v14, 1069066811, v12
    buffer_load_dwordx4 a[24:27], v11, s[16:19], s21 offen offset:0 sc1
    v_mfma_f32_16x16x32_bf16 v[60:63], v[36:39], a[180:183], v[60:63]
    ds_read_b64_tr_b16 v[26:27], v3 offset:19456
    v_mul_f32 v15, 1069066811, v13
    v_mfma_f32_16x16x32_bf16 v[60:63], v[32:35], a[164:167], v[60:63]
    v_exp_f32_e64 v14, v14 clamp
    v_mfma_f32_16x16x32_bf16 v[64:67], v[32:35], a[168:171], v[64:67]
    ds_read_b64_tr_b16 v[28:29], v3 offset:26624
    buffer_load_dwordx4 v11, s[4:7], s25 offen offset:3072 sc1 lds
    v_mfma_f32_16x16x32_bf16 v[64:67], v[36:39], a[184:187], v[64:67]
    ds_read_b64_tr_b16 v[30:31], v3 offset:27648
    s_add_u32 m0, s26, 45056
    v_mfma_f32_16x16x32_bf16 v[68:71], v[36:39], a[188:191], v[68:71]
    v_exp_f32_e64 v15, v15 clamp
    v_mfma_f32_16x16x32_bf16 v[68:71], v[32:35], a[172:175], v[68:71]
    v_max_f32 v12, 897988541, v12
    s_waitcnt lgkmcnt(4)
    v_mfma_f32_16x16x32_bf16 v[72:75], v[16:19], a[160:163], v[72:75]
    ds_read_b64_tr_b16 v[32:33], v4 offset:16384
    v_max_f32 v13, 897988541, v13
    v_mfma_f32_16x16x32_bf16 v[72:75], v[20:23], a[176:179], v[72:75]
    v_add_f32 v12, v12, v14
    s_add_u32 s25, s25, s24
    v_mfma_f32_16x16x32_bf16 v[76:79], v[20:23], a[180:183], v[76:79]
    ds_read_b64_tr_b16 v[34:35], v4 offset:17408
    buffer_load_dwordx4 a[28:31], v11, s[16:19], s21 offen offset:1024 sc1
    v_mfma_f32_16x16x32_bf16 v[76:79], v[16:19], a[164:167], v[76:79]
    v_add_f32 v13, v13, v15
    buffer_load_dwordx4 v11, s[4:7], s25 offen offset:0 sc1 lds
    v_mfma_f32_16x16x32_bf16 v[80:83], v[16:19], a[168:171], v[80:83]
    ds_read_b64_tr_b16 v[36:37], v4 offset:24576
    v_cvt_pk_bf16_f32 v244, v12, v13
    v_mfma_f32_16x16x32_bf16 v[80:83], v[20:23], a[184:187], v[80:83]
    ds_read_b64_tr_b16 v[38:39], v4 offset:25600
    s_add_u32 s20, s20, 2048
    v_mfma_f32_16x16x32_bf16 v[84:87], v[20:23], a[188:191], v[84:87]
    v_lshlrev_b32 v12, 16, v245
    s_add_u32 s22, s22, 147456
    v_mfma_f32_16x16x32_bf16 v[84:87], v[16:19], a[172:175], v[84:87]
    v_and_b32 v13, 0xffff0000, v245
    s_waitcnt lgkmcnt(4)
    v_mfma_f32_16x16x32_bf16 v[88:91], v[24:27], a[160:163], v[88:91]
    ds_read_b64_tr_b16 v[16:17], v4 offset:18432
    s_add_u32 s21, s21, 2048
    v_mfma_f32_16x16x32_bf16 v[88:91], v[28:31], a[176:179], v[88:91]
    v_mul_f32 v14, 1069066811, v12
    v_mfma_f32_16x16x32_bf16 v[92:95], v[28:31], a[180:183], v[92:95]
    ds_read_b64_tr_b16 v[18:19], v4 offset:19456
    v_mul_f32 v15, 1069066811, v13
    v_mfma_f32_16x16x32_bf16 v[92:95], v[24:27], a[164:167], v[92:95]
    v_exp_f32_e64 v14, v14 clamp
    v_mfma_f32_16x16x32_bf16 v[96:99], v[24:27], a[168:171], v[96:99]
    ds_read_b64_tr_b16 v[20:21], v4 offset:26624
    s_add_u32 m0, s60, 147456
    v_mfma_f32_16x16x32_bf16 v[96:99], v[28:31], a[184:187], v[96:99]
    ds_read_b64_tr_b16 v[22:23], v4 offset:27648
    v_mfma_f32_16x16x32_bf16 v[100:103], v[28:31], a[188:191], v[100:103]
    v_exp_f32_e64 v15, v15 clamp
    v_mfma_f32_16x16x32_bf16 v[100:103], v[24:27], a[172:175], v[100:103]
    s_add_u32 s64, s61, 4722688
    s_waitcnt lgkmcnt(4)
    v_mfma_f32_16x16x32_bf16 v[104:107], v[32:35], a[160:163], v[104:107]
    ds_read_b64_tr_b16 v[24:25], v5 offset:16384
    v_max_f32 v12, 897988541, v12
    v_mfma_f32_16x16x32_bf16 v[104:107], v[36:39], a[176:179], v[104:107]
    v_max_f32 v13, 897988541, v13
    buffer_load_dwordx4 a[32:35], v11, s[16:19], s20 offen offset:0 sc1
    v_mfma_f32_16x16x32_bf16 v[108:111], v[36:39], a[180:183], v[108:111]
    ds_read_b64_tr_b16 v[26:27], v5 offset:17408
    v_add_f32 v12, v12, v14
    v_mfma_f32_16x16x32_bf16 v[108:111], v[32:35], a[164:167], v[108:111]
    buffer_load_dwordx4 v6, s[8:11], s64 offen  lds
    v_add_f32 v13, v13, v15
    v_mfma_f32_16x16x32_bf16 v[112:115], v[32:35], a[168:171], v[112:115]
    ds_read_b64_tr_b16 v[28:29], v5 offset:24576
    buffer_load_dwordx4 a[36:39], v11, s[16:19], s20 offen offset:1024 sc1
    v_mfma_f32_16x16x32_bf16 v[112:115], v[36:39], a[184:187], v[112:115]
    ds_read_b64_tr_b16 v[30:31], v5 offset:25600
    v_cvt_pk_bf16_f32 v245, v12, v13
    v_mfma_f32_16x16x32_bf16 v[116:119], v[36:39], a[188:191], v[116:119]
    s_add_u32 s65, s61, 4758528
    s_lshl_b32 s3, s54, 2
    v_mfma_f32_16x16x32_bf16 v[116:119], v[32:35], a[172:175], v[116:119]
    s_add_u32 s3, s3, s57
    s_waitcnt lgkmcnt(4)
    v_mfma_f32_16x16x32_bf16 v[120:123], v[16:19], a[160:163], v[120:123]
    ds_read_b64_tr_b16 v[32:33], v5 offset:18432
    s_lshl_b32 s3, s3, 6
    v_mfma_f32_16x16x32_bf16 v[120:123], v[20:23], a[176:179], v[120:123]
    buffer_load_dwordx4 v6, s[12:15], s64 offen offset:2048  lds
    s_add_u32 s3, s3, 145408
    v_mfma_f32_16x16x32_bf16 v[124:127], v[20:23], a[180:183], v[124:127]
    ds_read_b64_tr_b16 v[34:35], v5 offset:19456
    v_bfe_u32 v14, v11, 2, 6
    v_mfma_f32_16x16x32_bf16 v[124:127], v[16:19], a[164:167], v[124:127]
    v_add_u32 v14, s3, v14
    v_xor_b32 v15, 0x80, v14
    buffer_load_dwordx4 a[40:43], v11, s[16:19], s21 offen offset:0 sc1
    v_mfma_f32_16x16x32_bf16 v[128:131], v[16:19], a[168:171], v[128:131]
    ds_read_b64_tr_b16 v[36:37], v5 offset:26624
    buffer_load_dwordx4 v6, s[8:11], s65 offen offset:1024  lds
    v_mfma_f32_16x16x32_bf16 v[128:131], v[20:23], a[184:187], v[128:131]
    ds_read_b64_tr_b16 v[38:39], v5 offset:27648
    v_cndmask_b32 v234, 0, v234, s[50:51]
    v_mfma_f32_16x16x32_bf16 v[132:135], v[20:23], a[188:191], v[132:135]
    v_lshlrev_b32 v12, 16, v235
    v_mul_f32 v12, 3216550459, v12
L_wm6:
    s_cbranch_execz L_wm10
    v_mfma_f32_16x16x32_bf16 v[132:135], v[16:19], a[172:175], v[132:135]
    s_waitcnt vmcnt(28)
    s_barrier
    s_waitcnt lgkmcnt(4)
    v_mfma_f32_16x16x32_bf16 v[136:139], v[24:27], a[160:163], v[136:139]
    ds_read_b64_tr_b16 v[16:17], v2 offset:32768
    buffer_load_dwordx4 v6, s[12:15], s65 offen offset:3072  lds
    buffer_load_dwordx4 a[44:47], v11, s[16:19], s21 offen offset:1024 sc1
    v_mfma_f32_16x16x32_bf16 v[136:139], v[28:31], a[176:179], v[136:139]
    v_exp_f32 v12, v12
    v_mfma_f32_16x16x32_bf16 v[140:143], v[28:31], a[180:183], v[140:143]
    ds_read_b64_tr_b16 v[18:19], v2 offset:33792
    v_add_f32 v12, 1.0, v12
    v_mfma_f32_16x16x32_bf16 v[140:143], v[24:27], a[164:167], v[140:143]
    v_rcp_f32 v12, v12
    s_nop 0
    v_cvt_pk_bf16_f32 v12, v12, v12
    v_mfma_f32_16x16x32_bf16 v[144:147], v[24:27], a[168:171], v[144:147]
    ds_read_b64_tr_b16 v[20:21], v2 offset:40960
    v_and_b32 v235, 0xffff0000, v12
    v_mfma_f32_16x16x32_bf16 v[144:147], v[28:31], a[184:187], v[144:147]
    ds_read_b64_tr_b16 v[22:23], v2 offset:41984
    v_sub_f32 v252, 1.0, v235
    s_add_u32 s20, s20, 2048
    v_mfma_f32_16x16x32_bf16 v[148:151], v[28:31], a[188:191], v[148:151]
    ds_write_b32 v14, v252 offset:0
    v_cndmask_b32 v238, 0, v238, s[50:51]
    s_add_u32 m0, s26, 0
    v_mfma_f32_16x16x32_bf16 v[148:151], v[24:27], a[172:175], v[148:151]
    v_lshlrev_b32 v12, 16, v239
    s_waitcnt lgkmcnt(5)
    v_mfma_f32_16x16x32_bf16 v[152:155], v[32:35], a[160:163], v[152:155]
    ds_read_b64_tr_b16 v[24:25], v2 offset:34816
    v_mul_f32 v12, 3216550459, v12
    v_mfma_f32_16x16x32_bf16 v[152:155], v[36:39], a[176:179], v[152:155]
    v_exp_f32 v12, v12
    s_mov_b32 s25, s22
    v_mfma_f32_16x16x32_bf16 v[156:159], v[36:39], a[180:183], v[156:159]
    ds_read_b64_tr_b16 v[26:27], v2 offset:35840
    v_add_f32 v12, 1.0, v12
    v_mfma_f32_16x16x32_bf16 v[156:159], v[32:35], a[164:167], v[156:159]
    v_rcp_f32 v12, v12
    s_add_u32 s21, s21, 2048
    v_mfma_f32_16x16x32_bf16 v[160:163], v[32:35], a[168:171], v[160:163]
    ds_read_b64_tr_b16 v[28:29], v2 offset:43008
    v_cvt_pk_bf16_f32 v12, v12, v12
    v_mfma_f32_16x16x32_bf16 v[160:163], v[36:39], a[184:187], v[160:163]
    ds_read_b64_tr_b16 v[30:31], v2 offset:44032
    v_and_b32 v239, 0xffff0000, v12
    v_mfma_f32_16x16x32_bf16 v[164:167], v[36:39], a[188:191], v[164:167]
    v_sub_f32 v253, 1.0, v239
    buffer_load_dwordx4 v11, s[4:7], s25 offen offset:0 sc1 lds
    v_mfma_f32_16x16x32_bf16 v[164:167], v[32:35], a[172:175], v[164:167]
    ds_write_b32 v14, v253 offset:64
    s_waitcnt lgkmcnt(6)
    v_mfma_f32_16x16x32_bf16 v[40:43], v[16:19], a[192:195], v[40:43]
    ds_read_b64_tr_b16 v[32:33], v3 offset:32768
    v_cndmask_b32 v242, 0, v242, s[50:51]
    s_add_u32 s25, s25, s23
    v_mfma_f32_16x16x32_bf16 v[40:43], v[20:23], a[208:211], v[40:43]
    v_lshlrev_b32 v12, 16, v243
    s_lshl_b32 s76, s55, 2
    v_mfma_f32_16x16x32_bf16 v[44:47], v[20:23], a[212:215], v[44:47]
    ds_read_b64_tr_b16 v[34:35], v3 offset:33792
    v_mul_f32 v12, 3216550459, v12
    s_add_u32 s76, s76, s54
    v_mfma_f32_16x16x32_bf16 v[44:47], v[16:19], a[196:199], v[44:47]
    v_exp_f32 v12, v12
    buffer_load_dwordx4 v11, s[4:7], s25 offen offset:1024 sc1 lds
    v_mfma_f32_16x16x32_bf16 v[48:51], v[16:19], a[200:203], v[48:51]
    ds_read_b64_tr_b16 v[36:37], v3 offset:40960
    v_add_f32 v12, 1.0, v12
    s_lshl_b32 s76, s76, 13
    v_mfma_f32_16x16x32_bf16 v[48:51], v[20:23], a[216:219], v[48:51]
    ds_read_b64_tr_b16 v[38:39], v3 offset:41984
    v_rcp_f32 v12, v12
    v_mfma_f32_16x16x32_bf16 v[52:55], v[20:23], a[220:223], v[52:55]
    v_cvt_pk_bf16_f32 v12, v12, v12
    v_and_b32 v243, 0xffff0000, v12
    s_add_u32 s76, s76, 29360128
    v_mfma_f32_16x16x32_bf16 v[52:55], v[16:19], a[204:207], v[52:55]
    v_sub_f32 v254, 1.0, v243
    s_add_u32 s77, s76, 4096
    s_waitcnt lgkmcnt(5)
    v_mfma_f32_16x16x32_bf16 v[56:59], v[24:27], a[192:195], v[56:59]
    ds_read_b64_tr_b16 v[16:17], v3 offset:34816
    ds_write_b32 v15, v254 offset:0
    buffer_load_dwordx4 v[168:171], v11, s[16:19], s76 offen offset:0 sc1
    v_mfma_f32_16x16x32_bf16 v[56:59], v[28:31], a[208:211], v[56:59]
    v_cndmask_b32 v246, 0, v246, s[50:51]
    v_lshlrev_b32 v12, 16, v247
    buffer_load_dwordx4 v[172:175], v11, s[16:19], s76 offen offset:1024 sc1
    v_mfma_f32_16x16x32_bf16 v[60:63], v[28:31], a[212:215], v[60:63]
    ds_read_b64_tr_b16 v[18:19], v3 offset:35840
    v_mul_f32 v12, 3216550459, v12
    v_mfma_f32_16x16x32_bf16 v[60:63], v[24:27], a[196:199], v[60:63]
    v_exp_f32 v12, v12
    buffer_load_dwordx4 v[176:179], v11, s[16:19], s76 offen offset:2048 sc1
    v_mfma_f32_16x16x32_bf16 v[64:67], v[24:27], a[200:203], v[64:67]
    ds_read_b64_tr_b16 v[20:21], v3 offset:43008
    buffer_load_dwordx4 v[180:183], v11, s[16:19], s76 offen offset:3072 sc1
    v_mfma_f32_16x16x32_bf16 v[64:67], v[28:31], a[216:219], v[64:67]
    ds_read_b64_tr_b16 v[22:23], v3 offset:44032
    v_add_f32 v12, 1.0, v12
    buffer_load_dwordx4 v[184:187], v11, s[16:19], s77 offen offset:0 sc1
    v_mfma_f32_16x16x32_bf16 v[68:71], v[28:31], a[220:223], v[68:71]
    v_rcp_f32 v12, v12
    v_mfma_f32_16x16x32_bf16 v[68:71], v[24:27], a[204:207], v[68:71]
    v_cvt_pk_bf16_f32 v12, v12, v12
    buffer_load_dwordx4 v[188:191], v11, s[16:19], s77 offen offset:1024 sc1
    s_waitcnt lgkmcnt(5)
    v_mfma_f32_16x16x32_bf16 v[72:75], v[32:35], a[192:195], v[72:75]
    ds_read_b64_tr_b16 v[24:25], v4 offset:32768
    v_and_b32 v247, 0xffff0000, v12
    buffer_load_dwordx4 v[192:195], v11, s[16:19], s77 offen offset:2048 sc1
    v_mfma_f32_16x16x32_bf16 v[72:75], v[36:39], a[208:211], v[72:75]
    v_sub_f32 v255, 1.0, v247
    buffer_load_dwordx4 v[196:199], v11, s[16:19], s77 offen offset:3072 sc1
    v_mfma_f32_16x16x32_bf16 v[76:79], v[36:39], a[212:215], v[76:79]
    ds_read_b64_tr_b16 v[26:27], v4 offset:33792
    ds_write_b32 v15, v255 offset:64
    v_mfma_f32_16x16x32_bf16 v[76:79], v[32:35], a[196:199], v[76:79]
    s_add_u32 s25, s25, s23
    buffer_load_dwordx4 v11, s[4:7], s25 offen offset:2048 sc1 lds
    v_mfma_f32_16x16x32_bf16 v[80:83], v[32:35], a[200:203], v[80:83]
    ds_read_b64_tr_b16 v[28:29], v4 offset:40960
    s_add_u32 s25, s25, s23
    v_mfma_f32_16x16x32_bf16 v[80:83], v[36:39], a[216:219], v[80:83]
    ds_read_b64_tr_b16 v[30:31], v4 offset:41984
    buffer_load_dwordx4 v11, s[4:7], s25 offen offset:3072 sc1 lds
    v_mfma_f32_16x16x32_bf16 v[84:87], v[36:39], a[220:223], v[84:87]
    s_add_u32 m0, s26, 4096
    v_mfma_f32_16x16x32_bf16 v[84:87], v[32:35], a[204:207], v[84:87]
    s_waitcnt lgkmcnt(5)
    v_mfma_f32_16x16x32_bf16 v[88:91], v[16:19], a[192:195], v[88:91]
    ds_read_b64_tr_b16 v[32:33], v4 offset:34816
    s_add_u32 s25, s25, s24
    v_mfma_f32_16x16x32_bf16 v[88:91], v[20:23], a[208:211], v[88:91]
    v_mfma_f32_16x16x32_bf16 v[92:95], v[20:23], a[212:215], v[92:95]
    ds_read_b64_tr_b16 v[34:35], v4 offset:35840
    v_mfma_f32_16x16x32_bf16 v[92:95], v[16:19], a[196:199], v[92:95]
    buffer_load_dwordx4 v11, s[4:7], s25 offen offset:0 sc1 lds
    v_mfma_f32_16x16x32_bf16 v[96:99], v[16:19], a[200:203], v[96:99]
    ds_read_b64_tr_b16 v[36:37], v4 offset:43008
    v_mfma_f32_16x16x32_bf16 v[96:99], v[20:23], a[216:219], v[96:99]
    ds_read_b64_tr_b16 v[38:39], v4 offset:44032
    v_mfma_f32_16x16x32_bf16 v[100:103], v[20:23], a[220:223], v[100:103]
    s_add_u32 s25, s25, s23
    v_mfma_f32_16x16x32_bf16 v[100:103], v[16:19], a[204:207], v[100:103]
    s_waitcnt lgkmcnt(4)
    v_mfma_f32_16x16x32_bf16 v[104:107], v[24:27], a[192:195], v[104:107]
    ds_read_b64_tr_b16 v[16:17], v5 offset:32768
    buffer_load_dwordx4 a[48:51], v11, s[16:19], s20 offen offset:0 sc1
    v_mfma_f32_16x16x32_bf16 v[104:107], v[28:31], a[208:211], v[104:107]
    buffer_load_dwordx4 v11, s[4:7], s25 offen offset:1024 sc1 lds
    v_mfma_f32_16x16x32_bf16 v[108:111], v[28:31], a[212:215], v[108:111]
    ds_read_b64_tr_b16 v[18:19], v5 offset:33792
    v_mfma_f32_16x16x32_bf16 v[108:111], v[24:27], a[196:199], v[108:111]
    v_mfma_f32_16x16x32_bf16 v[112:115], v[24:27], a[200:203], v[112:115]
    ds_read_b64_tr_b16 v[20:21], v5 offset:40960
    v_mfma_f32_16x16x32_bf16 v[112:115], v[28:31], a[216:219], v[112:115]
    ds_read_b64_tr_b16 v[22:23], v5 offset:41984
    s_add_u32 s25, s25, s23
    v_mfma_f32_16x16x32_bf16 v[116:119], v[28:31], a[220:223], v[116:119]
    buffer_load_dwordx4 a[52:55], v11, s[16:19], s20 offen offset:1024 sc1
    v_mfma_f32_16x16x32_bf16 v[116:119], v[24:27], a[204:207], v[116:119]
    s_waitcnt lgkmcnt(4)
    v_mfma_f32_16x16x32_bf16 v[120:123], v[32:35], a[192:195], v[120:123]
    ds_read_b64_tr_b16 v[24:25], v5 offset:34816
    v_mfma_f32_16x16x32_bf16 v[120:123], v[36:39], a[208:211], v[120:123]
    buffer_load_dwordx4 v11, s[4:7], s25 offen offset:2048 sc1 lds
    v_mfma_f32_16x16x32_bf16 v[124:127], v[36:39], a[212:215], v[124:127]
    ds_read_b64_tr_b16 v[26:27], v5 offset:35840
    v_mfma_f32_16x16x32_bf16 v[124:127], v[32:35], a[196:199], v[124:127]
    buffer_load_dwordx4 a[56:59], v11, s[16:19], s21 offen offset:0 sc1
    v_mfma_f32_16x16x32_bf16 v[128:131], v[32:35], a[200:203], v[128:131]
    ds_read_b64_tr_b16 v[28:29], v5 offset:43008
    s_add_u32 s25, s25, s23
    v_mfma_f32_16x16x32_bf16 v[128:131], v[36:39], a[216:219], v[128:131]
    ds_read_b64_tr_b16 v[30:31], v5 offset:44032
    v_mfma_f32_16x16x32_bf16 v[132:135], v[36:39], a[220:223], v[132:135]
    buffer_load_dwordx4 v11, s[4:7], s25 offen offset:3072 sc1 lds
    v_mfma_f32_16x16x32_bf16 v[132:135], v[32:35], a[204:207], v[132:135]
    s_waitcnt vmcnt(44)
    s_barrier
    s_waitcnt lgkmcnt(4)
    v_mfma_f32_16x16x32_bf16 v[136:139], v[16:19], a[192:195], v[136:139]
    ds_read_b64_tr_b16 v[32:33], v2 offset:49152
    buffer_load_dwordx4 a[60:63], v11, s[16:19], s21 offen offset:1024 sc1
    v_mfma_f32_16x16x32_bf16 v[136:139], v[20:23], a[208:211], v[136:139]
    v_mfma_f32_16x16x32_bf16 v[140:143], v[20:23], a[212:215], v[140:143]
    ds_read_b64_tr_b16 v[34:35], v2 offset:50176
    v_mfma_f32_16x16x32_bf16 v[140:143], v[16:19], a[196:199], v[140:143]
    s_add_u32 m0, s26, 8192
    v_mfma_f32_16x16x32_bf16 v[144:147], v[16:19], a[200:203], v[144:147]
    ds_read_b64_tr_b16 v[36:37], v2 offset:57344
    v_mfma_f32_16x16x32_bf16 v[144:147], v[20:23], a[216:219], v[144:147]
    ds_read_b64_tr_b16 v[38:39], v2 offset:58368
    s_add_u32 s20, s20, 2048
    v_mfma_f32_16x16x32_bf16 v[148:151], v[20:23], a[220:223], v[148:151]
    s_add_u32 s25, s25, s24
    v_mfma_f32_16x16x32_bf16 v[148:151], v[16:19], a[204:207], v[148:151]
    s_waitcnt lgkmcnt(4)
    v_mfma_f32_16x16x32_bf16 v[152:155], v[24:27], a[192:195], v[152:155]
    ds_read_b64_tr_b16 v[16:17], v2 offset:51200
    v_mfma_f32_16x16x32_bf16 v[152:155], v[28:31], a[208:211], v[152:155]
    buffer_load_dwordx4 v11, s[4:7], s25 offen offset:0 sc1 lds
    v_mfma_f32_16x16x32_bf16 v[156:159], v[28:31], a[212:215], v[156:159]
    ds_read_b64_tr_b16 v[18:19], v2 offset:52224
    v_mfma_f32_16x16x32_bf16 v[156:159], v[24:27], a[196:199], v[156:159]
    s_add_u32 s21, s21, 2048
    v_mfma_f32_16x16x32_bf16 v[160:163], v[24:27], a[200:203], v[160:163]
    ds_read_b64_tr_b16 v[20:21], v2 offset:59392
    v_mfma_f32_16x16x32_bf16 v[160:163], v[28:31], a[216:219], v[160:163]
    ds_read_b64_tr_b16 v[22:23], v2 offset:60416
    s_add_u32 s22, s22, 147456
    v_mfma_f32_16x16x32_bf16 v[164:167], v[28:31], a[220:223], v[164:167]
    v_mfma_f32_16x16x32_bf16 v[164:167], v[24:27], a[204:207], v[164:167]
    s_waitcnt lgkmcnt(4)
    v_mfma_f32_16x16x32_bf16 v[40:43], v[32:35], a[224:227], v[40:43]
    ds_read_b64_tr_b16 v[24:25], v3 offset:49152
    v_mfma_f32_16x16x32_bf16 v[40:43], v[36:39], a[240:243], v[40:43]
    v_mfma_f32_16x16x32_bf16 v[44:47], v[36:39], a[244:247], v[44:47]
    ds_read_b64_tr_b16 v[26:27], v3 offset:50176
    v_mfma_f32_16x16x32_bf16 v[44:47], v[32:35], a[228:231], v[44:47]
    v_mfma_f32_16x16x32_bf16 v[48:51], v[32:35], a[232:235], v[48:51]
    ds_read_b64_tr_b16 v[28:29], v3 offset:57344
    v_mfma_f32_16x16x32_bf16 v[48:51], v[36:39], a[248:251], v[48:51]
    ds_read_b64_tr_b16 v[30:31], v3 offset:58368
    v_mfma_f32_16x16x32_bf16 v[52:55], v[36:39], a[252:255], v[52:55]
    buffer_load_dwordx4 a[64:67], v11, s[16:19], s20 offen offset:0 sc1
    buffer_load_dwordx4 a[68:71], v11, s[16:19], s20 offen offset:1024 sc1
    v_mfma_f32_16x16x32_bf16 v[52:55], v[32:35], a[236:239], v[52:55]
    buffer_load_dwordx4 a[72:75], v11, s[16:19], s21 offen offset:0 sc1
    s_waitcnt lgkmcnt(4)
    v_mfma_f32_16x16x32_bf16 v[56:59], v[16:19], a[224:227], v[56:59]
    ds_read_b64_tr_b16 v[32:33], v3 offset:51200
    s_waitcnt vmcnt(20)
    v_min_u32 v12, v171, v175
    v_mfma_f32_16x16x32_bf16 v[56:59], v[20:23], a[240:243], v[56:59]
    v_max_u32 v13, v171, v175
    s_waitcnt vmcnt(18)
    v_min3_u32 v12, v179, v183, v12
    v_mfma_f32_16x16x32_bf16 v[60:63], v[20:23], a[244:247], v[60:63]
    ds_read_b64_tr_b16 v[34:35], v3 offset:52224
    v_max3_u32 v13, v179, v183, v13
    s_waitcnt vmcnt(16)
    v_min3_u32 v12, v187, v191, v12
    v_mfma_f32_16x16x32_bf16 v[60:63], v[16:19], a[228:231], v[60:63]
    v_max3_u32 v13, v187, v191, v13
    s_waitcnt vmcnt(14)
    v_min3_u32 v12, v195, v199, v12
    v_mfma_f32_16x16x32_bf16 v[64:67], v[16:19], a[232:235], v[64:67]
    ds_read_b64_tr_b16 v[36:37], v3 offset:59392
    v_max3_u32 v13, v195, v199, v13
    v_mfma_f32_16x16x32_bf16 v[64:67], v[20:23], a[248:251], v[64:67]
    ds_read_b64_tr_b16 v[38:39], v3 offset:60416
    v_xor_b32 v12, s80, v12
    v_xor_b32 v13, s80, v13
    v_mfma_f32_16x16x32_bf16 v[68:71], v[20:23], a[252:255], v[68:71]
    v_or_b32 v12, v12, v13
    v_cmp_ne_u32 vcc, 0, v12
    v_mfma_f32_16x16x32_bf16 v[68:71], v[16:19], a[236:239], v[68:71]
    buffer_load_dwordx4 a[76:79], v11, s[16:19], s21 offen offset:1024 sc1
    s_waitcnt lgkmcnt(4)
    v_mfma_f32_16x16x32_bf16 v[72:75], v[24:27], a[224:227], v[72:75]
    ds_read_b64_tr_b16 v[16:17], v4 offset:49152
    s_mov_b32 s76, s76
    s_mov_b32 s77, s77
    s_cbranch_vccnz L_slow_kv
L_ok_kv:
    v_mfma_f32_16x16x32_bf16 v[72:75], v[28:31], a[240:243], v[72:75]
    s_mov_b32 s31, 0x04000c0c
    s_mov_b32 s81, 0x0706000c
    v_mfma_f32_16x16x32_bf16 v[76:79], v[28:31], a[244:247], v[76:79]
    ds_read_b64_tr_b16 v[18:19], v4 offset:50176
    v_perm_b32 v171, v168, v169, s31
    v_perm_b32 v171, v171, v170, s81
    v_mfma_f32_16x16x32_bf16 v[76:79], v[24:27], a[228:231], v[76:79]
    v_perm_b32 v175, v172, v173, s31
    v_perm_b32 v175, v175, v174, s81
    v_mfma_f32_16x16x32_bf16 v[80:83], v[24:27], a[232:235], v[80:83]
    ds_read_b64_tr_b16 v[20:21], v4 offset:57344
    v_perm_b32 v179, v176, v177, s31
    v_perm_b32 v179, v179, v178, s81
    v_mfma_f32_16x16x32_bf16 v[80:83], v[28:31], a[248:251], v[80:83]
    ds_read_b64_tr_b16 v[22:23], v4 offset:58368
    v_perm_b32 v183, v180, v181, s31
    v_perm_b32 v183, v183, v182, s81
    v_mfma_f32_16x16x32_bf16 v[84:87], v[28:31], a[252:255], v[84:87]
    v_perm_b32 v187, v184, v185, s31
    v_perm_b32 v187, v187, v186, s81
    v_mfma_f32_16x16x32_bf16 v[84:87], v[24:27], a[236:239], v[84:87]
    v_perm_b32 v191, v188, v189, s31
    v_perm_b32 v191, v191, v190, s81
    s_waitcnt lgkmcnt(4)
    v_mfma_f32_16x16x32_bf16 v[88:91], v[32:35], a[224:227], v[88:91]
    ds_read_b64_tr_b16 v[24:25], v4 offset:51200
    v_perm_b32 v195, v192, v193, s31
    v_perm_b32 v195, v195, v194, s81
    v_mfma_f32_16x16x32_bf16 v[88:91], v[36:39], a[240:243], v[88:91]
    v_perm_b32 v199, v196, v197, s31
    v_perm_b32 v199, v199, v198, s81
    v_mfma_f32_16x16x32_bf16 v[92:95], v[36:39], a[244:247], v[92:95]
    ds_read_b64_tr_b16 v[26:27], v4 offset:52224
    v_add_f32 v168, v168, v172
    v_add_f32 v169, v169, v173
    v_mfma_f32_16x16x32_bf16 v[92:95], v[32:35], a[228:231], v[92:95]
    v_add_f32 v170, v170, v174
    v_add_f32 v171, v171, v175
    s_add_u32 s20, s20, 2048
    v_mfma_f32_16x16x32_bf16 v[96:99], v[32:35], a[232:235], v[96:99]
    ds_read_b64_tr_b16 v[28:29], v4 offset:59392
    v_add_f32 v176, v176, v180
    v_add_f32 v177, v177, v181
    v_mfma_f32_16x16x32_bf16 v[96:99], v[36:39], a[248:251], v[96:99]
    ds_read_b64_tr_b16 v[30:31], v4 offset:60416
    v_add_f32 v178, v178, v182
    v_add_f32 v179, v179, v183
    v_mfma_f32_16x16x32_bf16 v[100:103], v[36:39], a[252:255], v[100:103]
    v_add_f32 v184, v184, v188
    v_add_f32 v185, v185, v189
    v_add_u32 v248, 0, v11
    v_mfma_f32_16x16x32_bf16 v[100:103], v[32:35], a[236:239], v[100:103]
    v_add_f32 v186, v186, v190
    v_add_f32 v187, v187, v191
    s_waitcnt lgkmcnt(4)
    v_mfma_f32_16x16x32_bf16 v[104:107], v[16:19], a[224:227], v[104:107]
    ds_read_b64_tr_b16 v[32:33], v5 offset:49152
    v_add_f32 v192, v192, v196
    v_add_f32 v193, v193, v197
    v_mfma_f32_16x16x32_bf16 v[104:107], v[20:23], a[240:243], v[104:107]
    v_add_f32 v194, v194, v198
    v_add_f32 v195, v195, v199
    s_add_u32 s21, s21, 2048
    v_mfma_f32_16x16x32_bf16 v[108:111], v[20:23], a[244:247], v[108:111]
    ds_read_b64_tr_b16 v[34:35], v5 offset:50176
    v_add_f32 v168, v168, v176
    v_add_f32 v169, v169, v177
    v_mfma_f32_16x16x32_bf16 v[108:111], v[16:19], a[228:231], v[108:111]
    v_add_f32 v170, v170, v178
    v_add_f32 v171, v171, v179
    v_add_u32 v249, 36864, v11
    v_mfma_f32_16x16x32_bf16 v[112:115], v[16:19], a[232:235], v[112:115]
    ds_read_b64_tr_b16 v[36:37], v5 offset:57344
    v_add_f32 v184, v184, v192
    v_add_f32 v185, v185, v193
    v_mfma_f32_16x16x32_bf16 v[112:115], v[20:23], a[248:251], v[112:115]
    ds_read_b64_tr_b16 v[38:39], v5 offset:58368
    v_add_f32 v186, v186, v194
    v_add_f32 v187, v187, v195
    v_mfma_f32_16x16x32_bf16 v[116:119], v[20:23], a[252:255], v[116:119]
    v_add_f32 v168, v168, v184
    v_add_f32 v169, v169, v185
    v_add_f32 v170, v170, v186
    v_mfma_f32_16x16x32_bf16 v[116:119], v[16:19], a[236:239], v[116:119]
    v_add_f32 v171, v171, v187
    s_add_u32 s3, s60, 131072
    s_waitcnt lgkmcnt(4)
    v_mfma_f32_16x16x32_bf16 v[120:123], v[24:27], a[224:227], v[120:123]
    ds_read_b64_tr_b16 v[16:17], v5 offset:51200
    v_add_u32 v12, s3, v11
    ds_write_b128 v12, v[168:171]
    v_mfma_f32_16x16x32_bf16 v[120:123], v[28:31], a[240:243], v[120:123]
    v_add_u32 v12, 131072, v11
    v_and_b32 v13, 0xffffff3f, v12
    v_mfma_f32_16x16x32_bf16 v[124:127], v[28:31], a[244:247], v[124:127]
    ds_read_b64_tr_b16 v[18:19], v5 offset:52224
    v_or_b32 v13, 64, v13
    v_mfma_f32_16x16x32_bf16 v[124:127], v[24:27], a[228:231], v[124:127]
    s_mov_b32 s46, 0xcccccccc
    s_mov_b32 s47, 0xcccccccc
    v_mfma_f32_16x16x32_bf16 v[128:131], v[24:27], a[232:235], v[128:131]
    ds_read_b64_tr_b16 v[20:21], v5 offset:59392
    v_cndmask_b32 v13, v12, v13, s[46:47]
    v_add_u32 v250, 73728, v11
    v_mfma_f32_16x16x32_bf16 v[128:131], v[28:31], a[248:251], v[128:131]
    ds_read_b64_tr_b16 v[22:23], v5 offset:60416
    s_waitcnt lgkmcnt(3)
    s_barrier
    v_mfma_f32_16x16x32_bf16 v[132:135], v[28:31], a[252:255], v[132:135]
    ds_read_b128 v[168:171], v12 offset:0
    ds_read_b128 v[172:175], v12 offset:4096
    s_lshl_b32 s31, s82, 6
    v_mfma_f32_16x16x32_bf16 v[132:135], v[24:27], a[236:239], v[132:135]
    s_barrier
    v_mfma_f32_16x16x32_bf16 v[136:139], v[32:35], a[224:227], v[136:139]
    v_xor_b32 v2, 196608, v2
    ds_read_b128 v[176:179], v13 offset:8192
    v_mfma_f32_16x16x32_bf16 v[136:139], v[36:39], a[240:243], v[136:139]
    v_xor_b32 v3, 196608, v3
    ds_read_b128 v[180:183], v13 offset:12288
    v_mfma_f32_16x16x32_bf16 v[140:143], v[36:39], a[244:247], v[140:143]
    v_xor_b32 v4, 196608, v4
    s_and_b32 s31, s31, 0x3c0
    v_mfma_f32_16x16x32_bf16 v[140:143], v[32:35], a[228:231], v[140:143]
    v_xor_b32 v5, 196608, v5
    s_add_u32 s31, s31, 145408
    v_add_u32 v251, 110592, v11
    buffer_load_dwordx4 a[80:83], v11, s[16:19], s20 offen offset:0 sc1
    v_mfma_f32_16x16x32_bf16 v[144:147], v[32:35], a[232:235], v[144:147]
    ds_read_b64_tr_b16 v[24:25], v2 offset:16384
    ds_read_b64_tr_b16 v[26:27], v2 offset:17408
    v_mov_b32 v187, 0
    v_mfma_f32_16x16x32_bf16 v[144:147], v[36:39], a[248:251], v[144:147]
    ds_read_b64_tr_b16 v[28:29], v2 offset:24576
    v_mov_b32 v191, 0
    s_waitcnt lgkmcnt(6)
    v_cvt_pk_bf16_f32 v184, v168, v169
    v_mfma_f32_16x16x32_bf16 v[148:151], v[36:39], a[252:255], v[148:151]
    ds_read_b64_tr_b16 v[30:31], v2 offset:25600
    v_cvt_pk_bf16_f32 v185, v170, v171
    s_waitcnt lgkmcnt(6)
    v_cvt_pk_bf16_f32 v186, v174, v175
    v_mfma_f32_16x16x32_bf16 v[148:151], v[32:35], a[236:239], v[148:151]
    v_cndmask_b32 v186, 0, v186, s[50:51]
    v_bfe_u32 v8, v11, 2, 6
    v_mfma_f32_16x16x32_bf16 v[152:155], v[16:19], a[224:227], v[152:155]
    ds_read_b64_tr_b16 v[32:33], v2 offset:18432
    s_waitcnt lgkmcnt(6)
    v_cvt_pk_bf16_f32 v188, v176, v177
    v_cvt_pk_bf16_f32 v189, v178, v179
    v_mfma_f32_16x16x32_bf16 v[152:155], v[20:23], a[240:243], v[152:155]
    s_waitcnt lgkmcnt(5)
    v_cvt_pk_bf16_f32 v190, v182, v183
    v_cndmask_b32 v190, 0, v190, s[50:51]
    v_add_u32 v7, s31, v8
    v_mfma_f32_16x16x32_bf16 v[156:159], v[20:23], a[244:247], v[156:159]
    ds_read_b64_tr_b16 v[34:35], v2 offset:19456
    v_lshrrev_b32 v13, 1, v11
    buffer_load_dwordx4 a[84:87], v11, s[16:19], s20 offen offset:1024 sc1
    v_mfma_f32_16x16x32_bf16 v[156:159], v[16:19], a[228:231], v[156:159]
    s_lshl_b32 s72, s57, 6
    v_lshrrev_b32 v14, 2, v11
    v_xor_b32 v8, 64, v7
    v_mfma_f32_16x16x32_bf16 v[160:163], v[16:19], a[232:235], v[160:163]
    ds_read_b64_tr_b16 v[36:37], v2 offset:26624
    v_xor_b32 v14, s72, v14
    s_lshl_b32 s72, s56, 2
    v_mfma_f32_16x16x32_bf16 v[160:163], v[20:23], a[248:251], v[160:163]
    ds_read_b64_tr_b16 v[38:39], v2 offset:27648
    s_add_u32 s72, s72, s54
    ds_read_b32 v7, v7
    v_mfma_f32_16x16x32_bf16 v[164:167], v[20:23], a[252:255], v[164:167]
    s_lshl_b32 s72, s72, 5
    s_add_u32 s72, s72, s55
    buffer_load_dwordx4 a[88:91], v11, s[16:19], s21 offen offset:0 sc1
    v_mfma_f32_16x16x32_bf16 v[164:167], v[16:19], a[236:239], v[164:167]
    s_lshl_b32 s72, s72, 8
    s_add_u32 s72, s72, 20971520
    s_waitcnt lgkmcnt(5)
    v_mfma_f32_16x16x32_bf16 v[40:43], v[24:27], v[200:203], v[40:43]
    ds_read_b64_tr_b16 v[16:17], v3 offset:16384
    ds_read_b32 v8, v8
    v_mfma_f32_16x16x32_bf16 v[40:43], v[28:31], v[216:219], v[40:43]
    v_mfma_f32_16x16x32_bf16 v[172:175], v[188:191], v[232:235], 0
    v_mfma_f32_16x16x32_bf16 v[44:47], v[28:31], v[220:223], v[44:47]
    ds_read_b64_tr_b16 v[18:19], v3 offset:17408
    v_mfma_f32_16x16x32_bf16 v[168:171], v[184:187], v[232:235], 0
    v_mfma_f32_16x16x32_bf16 v[44:47], v[24:27], v[204:207], v[44:47]
    v_mfma_f32_16x16x32_bf16 v[180:183], v[188:191], v[236:239], 0
    v_mfma_f32_16x16x32_bf16 v[48:51], v[24:27], v[208:211], v[48:51]
    ds_read_b64_tr_b16 v[20:21], v3 offset:24576
    v_mfma_f32_16x16x32_bf16 v[176:179], v[184:187], v[236:239], 0
    v_mfma_f32_16x16x32_bf16 v[48:51], v[28:31], v[224:227], v[48:51]
    ds_read_b64_tr_b16 v[22:23], v3 offset:25600
    buffer_load_dwordx4 a[92:95], v11, s[16:19], s21 offen offset:1024 sc1
    v_mfma_f32_16x16x32_bf16 v[52:55], v[28:31], v[228:231], v[52:55]
    s_add_u32 s20, s20, 2048
    s_add_u32 s21, s21, 2048
    v_mfma_f32_16x16x32_bf16 v[52:55], v[24:27], v[212:215], v[52:55]
    v_add_f32 v172, 897988541, v172
    s_waitcnt lgkmcnt(6)
    v_mfma_f32_16x16x32_bf16 v[56:59], v[32:35], v[200:203], v[56:59]
    ds_read_b64_tr_b16 v[24:25], v3 offset:18432
    v_rcp_f32 v172, v172
    v_mfma_f32_16x16x32_bf16 v[56:59], v[36:39], v[216:219], v[56:59]
    v_mul_f32 v172, v172, v235
    v_mul_f32 v168, v168, v172
    v_mul_f32 v169, v169, v172
    v_mfma_f32_16x16x32_bf16 v[60:63], v[36:39], v[220:223], v[60:63]
    ds_read_b64_tr_b16 v[26:27], v3 offset:19456
    v_mul_f32 v170, v170, v172
    v_mfma_f32_16x16x32_bf16 v[60:63], v[32:35], v[204:207], v[60:63]
    v_mul_f32 v171, v171, v172
    v_mul_f32 v174, v174, v172
    v_mfma_f32_16x16x32_bf16 v[64:67], v[32:35], v[208:211], v[64:67]
    ds_read_b64_tr_b16 v[28:29], v3 offset:26624
    v_mul_f32 v175, v175, v172
    v_mfma_f32_16x16x32_bf16 v[64:67], v[36:39], v[224:227], v[64:67]
    ds_read_b64_tr_b16 v[30:31], v3 offset:27648
    v_cvt_pk_bf16_f32 v168, v168, v169
    v_cvt_pk_bf16_f32 v169, v170, v171
    v_mfma_f32_16x16x32_bf16 v[68:71], v[36:39], v[228:231], v[68:71]
    buffer_store_dwordx2 v[168:169], v13, s[16:19], s32 offen sc1
    v_cvt_pk_bf16_f32 v15, v174, v175
    v_mfma_f32_16x16x32_bf16 v[68:71], v[32:35], v[212:215], v[68:71]
    v_mfma_f32_16x16x32_bf16 v[172:175], v[188:191], v[240:243], 0
    s_waitcnt lgkmcnt(4)
    v_mfma_f32_16x16x32_bf16 v[72:75], v[16:19], v[200:203], v[72:75]
    ds_read_b64_tr_b16 v[32:33], v4 offset:16384
    v_mfma_f32_16x16x32_bf16 v[168:171], v[184:187], v[240:243], 0
    v_mfma_f32_16x16x32_bf16 v[72:75], v[20:23], v[216:219], v[72:75]
    v_add_f32 v180, 897988541, v180
    v_rcp_f32 v180, v180
    v_mfma_f32_16x16x32_bf16 v[76:79], v[20:23], v[220:223], v[76:79]
    ds_read_b64_tr_b16 v[34:35], v4 offset:17408
    v_mul_f32 v180, v180, v239
    v_mul_f32 v176, v176, v180
    v_mfma_f32_16x16x32_bf16 v[76:79], v[16:19], v[204:207], v[76:79]
    v_mul_f32 v177, v177, v180
    v_mul_f32 v178, v178, v180
    v_mul_f32 v179, v179, v180
    v_mfma_f32_16x16x32_bf16 v[80:83], v[16:19], v[208:211], v[80:83]
    ds_read_b64_tr_b16 v[36:37], v4 offset:24576
    v_mul_f32 v182, v182, v180
    v_mul_f32 v183, v183, v180
    v_mfma_f32_16x16x32_bf16 v[80:83], v[20:23], v[224:227], v[80:83]
    ds_read_b64_tr_b16 v[38:39], v4 offset:25600
    v_cvt_pk_bf16_f32 v176, v176, v177
    v_cvt_pk_bf16_f32 v177, v178, v179
    v_mfma_f32_16x16x32_bf16 v[84:87], v[20:23], v[228:231], v[84:87]
    buffer_store_dwordx2 v[176:177], v13, s[16:19], s33 offen sc1
    v_cvt_pk_bf16_f32 v182, v182, v183
    s_mov_b32 s46, 4294901760
    v_mfma_f32_16x16x32_bf16 v[84:87], v[16:19], v[212:215], v[84:87]
    s_mov_b32 s47, 4294967295
    v_cndmask_b32 v15, v15, v182, s[46:47]
    s_waitcnt lgkmcnt(4)
    v_mfma_f32_16x16x32_bf16 v[88:91], v[24:27], v[200:203], v[88:91]
    ds_read_b64_tr_b16 v[16:17], v4 offset:18432
    v_mfma_f32_16x16x32_bf16 v[180:183], v[188:191], v[244:247], 0
    v_mfma_f32_16x16x32_bf16 v[88:91], v[28:31], v[216:219], v[88:91]
    v_mfma_f32_16x16x32_bf16 v[176:179], v[184:187], v[244:247], 0
    v_add_f32 v172, 897988541, v172
    v_mfma_f32_16x16x32_bf16 v[92:95], v[28:31], v[220:223], v[92:95]
    ds_read_b64_tr_b16 v[18:19], v4 offset:19456
    v_rcp_f32 v172, v172
    v_mfma_f32_16x16x32_bf16 v[92:95], v[24:27], v[204:207], v[92:95]
    v_mul_f32 v172, v172, v243
    v_mul_f32 v168, v168, v172
    v_mul_f32 v169, v169, v172
    v_mfma_f32_16x16x32_bf16 v[96:99], v[24:27], v[208:211], v[96:99]
    ds_read_b64_tr_b16 v[20:21], v4 offset:26624
    v_mul_f32 v170, v170, v172
    v_mul_f32 v171, v171, v172
    v_mfma_f32_16x16x32_bf16 v[96:99], v[28:31], v[224:227], v[96:99]
    ds_read_b64_tr_b16 v[22:23], v4 offset:27648
    v_mul_f32 v174, v174, v172
    v_mul_f32 v175, v175, v172
    v_mfma_f32_16x16x32_bf16 v[100:103], v[28:31], v[228:231], v[100:103]
    v_cvt_pk_bf16_f32 v168, v168, v169
    v_cvt_pk_bf16_f32 v169, v170, v171
    buffer_store_dwordx2 v[168:169], v13, s[16:19], s34 offen sc1
    v_mfma_f32_16x16x32_bf16 v[100:103], v[24:27], v[212:215], v[100:103]
    v_cvt_pk_bf16_f32 v174, v174, v175
    s_mov_b32 s46, 0
    s_waitcnt lgkmcnt(4)
    v_mfma_f32_16x16x32_bf16 v[104:107], v[32:35], v[200:203], v[104:107]
    ds_read_b64_tr_b16 v[24:25], v5 offset:16384
    s_mov_b32 s47, 4294967295
    v_cndmask_b32 v15, v15, v174, s[46:47]
    v_mfma_f32_16x16x32_bf16 v[104:107], v[36:39], v[216:219], v[104:107]
    v_add_f32 v180, 897988541, v180
    v_rcp_f32 v180, v180
    v_mfma_f32_16x16x32_bf16 v[108:111], v[36:39], v[220:223], v[108:111]
    ds_read_b64_tr_b16 v[26:27], v5 offset:17408
    v_mul_f32 v180, v180, v247
    v_mul_f32 v48, v48, v64
    v_mfma_f32_16x16x32_bf16 v[108:111], v[32:35], v[204:207], v[108:111]
    v_mul_f32 v176, v176, v180
    v_mul_f32 v177, v177, v180
    v_mul_f32 v49, v49, v65
    v_mfma_f32_16x16x32_bf16 v[112:115], v[32:35], v[208:211], v[112:115]
    ds_read_b64_tr_b16 v[28:29], v5 offset:24576
    v_mul_f32 v178, v178, v180
    v_mul_f32 v179, v179, v180
    v_mfma_f32_16x16x32_bf16 v[112:115], v[36:39], v[224:227], v[112:115]
    ds_read_b64_tr_b16 v[30:31], v5 offset:25600
    v_mul_f32 v182, v182, v180
    v_mul_f32 v183, v183, v180
    v_mfma_f32_16x16x32_bf16 v[116:119], v[36:39], v[228:231], v[116:119]
    v_cvt_pk_bf16_f32 v176, v176, v177
    v_cvt_pk_bf16_f32 v177, v178, v179
    v_mul_f32 v50, v50, v66
    v_mfma_f32_16x16x32_bf16 v[116:119], v[32:35], v[212:215], v[116:119]
    buffer_store_dwordx2 v[176:177], v13, s[16:19], s35 offen sc1
    v_cvt_pk_bf16_f32 v182, v182, v183
    s_waitcnt lgkmcnt(4)
    v_mfma_f32_16x16x32_bf16 v[120:123], v[16:19], v[200:203], v[120:123]
    ds_read_b64_tr_b16 v[32:33], v5 offset:18432
    s_mov_b32 s46, 0
    s_mov_b32 s47, 4294901760
    v_mfma_f32_16x16x32_bf16 v[120:123], v[20:23], v[216:219], v[120:123]
    v_cndmask_b32 v15, v15, v182, s[46:47]
    buffer_store_dword v15, v14, s[16:19], s72 offen sc1
    v_mul_f32 v52, v52, v68
L_wm7:
    s_cbranch_execz L_wm_done
    v_mfma_f32_16x16x32_bf16 v[124:127], v[20:23], v[220:223], v[124:127]
    ds_read_b64_tr_b16 v[34:35], v5 offset:19456
    buffer_load_dwordx4 a[96:99], v11, s[16:19], s20 offen offset:0 sc1
    v_mul_f32 v53, v53, v69
    v_mfma_f32_16x16x32_bf16 v[124:127], v[16:19], v[204:207], v[124:127]
    buffer_load_dwordx4 a[100:103], v11, s[16:19], s20 offen offset:1024 sc1
    buffer_load_dwordx4 a[104:107], v11, s[16:19], s21 offen offset:0 sc1
    v_mfma_f32_16x16x32_bf16 v[128:131], v[16:19], v[208:211], v[128:131]
    ds_read_b64_tr_b16 v[36:37], v5 offset:26624
    buffer_load_dwordx4 a[108:111], v11, s[16:19], s21 offen offset:1024 sc1
    v_mfma_f32_16x16x32_bf16 v[128:131], v[20:23], v[224:227], v[128:131]
    ds_read_b64_tr_b16 v[38:39], v5 offset:27648
    v_mul_f32 v40, v40, v56
    v_mul_f32 v104, v104, v120
    v_mfma_f32_16x16x32_bf16 v[132:135], v[20:23], v[228:231], v[132:135]
    v_mul_f32 v41, v41, v57
    v_mul_f32 v42, v42, v58
    v_mul_f32 v105, v105, v121
    v_mfma_f32_16x16x32_bf16 v[132:135], v[16:19], v[212:215], v[132:135]
    v_mul_f32 v43, v43, v59
    v_mul_f32 v106, v106, v122
    s_waitcnt lgkmcnt(4)
    v_mfma_f32_16x16x32_bf16 v[136:139], v[24:27], v[200:203], v[136:139]
    s_add_u32 s20, s20, 2048
    v_mul_f32 v44, v44, v60
    v_mul_f32 v107, v107, v123
    v_mfma_f32_16x16x32_bf16 v[136:139], v[28:31], v[216:219], v[136:139]
    v_mul_f32 v40, v40, v252
    v_mul_f32 v45, v45, v61
    v_mul_f32 v104, v104, v252
    v_mfma_f32_16x16x32_bf16 v[140:143], v[28:31], v[220:223], v[140:143]
    v_mul_f32 v41, v41, v252
    v_mul_f32 v46, v46, v62
    v_mul_f32 v105, v105, v252
    v_mfma_f32_16x16x32_bf16 v[140:143], v[24:27], v[204:207], v[140:143]
    s_barrier
    v_mul_f32 v106, v106, v252
    v_mfma_f32_16x16x32_bf16 v[144:147], v[24:27], v[208:211], v[144:147]
    ds_read_b128 v[184:187], v249 offset:0
    v_mul_f32 v47, v47, v63
    v_mul_f32 v116, v116, v132
    v_mfma_f32_16x16x32_bf16 v[144:147], v[28:31], v[224:227], v[144:147]
    v_mul_f32 v42, v42, v252
    v_mul_f32 v44, v44, v253
    v_mul_f32 v117, v117, v133
    v_mfma_f32_16x16x32_bf16 v[148:151], v[28:31], v[228:231], v[148:151]
    ds_read_b128 v[188:191], v249 offset:9216
    s_add_u32 s21, s21, 2048
    v_mfma_f32_16x16x32_bf16 v[148:151], v[24:27], v[212:215], v[148:151]
    v_mul_f32 v45, v45, v253
    s_waitcnt lgkmcnt(2)
    v_mfma_f32_16x16x32_bf16 v[152:155], v[32:35], v[200:203], v[152:155]
    ds_read_b128 v[192:195], v249 offset:1024
    v_mul_f32 v46, v46, v253
    v_mfma_f32_16x16x32_bf16 v[152:155], v[36:39], v[216:219], v[152:155]
    v_mul_f32 v43, v43, v252
    v_mul_f32 v47, v47, v253
    v_mfma_f32_16x16x32_bf16 v[156:159], v[36:39], v[220:223], v[156:159]
    ds_read_b128 v[196:199], v249 offset:10240
    v_cvt_pk_bf16_f32 v60, v44, v45
    v_mfma_f32_16x16x32_bf16 v[156:159], v[32:35], v[204:207], v[156:159]
    v_cvt_pk_bf16_f32 v56, v40, v41
    v_cvt_pk_bf16_f32 v61, v46, v47
    v_mul_f32 v76, v76, v92
    v_mfma_f32_16x16x32_bf16 v[160:163], v[32:35], v[208:211], v[160:163]
    ds_read_b128 v[168:171], v249 offset:2048
    v_mul_f32 v77, v77, v93
    v_mul_f32 v78, v78, v94
    v_mfma_f32_16x16x32_bf16 v[160:163], v[36:39], v[224:227], v[160:163]
    v_cvt_pk_bf16_f32 v57, v42, v43
    v_mul_f32 v72, v72, v88
    v_mul_f32 v73, v73, v89
    v_mfma_f32_16x16x32_bf16 v[164:167], v[36:39], v[228:231], v[164:167]
    ds_read_b128 v[172:175], v249 offset:11264
    v_mul_f32 v74, v74, v90
    v_mul_f32 v75, v75, v91
    v_mfma_f32_16x16x32_bf16 v[164:167], v[32:35], v[212:215], v[164:167]
    v_mul_f32 v72, v72, v252
    v_mul_f32 v73, v73, v252
    s_waitcnt lgkmcnt(4)
    v_mfma_f32_16x16x32_bf16 v[16:19], v[184:187], a[0:3], 0
    ds_read_b128 v[176:179], v249 offset:3072
    v_mul_f32 v74, v74, v252
    v_mfma_f32_16x16x32_bf16 v[16:19], v[188:191], a[4:7], v[16:19]
    s_barrier
    v_mfma_f32_16x16x32_bf16 v[20:23], v[188:191], a[12:15], 0
    ds_read_b128 v[180:183], v249 offset:12288
    v_mul_f32 v75, v75, v252
    v_mfma_f32_16x16x32_bf16 v[20:23], v[184:187], a[8:11], v[20:23]
    s_add_u32 m0, s26, 73728
    s_waitcnt lgkmcnt(4)
    v_mfma_f32_16x16x32_bf16 v[24:27], v[192:195], a[0:3], 0
    ds_read_b128 v[184:187], v249 offset:4096
    s_mov_b32 s25, s22
    v_mfma_f32_16x16x32_bf16 v[24:27], v[196:199], a[4:7], v[24:27]
    buffer_load_dwordx4 v11, s[4:7], s25 offen offset:0 sc1 lds
    v_cvt_pk_bf16_f32 v58, v72, v73
    v_mfma_f32_16x16x32_bf16 v[28:31], v[196:199], a[12:15], 0
    ds_read_b128 v[188:191], v249 offset:13312
    s_add_u32 s25, s25, s23
    v_mfma_f32_16x16x32_bf16 v[28:31], v[192:195], a[8:11], v[28:31]
    buffer_load_dwordx4 v11, s[4:7], s25 offen offset:1024 sc1 lds
    s_waitcnt lgkmcnt(4)
    v_mfma_f32_16x16x32_bf16 v[32:35], v[168:171], a[0:3], 0
    ds_read_b128 v[192:195], v249 offset:5120
    v_cvt_pk_bf16_f32 v59, v74, v75
    v_mfma_f32_16x16x32_bf16 v[32:35], v[172:175], a[4:7], v[32:35]
    s_add_u32 s25, s25, s23
    v_mul_f32 v79, v79, v95
    v_mul_f32 v76, v76, v253
    v_mfma_f32_16x16x32_bf16 v[36:39], v[172:175], a[12:15], 0
    ds_read_b128 v[196:199], v249 offset:14336
    buffer_load_dwordx4 v11, s[4:7], s25 offen offset:2048 sc1 lds
    buffer_store_dwordx4 v[56:59], v11, s[16:19], s66 offen offset:0 sc1
    v_mfma_f32_16x16x32_bf16 v[36:39], v[168:171], a[8:11], v[36:39]
    s_add_u32 s25, s25, s23
    s_waitcnt lgkmcnt(4)
    v_mfma_f32_16x16x32_bf16 v[200:203], v[176:179], a[0:3], 0
    ds_read_b128 v[168:171], v249 offset:6144
    buffer_load_dwordx4 v11, s[4:7], s25 offen offset:3072 sc1 lds
    v_mfma_f32_16x16x32_bf16 v[200:203], v[180:183], a[4:7], v[200:203]
    s_add_u32 m0, s26, 77824
    v_mul_f32 v77, v77, v253
    v_mul_f32 v78, v78, v253
    v_mfma_f32_16x16x32_bf16 v[204:207], v[180:183], a[12:15], 0
    ds_read_b128 v[172:175], v249 offset:15360
    s_add_u32 s25, s25, s24
    v_mfma_f32_16x16x32_bf16 v[204:207], v[176:179], a[8:11], v[204:207]
    buffer_load_dwordx4 v11, s[4:7], s25 offen offset:0 sc1 lds
    s_waitcnt lgkmcnt(4)
    v_mfma_f32_16x16x32_bf16 v[208:211], v[184:187], a[0:3], 0
    ds_read_b128 v[176:179], v249 offset:7168
    s_add_u32 s25, s25, s23
    v_mfma_f32_16x16x32_bf16 v[208:211], v[188:191], a[4:7], v[208:211]
    buffer_load_dwordx4 v11, s[4:7], s25 offen offset:1024 sc1 lds
    v_mul_f32 v79, v79, v253
    v_mfma_f32_16x16x32_bf16 v[212:215], v[188:191], a[12:15], 0
    ds_read_b128 v[180:183], v249 offset:16384
    s_add_u32 s25, s25, s23
    v_mfma_f32_16x16x32_bf16 v[212:215], v[184:187], a[8:11], v[212:215]
    buffer_load_dwordx4 v11, s[4:7], s25 offen offset:2048 sc1 lds
    s_waitcnt lgkmcnt(4)
    v_mfma_f32_16x16x32_bf16 v[216:219], v[192:195], a[0:3], 0
    ds_read_b128 v[184:187], v249 offset:8192
    v_cvt_pk_bf16_f32 v62, v76, v77
    v_mfma_f32_16x16x32_bf16 v[216:219], v[196:199], a[4:7], v[216:219]
    s_add_u32 s25, s25, s23
    v_cvt_pk_bf16_f32 v63, v78, v79
    v_mfma_f32_16x16x32_bf16 v[220:223], v[196:199], a[12:15], 0
    ds_read_b128 v[188:191], v249 offset:17408
    buffer_load_dwordx4 v11, s[4:7], s25 offen offset:3072 sc1 lds
    v_mfma_f32_16x16x32_bf16 v[220:223], v[192:195], a[8:11], v[220:223]
    s_add_u32 m0, s26, 81920
    s_waitcnt lgkmcnt(4)
    v_mfma_f32_16x16x32_bf16 v[224:227], v[168:171], a[0:3], 0
    ds_read_b128 v[192:195], v249 offset:18432
    s_add_u32 s25, s25, s24
    buffer_store_dwordx4 v[60:63], v11, s[16:19], s67 offen offset:0 sc1
    v_mfma_f32_16x16x32_bf16 v[224:227], v[172:175], a[4:7], v[224:227]
    buffer_load_dwordx4 v11, s[4:7], s25 offen offset:0 sc1 lds
    v_mul_f32 v51, v51, v67
    v_mfma_f32_16x16x32_bf16 v[228:231], v[172:175], a[12:15], 0
    ds_read_b128 v[196:199], v249 offset:27648
    s_add_u32 s22, s22, 147456
    v_mfma_f32_16x16x32_bf16 v[228:231], v[168:171], a[8:11], v[228:231]
    v_mul_f32 v48, v48, v254
    s_waitcnt lgkmcnt(4)
    v_mfma_f32_16x16x32_bf16 v[232:235], v[176:179], a[0:3], 0
    ds_read_b128 v[168:171], v249 offset:19456
    s_add_u32 m0, s26, 110592
    v_mfma_f32_16x16x32_bf16 v[232:235], v[180:183], a[4:7], v[232:235]
    v_mul_f32 v49, v49, v254
    v_mul_f32 v50, v50, v254
    v_mfma_f32_16x16x32_bf16 v[236:239], v[180:183], a[12:15], 0
    ds_read_b128 v[172:175], v249 offset:28672
    s_mov_b32 s25, s22
    v_mfma_f32_16x16x32_bf16 v[236:239], v[176:179], a[8:11], v[236:239]
    v_mul_f32 v51, v51, v254
    s_waitcnt lgkmcnt(4)
    v_mfma_f32_16x16x32_bf16 v[240:243], v[184:187], a[0:3], 0
    ds_read_b128 v[176:179], v249 offset:20480
    buffer_load_dwordx4 v11, s[4:7], s25 offen offset:0 sc1 lds
    v_mfma_f32_16x16x32_bf16 v[240:243], v[188:191], a[4:7], v[240:243]
    s_add_u32 s25, s25, s23
    v_cvt_pk_bf16_f32 v64, v48, v49
    v_mfma_f32_16x16x32_bf16 v[244:247], v[188:191], a[12:15], 0
    ds_read_b128 v[180:183], v249 offset:29696
    v_cvt_pk_bf16_f32 v65, v50, v51
    v_mul_f32 v80, v80, v96
    v_mul_f32 v81, v81, v97
    v_mfma_f32_16x16x32_bf16 v[244:247], v[184:187], a[8:11], v[244:247]
    buffer_load_dwordx4 v11, s[4:7], s25 offen offset:1024 sc1 lds
    v_mul_f32 v82, v82, v98
    v_mul_f32 v83, v83, v99
    s_waitcnt lgkmcnt(4)
    v_mfma_f32_16x16x32_bf16 v[16:19], v[192:195], a[16:19], v[16:19]
    ds_read_b128 v[184:187], v249 offset:21504
    v_mul_f32 v80, v80, v254
    v_mul_f32 v81, v81, v254
    v_mfma_f32_16x16x32_bf16 v[16:19], v[196:199], a[20:23], v[16:19]
    s_add_u32 s25, s25, s23
    v_mul_f32 v82, v82, v254
    v_mul_f32 v83, v83, v254
    v_mfma_f32_16x16x32_bf16 v[20:23], v[196:199], a[28:31], v[20:23]
    ds_read_b128 v[188:191], v249 offset:30720
    v_cvt_pk_bf16_f32 v66, v80, v81
    v_cvt_pk_bf16_f32 v67, v82, v83
    v_mfma_f32_16x16x32_bf16 v[20:23], v[192:195], a[24:27], v[20:23]
    buffer_load_dwordx4 v11, s[4:7], s25 offen offset:2048 sc1 lds
    buffer_store_dwordx4 v[64:67], v11, s[16:19], s68 offen offset:0 sc1
    s_waitcnt lgkmcnt(4)
    v_mfma_f32_16x16x32_bf16 v[24:27], v[168:171], a[16:19], v[24:27]
    ds_read_b128 v[192:195], v249 offset:22528
    v_mul_f32 v54, v54, v70
    v_mfma_f32_16x16x32_bf16 v[24:27], v[172:175], a[20:23], v[24:27]
    s_add_u32 s25, s25, s23
    v_mul_f32 v55, v55, v71
    v_mfma_f32_16x16x32_bf16 v[28:31], v[172:175], a[28:31], v[28:31]
    ds_read_b128 v[196:199], v249 offset:31744
    v_mul_f32 v52, v52, v255
    v_mfma_f32_16x16x32_bf16 v[28:31], v[168:171], a[24:27], v[28:31]
    buffer_load_dwordx4 v11, s[4:7], s25 offen offset:3072 sc1 lds
    s_waitcnt lgkmcnt(4)
    v_mfma_f32_16x16x32_bf16 v[32:35], v[176:179], a[16:19], v[32:35]
    ds_read_b128 v[168:171], v249 offset:23552
    v_mul_f32 v53, v53, v255
    v_mfma_f32_16x16x32_bf16 v[32:35], v[180:183], a[20:23], v[32:35]
    s_add_u32 m0, s26, 114688
    v_mul_f32 v54, v54, v255
    v_mfma_f32_16x16x32_bf16 v[36:39], v[180:183], a[28:31], v[36:39]
    ds_read_b128 v[172:175], v249 offset:32768
    s_add_u32 s25, s25, s24
    v_mfma_f32_16x16x32_bf16 v[36:39], v[176:179], a[24:27], v[36:39]
    v_mul_f32 v55, v55, v255
    s_waitcnt lgkmcnt(4)
    v_mfma_f32_16x16x32_bf16 v[200:203], v[184:187], a[16:19], v[200:203]
    ds_read_b128 v[176:179], v249 offset:24576
    buffer_load_dwordx4 v11, s[4:7], s25 offen offset:0 sc1 lds
    v_mfma_f32_16x16x32_bf16 v[200:203], v[188:191], a[20:23], v[200:203]
    v_cvt_pk_bf16_f32 v68, v52, v53
    v_cvt_pk_bf16_f32 v69, v54, v55
    v_mul_f32 v84, v84, v100
    v_mul_f32 v85, v85, v101
    v_mfma_f32_16x16x32_bf16 v[204:207], v[188:191], a[28:31], v[204:207]
    ds_read_b128 v[180:183], v249 offset:33792
    s_add_u32 s25, s25, s23
    v_mul_f32 v86, v86, v102
    v_mul_f32 v87, v87, v103
    v_mfma_f32_16x16x32_bf16 v[204:207], v[184:187], a[24:27], v[204:207]
    v_mul_f32 v84, v84, v255
    v_mul_f32 v85, v85, v255
    v_mul_f32 v86, v86, v255
    s_waitcnt lgkmcnt(4)
    v_mfma_f32_16x16x32_bf16 v[208:211], v[192:195], a[16:19], v[208:211]
    ds_read_b128 v[184:187], v249 offset:25600
    buffer_load_dwordx4 v11, s[4:7], s25 offen offset:1024 sc1 lds
    v_mul_f32 v87, v87, v255
    v_cvt_pk_bf16_f32 v70, v84, v85
    v_mfma_f32_16x16x32_bf16 v[208:211], v[196:199], a[20:23], v[208:211]
    s_add_u32 s25, s25, s23
    buffer_load_dwordx4 v11, s[4:7], s25 offen offset:2048 sc1 lds
    v_cvt_pk_bf16_f32 v71, v86, v87
    v_mfma_f32_16x16x32_bf16 v[212:215], v[196:199], a[28:31], v[212:215]
    ds_read_b128 v[188:191], v249 offset:34816
    s_lshl_b32 s38, s56, 5
    buffer_store_dwordx4 v[68:71], v11, s[16:19], s69 offen offset:0 sc1
    v_mfma_f32_16x16x32_bf16 v[212:215], v[192:195], a[24:27], v[212:215]
    s_add_u32 s38, s38, s55
    s_waitcnt lgkmcnt(4)
    v_mfma_f32_16x16x32_bf16 v[216:219], v[168:171], a[16:19], v[216:219]
    ds_read_b128 v[192:195], v249 offset:26624
    s_lshl_b32 s38, s38, 7
    v_mfma_f32_16x16x32_bf16 v[216:219], v[172:175], a[20:23], v[216:219]
    s_add_u32 s38, s38, 28442624
    s_add_u32 s25, s25, s23
    v_mfma_f32_16x16x32_bf16 v[220:223], v[172:175], a[28:31], v[220:223]
    ds_read_b128 v[196:199], v249 offset:35840
    v_mov_b32 v12, s80
    v_mfma_f32_16x16x32_bf16 v[220:223], v[168:171], a[24:27], v[220:223]
    s_waitcnt vmcnt(24)
    s_barrier
    buffer_store_dword v12, v0, s[16:19], s38 offen sc1
    s_waitcnt lgkmcnt(4)
    v_mfma_f32_16x16x32_bf16 v[224:227], v[176:179], a[16:19], v[224:227]
    ds_read_b128 v[168:171], v248 offset:0
    buffer_load_dwordx4 v11, s[4:7], s25 offen offset:3072 sc1 lds
    v_mfma_f32_16x16x32_bf16 v[224:227], v[180:183], a[20:23], v[224:227]
    s_add_u32 m0, s26, 118784
    v_mul_f32 v107, v107, v252
    v_mfma_f32_16x16x32_bf16 v[228:231], v[180:183], a[28:31], v[228:231]
    ds_read_b128 v[172:175], v248 offset:9216
    v_cvt_pk_bf16_f32 v120, v104, v105
    v_mfma_f32_16x16x32_bf16 v[228:231], v[176:179], a[24:27], v[228:231]
    s_add_u32 s25, s25, s24
    s_waitcnt lgkmcnt(4)
    v_mfma_f32_16x16x32_bf16 v[232:235], v[184:187], a[16:19], v[232:235]
    ds_read_b128 v[176:179], v248 offset:1024
    v_cvt_pk_bf16_f32 v121, v106, v107
    v_mul_f32 v136, v136, v152
    v_mul_f32 v137, v137, v153
    v_mfma_f32_16x16x32_bf16 v[232:235], v[188:191], a[20:23], v[232:235]
    buffer_load_dwordx4 v11, s[4:7], s25 offen offset:0 sc1 lds
    v_mul_f32 v138, v138, v154
    v_mul_f32 v139, v139, v155
    v_mul_f32 v136, v136, v252
    v_mfma_f32_16x16x32_bf16 v[236:239], v[188:191], a[28:31], v[236:239]
    ds_read_b128 v[180:183], v248 offset:10240
    s_add_u32 s22, s22, s27
    v_mul_f32 v137, v137, v252
    v_mfma_f32_16x16x32_bf16 v[236:239], v[184:187], a[24:27], v[236:239]
    v_mul_f32 v138, v138, v252
    v_mul_f32 v139, v139, v252
    s_waitcnt lgkmcnt(4)
    v_mfma_f32_16x16x32_bf16 v[240:243], v[192:195], a[16:19], v[240:243]
    ds_read_b128 v[184:187], v248 offset:2048
    v_cvt_pk_bf16_f32 v122, v136, v137
    v_cvt_pk_bf16_f32 v123, v138, v139
    v_mfma_f32_16x16x32_bf16 v[240:243], v[196:199], a[20:23], v[240:243]
    v_mul_f32 v108, v108, v124
    v_mul_f32 v109, v109, v125
    buffer_store_dwordx4 v[120:123], v11, s[16:19], s66 offen offset:1024 sc1
    v_mfma_f32_16x16x32_bf16 v[244:247], v[196:199], a[28:31], v[244:247]
    ds_read_b128 v[188:191], v248 offset:11264
    v_mul_f32 v110, v110, v126
    v_mfma_f32_16x16x32_bf16 v[244:247], v[192:195], a[24:27], v[244:247]
    v_lshrrev_b32 v2, 1, v11
    s_waitcnt lgkmcnt(4)
    v_mfma_f32_16x16x32_bf16 v[16:19], v[168:171], a[32:35], v[16:19]
    ds_read_b128 v[192:195], v248 offset:3072
    v_mul_f32 v111, v111, v127
    v_mfma_f32_16x16x32_bf16 v[16:19], v[172:175], a[36:39], v[16:19]
    v_mul_f32 v108, v108, v253
    v_mul_f32 v109, v109, v253
    v_mfma_f32_16x16x32_bf16 v[20:23], v[172:175], a[44:47], v[20:23]
    ds_read_b128 v[196:199], v248 offset:12288
    v_bfe_u32 v3, v11, 2, 6
    v_mfma_f32_16x16x32_bf16 v[20:23], v[168:171], a[40:43], v[20:23]
    v_mul_f32 v110, v110, v253
    s_waitcnt lgkmcnt(4)
    v_mfma_f32_16x16x32_bf16 v[24:27], v[176:179], a[32:35], v[24:27]
    ds_read_b128 v[168:171], v248 offset:4096
    v_mul_f32 v111, v111, v253
    v_mfma_f32_16x16x32_bf16 v[24:27], v[180:183], a[36:39], v[24:27]
    v_lshrrev_b32 v4, 8, v11
    v_cvt_pk_bf16_f32 v124, v108, v109
    v_mfma_f32_16x16x32_bf16 v[28:31], v[180:183], a[44:47], v[28:31]
    ds_read_b128 v[172:175], v248 offset:13312
    v_cvt_pk_bf16_f32 v125, v110, v111
    v_mul_f32 v140, v140, v156
    v_mfma_f32_16x16x32_bf16 v[28:31], v[176:179], a[40:43], v[28:31]
    v_mul_f32 v141, v141, v157
    v_mul_f32 v142, v142, v158
    s_waitcnt lgkmcnt(4)
    v_mfma_f32_16x16x32_bf16 v[32:35], v[184:187], a[32:35], v[32:35]
    ds_read_b128 v[176:179], v248 offset:5120
    v_lshl_add_u32 v3, v4, 10, v3
    v_mul_f32 v143, v143, v159
    v_mfma_f32_16x16x32_bf16 v[32:35], v[188:191], a[36:39], v[32:35]
    v_mul_f32 v140, v140, v253
    v_mul_f32 v141, v141, v253
    v_mul_f32 v142, v142, v253
    v_mfma_f32_16x16x32_bf16 v[36:39], v[188:191], a[44:47], v[36:39]
    ds_read_b128 v[180:183], v248 offset:14336
    v_mul_f32 v143, v143, v253
    v_cvt_pk_bf16_f32 v126, v140, v141
    v_mfma_f32_16x16x32_bf16 v[36:39], v[184:187], a[40:43], v[36:39]
    s_lshl_b32 s72, s82, 2
    v_cvt_pk_bf16_f32 v127, v142, v143
    s_waitcnt lgkmcnt(4)
    v_mfma_f32_16x16x32_bf16 v[200:203], v[192:195], a[32:35], v[200:203]
    ds_read_b128 v[184:187], v248 offset:6144
    v_mul_f32 v112, v112, v128
    buffer_store_dwordx4 v[124:127], v11, s[16:19], s67 offen offset:1024 sc1
    v_mfma_f32_16x16x32_bf16 v[200:203], v[196:199], a[36:39], v[200:203]
    v_mul_f32 v113, v113, v129
    v_mul_f32 v114, v114, v130
    v_mfma_f32_16x16x32_bf16 v[204:207], v[196:199], a[44:47], v[204:207]
    ds_read_b128 v[188:191], v248 offset:15360
    s_add_u32 s72, s72, s58
    v_mfma_f32_16x16x32_bf16 v[204:207], v[192:195], a[40:43], v[204:207]
    v_mul_f32 v115, v115, v131
    s_waitcnt lgkmcnt(4)
    v_mfma_f32_16x16x32_bf16 v[208:211], v[168:171], a[32:35], v[208:211]
    ds_read_b128 v[192:195], v248 offset:7168
    v_mul_f32 v112, v112, v254
    v_mfma_f32_16x16x32_bf16 v[208:211], v[172:175], a[36:39], v[208:211]
    s_lshl_b32 s72, s72, 12
    v_mul_f32 v113, v113, v254
    v_mfma_f32_16x16x32_bf16 v[212:215], v[172:175], a[44:47], v[212:215]
    ds_read_b128 v[196:199], v248 offset:16384
    v_mul_f32 v114, v114, v254
    v_mfma_f32_16x16x32_bf16 v[212:215], v[168:171], a[40:43], v[212:215]
    v_mul_f32 v115, v115, v254
    s_waitcnt lgkmcnt(4)
    v_mfma_f32_16x16x32_bf16 v[216:219], v[176:179], a[32:35], v[216:219]
    ds_read_b128 v[168:171], v248 offset:8192
    s_add_u32 s72, s72, 18874368
    v_mfma_f32_16x16x32_bf16 v[216:219], v[180:183], a[36:39], v[216:219]
    buffer_load_dwordx4 a[112:115], v11, s[16:19], s20 offen offset:0 sc1
    v_cvt_pk_bf16_f32 v128, v112, v113
    v_mfma_f32_16x16x32_bf16 v[220:223], v[180:183], a[44:47], v[220:223]
    ds_read_b128 v[172:175], v248 offset:17408
    v_cvt_pk_bf16_f32 v129, v114, v115
    v_mul_f32 v144, v144, v160
    v_mul_f32 v145, v145, v161
    v_mfma_f32_16x16x32_bf16 v[220:223], v[176:179], a[40:43], v[220:223]
    s_lshr_b32 s74, s82, 2
    v_mul_f32 v146, v146, v162
    v_mul_f32 v147, v147, v163
    s_waitcnt lgkmcnt(4)
    v_mfma_f32_16x16x32_bf16 v[224:227], v[184:187], a[32:35], v[224:227]
    ds_read_b128 v[176:179], v248 offset:18432
    v_mul_f32 v144, v144, v254
    v_mul_f32 v145, v145, v254
    v_mfma_f32_16x16x32_bf16 v[224:227], v[188:191], a[36:39], v[224:227]
    v_mul_f32 v146, v146, v254
    v_mul_f32 v147, v147, v254
    v_cvt_pk_bf16_f32 v130, v144, v145
    v_mfma_f32_16x16x32_bf16 v[228:231], v[188:191], a[44:47], v[228:231]
    ds_read_b128 v[180:183], v248 offset:27648
    s_lshl_b32 s74, s74, 1
    v_cvt_pk_bf16_f32 v131, v146, v147
    v_mfma_f32_16x16x32_bf16 v[228:231], v[184:187], a[40:43], v[228:231]
    buffer_load_dwordx4 a[116:119], v11, s[16:19], s20 offen offset:1024 sc1
    buffer_store_dwordx4 v[128:131], v11, s[16:19], s68 offen offset:1024 sc1
    s_waitcnt lgkmcnt(4)
    v_mfma_f32_16x16x32_bf16 v[232:235], v[192:195], a[32:35], v[232:235]
    ds_read_b128 v[184:187], v248 offset:19456
    v_mul_f32 v118, v118, v134
    v_mfma_f32_16x16x32_bf16 v[232:235], v[196:199], a[36:39], v[232:235]
    s_add_u32 s74, s74, s58
    v_mul_f32 v119, v119, v135
    v_mfma_f32_16x16x32_bf16 v[236:239], v[196:199], a[44:47], v[236:239]
    ds_read_b128 v[188:191], v248 offset:28672
    v_mul_f32 v116, v116, v255
    v_mfma_f32_16x16x32_bf16 v[236:239], v[192:195], a[40:43], v[236:239]
    v_mul_f32 v117, v117, v255
    s_waitcnt lgkmcnt(4)
    v_mfma_f32_16x16x32_bf16 v[240:243], v[168:171], a[32:35], v[240:243]
    ds_read_b128 v[192:195], v248 offset:20480
    buffer_load_dwordx4 a[120:123], v11, s[16:19], s21 offen offset:0 sc1
    v_mfma_f32_16x16x32_bf16 v[240:243], v[172:175], a[36:39], v[240:243]
    s_lshl_b32 s74, s74, 12
    v_mul_f32 v118, v118, v255
    v_mfma_f32_16x16x32_bf16 v[244:247], v[172:175], a[44:47], v[244:247]
    ds_read_b128 v[196:199], v248 offset:29696
    v_mul_f32 v119, v119, v255
    v_mfma_f32_16x16x32_bf16 v[244:247], v[168:171], a[40:43], v[244:247]
    s_and_b32 s76, s82, 3
    s_waitcnt lgkmcnt(4)
    v_mfma_f32_16x16x32_bf16 v[16:19], v[176:179], a[48:51], v[16:19]
    ds_read_b128 v[168:171], v248 offset:21504
    v_cvt_pk_bf16_f32 v132, v116, v117
    v_mfma_f32_16x16x32_bf16 v[16:19], v[180:183], a[52:55], v[16:19]
    buffer_load_dwordx4 a[124:127], v11, s[16:19], s21 offen offset:1024 sc1
    v_cvt_pk_bf16_f32 v133, v118, v119
    v_mul_f32 v148, v148, v164
    v_mul_f32 v149, v149, v165
    v_mfma_f32_16x16x32_bf16 v[20:23], v[180:183], a[60:63], v[20:23]
    ds_read_b128 v[172:175], v248 offset:30720
    s_lshl_b32 s76, s76, 6
    v_mul_f32 v150, v150, v166
    v_mul_f32 v151, v151, v167
    v_mfma_f32_16x16x32_bf16 v[20:23], v[176:179], a[56:59], v[20:23]
    v_mul_f32 v148, v148, v255
    v_mul_f32 v149, v149, v255
    s_waitcnt lgkmcnt(4)
    v_mfma_f32_16x16x32_bf16 v[24:27], v[184:187], a[48:51], v[24:27]
    ds_read_b128 v[176:179], v248 offset:22528
    v_mul_f32 v150, v150, v255
    v_mul_f32 v151, v151, v255
    v_mfma_f32_16x16x32_bf16 v[24:27], v[188:191], a[52:55], v[24:27]
    s_add_u32 s74, s74, s76
    v_cvt_pk_bf16_f32 v134, v148, v149
    v_cvt_pk_bf16_f32 v135, v150, v151
    v_mfma_f32_16x16x32_bf16 v[28:31], v[188:191], a[60:63], v[28:31]
    ds_read_b128 v[180:183], v248 offset:31744
    buffer_store_dwordx4 v[132:135], v11, s[16:19], s69 offen offset:1024 sc1
    v_mfma_f32_16x16x32_bf16 v[28:31], v[184:187], a[56:59], v[28:31]
    s_add_u32 s20, s20, s28
    s_waitcnt lgkmcnt(4)
    v_mfma_f32_16x16x32_bf16 v[32:35], v[192:195], a[48:51], v[32:35]
    ds_read_b128 v[184:187], v248 offset:23552
    v_mfma_f32_16x16x32_bf16 v[32:35], v[196:199], a[52:55], v[32:35]
    s_add_u32 s74, s74, 20971520
    v_mfma_f32_16x16x32_bf16 v[36:39], v[196:199], a[60:63], v[36:39]
    ds_read_b128 v[188:191], v248 offset:32768
    v_mfma_f32_16x16x32_bf16 v[36:39], v[192:195], a[56:59], v[36:39]
    s_waitcnt lgkmcnt(4)
    v_mfma_f32_16x16x32_bf16 v[200:203], v[168:171], a[48:51], v[200:203]
    ds_read_b128 v[192:195], v248 offset:24576
    s_add_u32 s21, s21, s28
    v_mfma_f32_16x16x32_bf16 v[200:203], v[172:175], a[52:55], v[200:203]
    s_cmp_ge_u32 s58, 2
    s_cselect_b32 s74, 1073741824, s74
    v_mfma_f32_16x16x32_bf16 v[204:207], v[172:175], a[60:63], v[204:207]
    ds_read_b128 v[196:199], v248 offset:33792
    v_mfma_f32_16x16x32_bf16 v[204:207], v[168:171], a[56:59], v[204:207]
    s_lshl_b32 s73, s83, 2
    s_waitcnt lgkmcnt(4)
    v_mfma_f32_16x16x32_bf16 v[208:211], v[176:179], a[48:51], v[208:211]
    ds_read_b128 v[168:171], v248 offset:25600
    v_mfma_f32_16x16x32_bf16 v[208:211], v[180:183], a[52:55], v[208:211]
    s_add_u32 s73, s73, s58
    v_mfma_f32_16x16x32_bf16 v[212:215], v[180:183], a[60:63], v[212:215]
    ds_read_b128 v[172:175], v248 offset:34816
    v_mfma_f32_16x16x32_bf16 v[212:215], v[176:179], a[56:59], v[212:215]
    s_waitcnt lgkmcnt(4)
    v_mfma_f32_16x16x32_bf16 v[216:219], v[184:187], a[48:51], v[216:219]
    ds_read_b128 v[176:179], v248 offset:26624
    v_mfma_f32_16x16x32_bf16 v[216:219], v[188:191], a[52:55], v[216:219]
    s_lshl_b32 s73, s73, 12
    v_mfma_f32_16x16x32_bf16 v[220:223], v[188:191], a[60:63], v[220:223]
    ds_read_b128 v[180:183], v248 offset:35840
    v_mfma_f32_16x16x32_bf16 v[220:223], v[184:187], a[56:59], v[220:223]
    s_waitcnt vmcnt(20)
    s_barrier
    s_waitcnt lgkmcnt(4)
    v_mfma_f32_16x16x32_bf16 v[224:227], v[192:195], a[48:51], v[224:227]
    ds_read_b128 v[184:187], v250 offset:0
    s_add_u32 s73, s73, 18874368
    v_mfma_f32_16x16x32_bf16 v[224:227], v[196:199], a[52:55], v[224:227]
    v_mfma_f32_16x16x32_bf16 v[228:231], v[196:199], a[60:63], v[228:231]
    ds_read_b128 v[188:191], v250 offset:9216
    v_mfma_f32_16x16x32_bf16 v[228:231], v[192:195], a[56:59], v[228:231]
    s_lshr_b32 s75, s83, 2
    s_waitcnt lgkmcnt(4)
    v_mfma_f32_16x16x32_bf16 v[232:235], v[168:171], a[48:51], v[232:235]
    ds_read_b128 v[192:195], v250 offset:1024
    v_mfma_f32_16x16x32_bf16 v[232:235], v[172:175], a[52:55], v[232:235]
    s_lshl_b32 s75, s75, 1
    v_mfma_f32_16x16x32_bf16 v[236:239], v[172:175], a[60:63], v[236:239]
    ds_read_b128 v[196:199], v250 offset:10240
    v_mfma_f32_16x16x32_bf16 v[236:239], v[168:171], a[56:59], v[236:239]
    s_waitcnt lgkmcnt(4)
    v_mfma_f32_16x16x32_bf16 v[240:243], v[176:179], a[48:51], v[240:243]
    ds_read_b128 v[168:171], v250 offset:2048
    v_mfma_f32_16x16x32_bf16 v[240:243], v[180:183], a[52:55], v[240:243]
    s_add_u32 s75, s75, s58
    v_mfma_f32_16x16x32_bf16 v[244:247], v[180:183], a[60:63], v[244:247]
    ds_read_b128 v[172:175], v250 offset:11264
    v_mfma_f32_16x16x32_bf16 v[244:247], v[176:179], a[56:59], v[244:247]
    s_waitcnt lgkmcnt(4)
    v_mfma_f32_16x16x32_bf16 v[16:19], v[184:187], a[64:67], v[16:19]
    ds_read_b128 v[176:179], v250 offset:3072
    s_lshl_b32 s75, s75, 12
    v_mfma_f32_16x16x32_bf16 v[16:19], v[188:191], a[68:71], v[16:19]
    s_add_u32 m0, s26, 36864
    buffer_load_dwordx4 a[0:3], v11, s[16:19], s20 offen offset:0 sc1
    v_mfma_f32_16x16x32_bf16 v[20:23], v[188:191], a[76:79], v[20:23]
    ds_read_b128 v[180:183], v250 offset:12288
    s_mov_b32 s25, s22
    v_mfma_f32_16x16x32_bf16 v[20:23], v[184:187], a[72:75], v[20:23]
    s_and_b32 s76, s83, 3
    s_waitcnt lgkmcnt(4)
    v_mfma_f32_16x16x32_bf16 v[24:27], v[192:195], a[64:67], v[24:27]
    ds_read_b128 v[184:187], v250 offset:4096
    v_mfma_f32_16x16x32_bf16 v[24:27], v[196:199], a[68:71], v[24:27]
    buffer_load_dwordx4 v11, s[4:7], s25 offen offset:0 sc1 lds
    buffer_load_dwordx4 a[4:7], v11, s[16:19], s20 offen offset:1024 sc1
    v_mfma_f32_16x16x32_bf16 v[28:31], v[196:199], a[76:79], v[28:31]
    ds_read_b128 v[188:191], v250 offset:13312
    s_lshl_b32 s76, s76, 6
    v_mfma_f32_16x16x32_bf16 v[28:31], v[192:195], a[72:75], v[28:31]
    s_waitcnt lgkmcnt(4)
    v_mfma_f32_16x16x32_bf16 v[32:35], v[168:171], a[64:67], v[32:35]
    ds_read_b128 v[192:195], v250 offset:5120
    v_mfma_f32_16x16x32_bf16 v[32:35], v[172:175], a[68:71], v[32:35]
    s_add_u32 s75, s75, s76
    s_add_u32 s25, s25, s23
    v_mfma_f32_16x16x32_bf16 v[36:39], v[172:175], a[76:79], v[36:39]
    ds_read_b128 v[196:199], v250 offset:14336
    buffer_load_dwordx4 a[8:11], v11, s[16:19], s21 offen offset:0 sc1
    v_mfma_f32_16x16x32_bf16 v[36:39], v[168:171], a[72:75], v[36:39]
    buffer_load_dwordx4 v11, s[4:7], s25 offen offset:1024 sc1 lds
    s_waitcnt lgkmcnt(4)
    v_mfma_f32_16x16x32_bf16 v[200:203], v[176:179], a[64:67], v[200:203]
    ds_read_b128 v[168:171], v250 offset:6144
    s_add_u32 s75, s75, 20971520
    v_mfma_f32_16x16x32_bf16 v[200:203], v[180:183], a[68:71], v[200:203]
    s_cmp_ge_u32 s58, 2
    s_cselect_b32 s75, 1073741824, s75
    v_mfma_f32_16x16x32_bf16 v[204:207], v[180:183], a[76:79], v[204:207]
    ds_read_b128 v[172:175], v250 offset:15360
    v_mfma_f32_16x16x32_bf16 v[204:207], v[176:179], a[72:75], v[204:207]
    s_add_u32 s25, s25, s23
    s_waitcnt lgkmcnt(4)
    v_mfma_f32_16x16x32_bf16 v[208:211], v[184:187], a[64:67], v[208:211]
    ds_read_b128 v[176:179], v250 offset:7168
    buffer_load_dwordx4 a[12:15], v11, s[16:19], s21 offen offset:1024 sc1
    v_mfma_f32_16x16x32_bf16 v[208:211], v[188:191], a[68:71], v[208:211]
    buffer_load_dwordx4 v11, s[4:7], s25 offen offset:2048 sc1 lds
    v_mfma_f32_16x16x32_bf16 v[212:215], v[188:191], a[76:79], v[212:215]
    ds_read_b128 v[180:183], v250 offset:16384
    v_mfma_f32_16x16x32_bf16 v[212:215], v[184:187], a[72:75], v[212:215]
    s_waitcnt lgkmcnt(4)
    v_mfma_f32_16x16x32_bf16 v[216:219], v[192:195], a[64:67], v[216:219]
    ds_read_b128 v[184:187], v250 offset:8192
    v_mfma_f32_16x16x32_bf16 v[216:219], v[196:199], a[68:71], v[216:219]
    s_add_u32 s25, s25, s23
    s_add_u32 s20, s20, 2048
    v_mfma_f32_16x16x32_bf16 v[220:223], v[196:199], a[76:79], v[220:223]
    ds_read_b128 v[188:191], v250 offset:17408
    v_mfma_f32_16x16x32_bf16 v[220:223], v[192:195], a[72:75], v[220:223]
    buffer_load_dwordx4 v11, s[4:7], s25 offen offset:3072 sc1 lds
    s_waitcnt lgkmcnt(4)
    v_mfma_f32_16x16x32_bf16 v[224:227], v[168:171], a[64:67], v[224:227]
    ds_read_b128 v[192:195], v250 offset:18432
    v_mfma_f32_16x16x32_bf16 v[224:227], v[172:175], a[68:71], v[224:227]
    v_mfma_f32_16x16x32_bf16 v[228:231], v[172:175], a[76:79], v[228:231]
    ds_read_b128 v[196:199], v250 offset:27648
    s_add_u32 m0, s26, 40960
    v_mfma_f32_16x16x32_bf16 v[228:231], v[168:171], a[72:75], v[228:231]
    s_add_u32 s21, s21, 2048
    s_waitcnt lgkmcnt(4)
    v_mfma_f32_16x16x32_bf16 v[232:235], v[176:179], a[64:67], v[232:235]
    ds_read_b128 v[168:171], v250 offset:19456
    v_mfma_f32_16x16x32_bf16 v[232:235], v[180:183], a[68:71], v[232:235]
    s_add_u32 s25, s25, s24
    v_mfma_f32_16x16x32_bf16 v[236:239], v[180:183], a[76:79], v[236:239]
    ds_read_b128 v[172:175], v250 offset:28672
    v_mfma_f32_16x16x32_bf16 v[236:239], v[176:179], a[72:75], v[236:239]
    s_waitcnt lgkmcnt(4)
    v_mfma_f32_16x16x32_bf16 v[240:243], v[184:187], a[64:67], v[240:243]
    ds_read_b128 v[176:179], v250 offset:20480
    buffer_load_dwordx4 v11, s[4:7], s25 offen offset:0 sc1 lds
L_wm8:
    s_cbranch_execz L_wm_done
    v_mfma_f32_16x16x32_bf16 v[240:243], v[188:191], a[68:71], v[240:243]
    v_mfma_f32_16x16x32_bf16 v[244:247], v[188:191], a[76:79], v[244:247]
    ds_read_b128 v[180:183], v250 offset:29696
    v_mfma_f32_16x16x32_bf16 v[244:247], v[184:187], a[72:75], v[244:247]
    s_add_u32 s25, s25, s23
    s_waitcnt lgkmcnt(4)
    v_mfma_f32_16x16x32_bf16 v[16:19], v[192:195], a[80:83], v[16:19]
    ds_read_b128 v[184:187], v250 offset:21504
    buffer_load_dwordx4 a[16:19], v11, s[16:19], s20 offen offset:0 sc1
    v_mfma_f32_16x16x32_bf16 v[16:19], v[196:199], a[84:87], v[16:19]
    v_mfma_f32_16x16x32_bf16 v[20:23], v[196:199], a[92:95], v[20:23]
    ds_read_b128 v[188:191], v250 offset:30720
    buffer_load_dwordx4 v11, s[4:7], s25 offen offset:1024 sc1 lds
    v_mfma_f32_16x16x32_bf16 v[20:23], v[192:195], a[88:91], v[20:23]
    s_waitcnt lgkmcnt(4)
    v_mfma_f32_16x16x32_bf16 v[24:27], v[168:171], a[80:83], v[24:27]
    ds_read_b128 v[192:195], v250 offset:22528
    buffer_load_dwordx4 a[20:23], v11, s[16:19], s20 offen offset:1024 sc1
    v_mfma_f32_16x16x32_bf16 v[24:27], v[172:175], a[84:87], v[24:27]
    s_add_u32 s25, s25, s23
    v_mfma_f32_16x16x32_bf16 v[28:31], v[172:175], a[92:95], v[28:31]
    ds_read_b128 v[196:199], v250 offset:31744
    v_mfma_f32_16x16x32_bf16 v[28:31], v[168:171], a[88:91], v[28:31]
    s_waitcnt lgkmcnt(4)
    v_mfma_f32_16x16x32_bf16 v[32:35], v[176:179], a[80:83], v[32:35]
    ds_read_b128 v[168:171], v250 offset:23552
    buffer_load_dwordx4 v11, s[4:7], s25 offen offset:2048 sc1 lds
    v_mfma_f32_16x16x32_bf16 v[32:35], v[180:183], a[84:87], v[32:35]
    buffer_load_dwordx4 a[24:27], v11, s[16:19], s21 offen offset:0 sc1
    v_mfma_f32_16x16x32_bf16 v[36:39], v[180:183], a[92:95], v[36:39]
    ds_read_b128 v[172:175], v250 offset:32768
    v_mfma_f32_16x16x32_bf16 v[36:39], v[176:179], a[88:91], v[36:39]
    s_add_u32 s25, s25, s23
    s_waitcnt lgkmcnt(4)
    v_mfma_f32_16x16x32_bf16 v[200:203], v[184:187], a[80:83], v[200:203]
    ds_read_b128 v[176:179], v250 offset:24576
    buffer_load_dwordx4 a[28:31], v11, s[16:19], s21 offen offset:1024 sc1
    v_mfma_f32_16x16x32_bf16 v[200:203], v[188:191], a[84:87], v[200:203]
    buffer_load_dwordx4 v11, s[4:7], s25 offen offset:3072 sc1 lds
    v_mfma_f32_16x16x32_bf16 v[204:207], v[188:191], a[92:95], v[204:207]
    ds_read_b128 v[180:183], v250 offset:33792
    v_mfma_f32_16x16x32_bf16 v[204:207], v[184:187], a[88:91], v[204:207]
    s_waitcnt lgkmcnt(4)
    v_mfma_f32_16x16x32_bf16 v[208:211], v[192:195], a[80:83], v[208:211]
    ds_read_b128 v[184:187], v250 offset:25600
    s_add_u32 s20, s20, 49152
    v_mfma_f32_16x16x32_bf16 v[208:211], v[196:199], a[84:87], v[208:211]
    s_add_u32 m0, s26, 45056
    v_mfma_f32_16x16x32_bf16 v[212:215], v[196:199], a[92:95], v[212:215]
    ds_read_b128 v[188:191], v250 offset:34816
    v_mfma_f32_16x16x32_bf16 v[212:215], v[192:195], a[88:91], v[212:215]
    s_add_u32 s25, s25, s24
    s_waitcnt lgkmcnt(4)
    v_mfma_f32_16x16x32_bf16 v[216:219], v[168:171], a[80:83], v[216:219]
    ds_read_b128 v[192:195], v250 offset:26624
    s_add_u32 s21, s21, 49152
    v_mfma_f32_16x16x32_bf16 v[216:219], v[172:175], a[84:87], v[216:219]
    v_mfma_f32_16x16x32_bf16 v[220:223], v[172:175], a[92:95], v[220:223]
    ds_read_b128 v[196:199], v250 offset:35840
    buffer_load_dwordx4 v11, s[4:7], s25 offen offset:0 sc1 lds
    v_mfma_f32_16x16x32_bf16 v[220:223], v[168:171], a[88:91], v[220:223]
    s_waitcnt vmcnt(25)
    s_barrier
    s_waitcnt lgkmcnt(4)
    v_mfma_f32_16x16x32_bf16 v[224:227], v[176:179], a[80:83], v[224:227]
    ds_read_b128 v[168:171], v251 offset:0
    s_sub_u32 s20, s20, s28
    v_mfma_f32_16x16x32_bf16 v[224:227], v[180:183], a[84:87], v[224:227]
    s_add_u32 s22, s22, 589824
    v_mfma_f32_16x16x32_bf16 v[228:231], v[180:183], a[92:95], v[228:231]
    ds_read_b128 v[172:175], v251 offset:9216
    v_mfma_f32_16x16x32_bf16 v[228:231], v[176:179], a[88:91], v[228:231]
    s_waitcnt lgkmcnt(4)
    v_mfma_f32_16x16x32_bf16 v[232:235], v[184:187], a[80:83], v[232:235]
    ds_read_b128 v[176:179], v251 offset:1024
    s_sub_u32 s21, s21, s28
    v_mfma_f32_16x16x32_bf16 v[232:235], v[188:191], a[84:87], v[232:235]
    v_mfma_f32_16x16x32_bf16 v[236:239], v[188:191], a[92:95], v[236:239]
    ds_read_b128 v[180:183], v251 offset:10240
    s_lshl_b32 s38, s58, 8
    s_lshl_b32 s0, s56, 2
    v_mfma_f32_16x16x32_bf16 v[236:239], v[184:187], a[88:91], v[236:239]
    s_add_u32 s38, s38, s59
    s_add_u32 s0, s0, s58
    s_lshl_b32 s0, s0, 3
    s_waitcnt lgkmcnt(4)
    v_mfma_f32_16x16x32_bf16 v[240:243], v[192:195], a[80:83], v[240:243]
    ds_read_b128 v[184:187], v251 offset:2048
    s_lshr_b32 s38, s38, 2
    s_lshl_b32 s0, s0, 7
    s_add_u32 s0, s0, 28442624
    v_mfma_f32_16x16x32_bf16 v[240:243], v[196:199], a[84:87], v[240:243]
    s_lshl_b32 s38, s38, 7
    s_add_u32 s38, s38, 28377088
    s_cmp_eq_u32 s54, 0
    s_cselect_b32 s0, s0, 1073741824
    v_mfma_f32_16x16x32_bf16 v[244:247], v[196:199], a[92:95], v[244:247]
    ds_read_b128 v[188:191], v251 offset:11264
    v_mov_b32 v12, s80
    v_bfe_u32 v1, v11, 4, 3
    v_lshlrev_b32 v1, 7, v1
    v_mfma_f32_16x16x32_bf16 v[244:247], v[192:195], a[88:91], v[244:247]
    s_waitcnt vmcnt(17)
    s_barrier
    buffer_store_dword v12, v0, s[16:19], s38 offen sc1
    buffer_load_dword v1, v1, s[16:19], s0 offen sc1
    s_waitcnt lgkmcnt(4)
    v_mfma_f32_16x16x32_bf16 v[16:19], v[168:171], a[96:99], v[16:19]
    ds_read_b128 v[192:195], v251 offset:3072
    s_add_u32 m0, s26, 0
    v_mfma_f32_16x16x32_bf16 v[16:19], v[172:175], a[100:103], v[16:19]
    v_mfma_f32_16x16x32_bf16 v[20:23], v[172:175], a[108:111], v[20:23]
    ds_read_b128 v[196:199], v251 offset:12288
    v_mfma_f32_16x16x32_bf16 v[20:23], v[168:171], a[104:107], v[20:23]
    s_mov_b32 s25, s22
    s_waitcnt lgkmcnt(4)
    v_mfma_f32_16x16x32_bf16 v[24:27], v[176:179], a[96:99], v[24:27]
    ds_read_b128 v[168:171], v251 offset:4096
    v_mfma_f32_16x16x32_bf16 v[24:27], v[180:183], a[100:103], v[24:27]
    buffer_load_dwordx4 v11, s[4:7], s25 offen offset:0 sc1 lds
    v_mfma_f32_16x16x32_bf16 v[28:31], v[180:183], a[108:111], v[28:31]
    ds_read_b128 v[172:175], v251 offset:13312
    v_mfma_f32_16x16x32_bf16 v[28:31], v[176:179], a[104:107], v[28:31]
    s_waitcnt lgkmcnt(4)
    v_mfma_f32_16x16x32_bf16 v[32:35], v[184:187], a[96:99], v[32:35]
    ds_read_b128 v[176:179], v251 offset:5120
    v_mfma_f32_16x16x32_bf16 v[32:35], v[188:191], a[100:103], v[32:35]
    s_add_u32 s25, s25, s23
    v_mfma_f32_16x16x32_bf16 v[36:39], v[188:191], a[108:111], v[36:39]
    ds_read_b128 v[180:183], v251 offset:14336
    v_mfma_f32_16x16x32_bf16 v[36:39], v[184:187], a[104:107], v[36:39]
    buffer_load_dwordx4 v11, s[4:7], s25 offen offset:1024 sc1 lds
    s_waitcnt lgkmcnt(4)
    v_mfma_f32_16x16x32_bf16 v[200:203], v[192:195], a[96:99], v[200:203]
    ds_read_b128 v[184:187], v251 offset:6144
    v_mfma_f32_16x16x32_bf16 v[200:203], v[196:199], a[100:103], v[200:203]
    v_mfma_f32_16x16x32_bf16 v[204:207], v[196:199], a[108:111], v[204:207]
    ds_read_b128 v[188:191], v251 offset:15360
    s_add_u32 s25, s25, s23
    v_mfma_f32_16x16x32_bf16 v[204:207], v[192:195], a[104:107], v[204:207]
    s_waitcnt lgkmcnt(4)
    v_mfma_f32_16x16x32_bf16 v[208:211], v[168:171], a[96:99], v[208:211]
    ds_read_b128 v[192:195], v251 offset:7168
    v_mfma_f32_16x16x32_bf16 v[208:211], v[172:175], a[100:103], v[208:211]
    buffer_load_dwordx4 v11, s[4:7], s25 offen offset:2048 sc1 lds
    v_mfma_f32_16x16x32_bf16 v[212:215], v[172:175], a[108:111], v[212:215]
    ds_read_b128 v[196:199], v251 offset:16384
    v_mfma_f32_16x16x32_bf16 v[212:215], v[168:171], a[104:107], v[212:215]
    s_add_u32 s25, s25, s23
    s_waitcnt lgkmcnt(4)
    v_mfma_f32_16x16x32_bf16 v[216:219], v[176:179], a[96:99], v[216:219]
    ds_read_b128 v[168:171], v251 offset:8192
    v_mfma_f32_16x16x32_bf16 v[216:219], v[180:183], a[100:103], v[216:219]
    v_mfma_f32_16x16x32_bf16 v[220:223], v[180:183], a[108:111], v[220:223]
    ds_read_b128 v[172:175], v251 offset:17408
    buffer_load_dwordx4 v11, s[4:7], s25 offen offset:3072 sc1 lds
    v_mfma_f32_16x16x32_bf16 v[220:223], v[176:179], a[104:107], v[220:223]
    s_waitcnt lgkmcnt(4)
    v_mfma_f32_16x16x32_bf16 v[224:227], v[184:187], a[96:99], v[224:227]
    ds_read_b128 v[176:179], v251 offset:18432
    v_mfma_f32_16x16x32_bf16 v[224:227], v[188:191], a[100:103], v[224:227]
    s_add_u32 m0, s26, 4096
    v_mfma_f32_16x16x32_bf16 v[228:231], v[188:191], a[108:111], v[228:231]
    ds_read_b128 v[180:183], v251 offset:27648
    v_mfma_f32_16x16x32_bf16 v[228:231], v[184:187], a[104:107], v[228:231]
    s_waitcnt lgkmcnt(4)
    v_mfma_f32_16x16x32_bf16 v[232:235], v[192:195], a[96:99], v[232:235]
    ds_read_b128 v[184:187], v251 offset:19456
    s_add_u32 s25, s25, s24
    v_mfma_f32_16x16x32_bf16 v[232:235], v[196:199], a[100:103], v[232:235]
    v_mfma_f32_16x16x32_bf16 v[236:239], v[196:199], a[108:111], v[236:239]
    ds_read_b128 v[188:191], v251 offset:28672
    v_mfma_f32_16x16x32_bf16 v[236:239], v[192:195], a[104:107], v[236:239]
    buffer_load_dwordx4 v11, s[4:7], s25 offen offset:0 sc1 lds
    s_waitcnt lgkmcnt(4)
    v_mfma_f32_16x16x32_bf16 v[240:243], v[168:171], a[96:99], v[240:243]
    ds_read_b128 v[192:195], v251 offset:20480
    v_mfma_f32_16x16x32_bf16 v[240:243], v[172:175], a[100:103], v[240:243]
    s_add_u32 s25, s25, s23
    v_mfma_f32_16x16x32_bf16 v[244:247], v[172:175], a[108:111], v[244:247]
    ds_read_b128 v[196:199], v251 offset:29696
    v_mfma_f32_16x16x32_bf16 v[244:247], v[168:171], a[104:107], v[244:247]
    s_waitcnt lgkmcnt(4)
    v_mfma_f32_16x16x32_bf16 v[16:19], v[176:179], a[112:115], v[16:19]
    ds_read_b128 v[168:171], v251 offset:21504
    buffer_load_dwordx4 v11, s[4:7], s25 offen offset:1024 sc1 lds
    v_mfma_f32_16x16x32_bf16 v[16:19], v[180:183], a[116:119], v[16:19]
    v_mfma_f32_16x16x32_bf16 v[20:23], v[180:183], a[124:127], v[20:23]
    ds_read_b128 v[172:175], v251 offset:30720
    v_mfma_f32_16x16x32_bf16 v[20:23], v[176:179], a[120:123], v[20:23]
    s_add_u32 s25, s25, s23
    s_waitcnt lgkmcnt(4)
    v_mfma_f32_16x16x32_bf16 v[24:27], v[184:187], a[112:115], v[24:27]
    ds_read_b128 v[176:179], v251 offset:22528
    v_mfma_f32_16x16x32_bf16 v[24:27], v[188:191], a[116:119], v[24:27]
    buffer_load_dwordx4 v11, s[4:7], s25 offen offset:2048 sc1 lds
    v_mfma_f32_16x16x32_bf16 v[28:31], v[188:191], a[124:127], v[28:31]
    ds_read_b128 v[180:183], v251 offset:31744
    v_mfma_f32_16x16x32_bf16 v[28:31], v[184:187], a[120:123], v[28:31]
    s_waitcnt lgkmcnt(4)
    v_mfma_f32_16x16x32_bf16 v[32:35], v[192:195], a[112:115], v[32:35]
    ds_read_b128 v[184:187], v251 offset:23552
    v_mfma_f32_16x16x32_bf16 v[32:35], v[196:199], a[116:119], v[32:35]
    s_add_u32 s25, s25, s23
    v_mfma_f32_16x16x32_bf16 v[36:39], v[196:199], a[124:127], v[36:39]
    ds_read_b128 v[188:191], v251 offset:32768
    v_mfma_f32_16x16x32_bf16 v[36:39], v[192:195], a[120:123], v[36:39]
    buffer_load_dwordx4 v11, s[4:7], s25 offen offset:3072 sc1 lds
    s_waitcnt lgkmcnt(4)
    v_mfma_f32_16x16x32_bf16 v[200:203], v[168:171], a[112:115], v[200:203]
    ds_read_b128 v[192:195], v251 offset:24576
    v_mfma_f32_16x16x32_bf16 v[200:203], v[172:175], a[116:119], v[200:203]
    s_waitcnt vmcnt(8)
    v_cmp_ne_u32 vcc, s1, v1
    v_mfma_f32_16x16x32_bf16 v[204:207], v[172:175], a[124:127], v[204:207]
    ds_read_b128 v[196:199], v251 offset:33792
    s_add_u32 m0, s26, 8192
    v_mfma_f32_16x16x32_bf16 v[204:207], v[168:171], a[120:123], v[204:207]
    s_mov_b32 s0, s0
    s_cbranch_vccnz L_slow_m3
L_ok_m3:
    s_waitcnt lgkmcnt(4)
    v_mfma_f32_16x16x32_bf16 v[208:211], v[176:179], a[112:115], v[208:211]
    ds_read_b128 v[168:171], v251 offset:25600
    v_mfma_f32_16x16x32_bf16 v[208:211], v[180:183], a[116:119], v[208:211]
    s_add_u32 s25, s25, s24
    v_mfma_f32_16x16x32_bf16 v[212:215], v[180:183], a[124:127], v[212:215]
    ds_read_b128 v[172:175], v251 offset:34816
    v_mfma_f32_16x16x32_bf16 v[212:215], v[176:179], a[120:123], v[212:215]
    s_waitcnt lgkmcnt(4)
    v_mfma_f32_16x16x32_bf16 v[216:219], v[184:187], a[112:115], v[216:219]
    ds_read_b128 v[176:179], v251 offset:26624
    buffer_load_dwordx4 v11, s[4:7], s25 offen offset:0 sc1 lds
    v_mfma_f32_16x16x32_bf16 v[216:219], v[188:191], a[116:119], v[216:219]
    v_mfma_f32_16x16x32_bf16 v[220:223], v[188:191], a[124:127], v[220:223]
    ds_read_b128 v[180:183], v251 offset:35840
    s_add_u32 s22, s22, 1327104
    v_mfma_f32_16x16x32_bf16 v[220:223], v[184:187], a[120:123], v[220:223]
    s_barrier
    s_waitcnt lgkmcnt(4)
    v_mfma_f32_16x16x32_bf16 v[224:227], v[192:195], a[112:115], v[224:227]
    ds_read_b128 v[184:187], v249 offset:0
    v_mfma_f32_16x16x32_bf16 v[224:227], v[196:199], a[116:119], v[224:227]
    s_sub_u32 s22, s22, s27
    buffer_load_dwordx2 a[32:33], v2, s[16:19], s72 offen offset:0 sc1
    v_mfma_f32_16x16x32_bf16 v[228:231], v[196:199], a[124:127], v[228:231]
    ds_read_b128 v[188:191], v249 offset:9216
    v_mfma_f32_16x16x32_bf16 v[228:231], v[192:195], a[120:123], v[228:231]
    s_waitcnt lgkmcnt(4)
    v_mfma_f32_16x16x32_bf16 v[232:235], v[168:171], a[112:115], v[232:235]
    ds_read_b128 v[192:195], v249 offset:1024
    v_mfma_f32_16x16x32_bf16 v[232:235], v[172:175], a[116:119], v[232:235]
    buffer_load_dwordx2 a[34:35], v2, s[16:19], s72 offen offset:512 sc1
    v_mfma_f32_16x16x32_bf16 v[236:239], v[172:175], a[124:127], v[236:239]
    ds_read_b128 v[196:199], v249 offset:10240
    v_mfma_f32_16x16x32_bf16 v[236:239], v[168:171], a[120:123], v[236:239]
    s_waitcnt lgkmcnt(4)
    v_mfma_f32_16x16x32_bf16 v[240:243], v[176:179], a[112:115], v[240:243]
    ds_read_b128 v[168:171], v249 offset:2048
    v_mfma_f32_16x16x32_bf16 v[240:243], v[180:183], a[116:119], v[240:243]
    buffer_load_dwordx2 a[36:37], v2, s[16:19], s72 offen offset:1024 sc1
    v_mfma_f32_16x16x32_bf16 v[244:247], v[180:183], a[124:127], v[244:247]
    ds_read_b128 v[172:175], v249 offset:11264
    v_mfma_f32_16x16x32_bf16 v[244:247], v[176:179], a[120:123], v[244:247]
    s_waitcnt lgkmcnt(4)
    v_mfma_f32_16x16x32_bf16 v[16:19], v[184:187], a[0:3], v[16:19]
    ds_read_b128 v[176:179], v249 offset:3072
    s_add_u32 m0, s26, 73728
    v_mfma_f32_16x16x32_bf16 v[16:19], v[188:191], a[4:7], v[16:19]
    buffer_load_dwordx2 a[38:39], v2, s[16:19], s72 offen offset:1536 sc1
    v_mfma_f32_16x16x32_bf16 v[20:23], v[188:191], a[12:15], v[20:23]
    ds_read_b128 v[180:183], v249 offset:12288
    v_mfma_f32_16x16x32_bf16 v[20:23], v[184:187], a[8:11], v[20:23]
    s_mov_b32 s25, s22
    s_waitcnt lgkmcnt(4)
    v_mfma_f32_16x16x32_bf16 v[24:27], v[192:195], a[0:3], v[24:27]
    ds_read_b128 v[184:187], v249 offset:4096
    v_mfma_f32_16x16x32_bf16 v[24:27], v[196:199], a[4:7], v[24:27]
    buffer_load_dwordx2 a[40:41], v2, s[16:19], s73 offen offset:0 sc1
    v_mfma_f32_16x16x32_bf16 v[28:31], v[196:199], a[12:15], v[28:31]
    ds_read_b128 v[188:191], v249 offset:13312
    buffer_load_dwordx4 v11, s[4:7], s25 offen offset:0 sc1 lds
    v_mfma_f32_16x16x32_bf16 v[28:31], v[192:195], a[8:11], v[28:31]
    s_waitcnt lgkmcnt(4)
    v_mfma_f32_16x16x32_bf16 v[32:35], v[168:171], a[0:3], v[32:35]
    ds_read_b128 v[192:195], v249 offset:5120
    v_mfma_f32_16x16x32_bf16 v[32:35], v[172:175], a[4:7], v[32:35]
    s_add_u32 s25, s25, s23
    buffer_load_dwordx2 a[42:43], v2, s[16:19], s73 offen offset:512 sc1
    v_mfma_f32_16x16x32_bf16 v[36:39], v[172:175], a[12:15], v[36:39]
    ds_read_b128 v[196:199], v249 offset:14336
    v_mfma_f32_16x16x32_bf16 v[36:39], v[168:171], a[8:11], v[36:39]
    s_waitcnt lgkmcnt(4)
    v_mfma_f32_16x16x32_bf16 v[200:203], v[176:179], a[0:3], v[200:203]
    ds_read_b128 v[168:171], v249 offset:6144
    buffer_load_dwordx4 v11, s[4:7], s25 offen offset:1024 sc1 lds
    v_mfma_f32_16x16x32_bf16 v[200:203], v[180:183], a[4:7], v[200:203]
    buffer_load_dwordx2 a[44:45], v2, s[16:19], s73 offen offset:1024 sc1
    v_mfma_f32_16x16x32_bf16 v[204:207], v[180:183], a[12:15], v[204:207]
    ds_read_b128 v[172:175], v249 offset:15360
    v_mfma_f32_16x16x32_bf16 v[204:207], v[176:179], a[8:11], v[204:207]
    s_add_u32 s25, s25, s23
    s_waitcnt lgkmcnt(4)
    v_mfma_f32_16x16x32_bf16 v[208:211], v[184:187], a[0:3], v[208:211]
    ds_read_b128 v[176:179], v249 offset:7168
    v_mfma_f32_16x16x32_bf16 v[208:211], v[188:191], a[4:7], v[208:211]
    buffer_load_dwordx4 v11, s[4:7], s25 offen offset:2048 sc1 lds
    buffer_load_dwordx2 a[46:47], v2, s[16:19], s73 offen offset:1536 sc1
    v_mfma_f32_16x16x32_bf16 v[212:215], v[188:191], a[12:15], v[212:215]
    ds_read_b128 v[180:183], v249 offset:16384
    v_mfma_f32_16x16x32_bf16 v[212:215], v[184:187], a[8:11], v[212:215]
    s_waitcnt lgkmcnt(4)
    v_mfma_f32_16x16x32_bf16 v[216:219], v[192:195], a[0:3], v[216:219]
    ds_read_b128 v[184:187], v249 offset:8192
    v_mfma_f32_16x16x32_bf16 v[216:219], v[196:199], a[4:7], v[216:219]
    s_add_u32 s25, s25, s23
    v_mfma_f32_16x16x32_bf16 v[220:223], v[196:199], a[12:15], v[220:223]
    ds_read_b128 v[188:191], v249 offset:17408
    v_mfma_f32_16x16x32_bf16 v[220:223], v[192:195], a[8:11], v[220:223]
    buffer_load_dwordx4 v11, s[4:7], s25 offen offset:3072 sc1 lds
    s_waitcnt lgkmcnt(4)
    v_mfma_f32_16x16x32_bf16 v[224:227], v[168:171], a[0:3], v[224:227]
    ds_read_b128 v[192:195], v249 offset:18432
    v_mfma_f32_16x16x32_bf16 v[224:227], v[172:175], a[4:7], v[224:227]
    s_add_u32 m0, s26, 77824
    buffer_load_dwordx2 a[48:49], v2, s[16:19], s72 offen offset:2048 sc1
    v_mfma_f32_16x16x32_bf16 v[228:231], v[172:175], a[12:15], v[228:231]
    ds_read_b128 v[196:199], v249 offset:27648
    s_lshl_b32 s0, s58, 3
    v_mfma_f32_16x16x32_bf16 v[228:231], v[168:171], a[8:11], v[228:231]
    s_add_u32 s0, s0, s56
    s_lshl_b32 s0, s0, 3
    s_waitcnt lgkmcnt(4)
    v_mfma_f32_16x16x32_bf16 v[232:235], v[176:179], a[0:3], v[232:235]
    ds_read_b128 v[168:171], v249 offset:19456
    s_lshl_b32 s0, s0, 7
    v_mfma_f32_16x16x32_bf16 v[232:235], v[180:183], a[4:7], v[232:235]
    s_add_u32 s0, s0, 28377088
    s_cmp_eq_u32 s54, 0
    s_cselect_b32 s0, s0, 1073741824
    v_mfma_f32_16x16x32_bf16 v[236:239], v[180:183], a[12:15], v[236:239]
    ds_read_b128 v[172:175], v249 offset:28672
    v_bfe_u32 v1, v11, 4, 3
    v_mfma_f32_16x16x32_bf16 v[236:239], v[176:179], a[8:11], v[236:239]
    v_lshlrev_b32 v1, 7, v1
    buffer_load_dword v1, v1, s[16:19], s0 offen sc1
    s_waitcnt lgkmcnt(4)
    v_mfma_f32_16x16x32_bf16 v[240:243], v[184:187], a[0:3], v[240:243]
    ds_read_b128 v[176:179], v249 offset:20480
    s_add_u32 s25, s25, s24
    v_mfma_f32_16x16x32_bf16 v[240:243], v[188:191], a[4:7], v[240:243]
    buffer_load_dwordx4 v11, s[4:7], s25 offen offset:0 sc1 lds
    buffer_load_dwordx2 a[50:51], v2, s[16:19], s72 offen offset:2560 sc1
    v_mfma_f32_16x16x32_bf16 v[244:247], v[188:191], a[12:15], v[244:247]
    ds_read_b128 v[180:183], v249 offset:29696
    buffer_load_dwordx2 a[52:53], v2, s[16:19], s72 offen offset:3072 sc1
    v_mfma_f32_16x16x32_bf16 v[244:247], v[184:187], a[8:11], v[244:247]
    s_add_u32 s25, s25, s23
    s_waitcnt lgkmcnt(4)
    v_mfma_f32_16x16x32_bf16 v[16:19], v[192:195], a[16:19], v[16:19]
    ds_read_b128 v[184:187], v249 offset:21504
    v_mfma_f32_16x16x32_bf16 v[16:19], v[196:199], a[20:23], v[16:19]
    v_mfma_f32_16x16x32_bf16 v[20:23], v[196:199], a[28:31], v[20:23]
    ds_read_b128 v[188:191], v249 offset:30720
    buffer_load_dwordx4 v11, s[4:7], s25 offen offset:1024 sc1 lds
    v_mfma_f32_16x16x32_bf16 v[20:23], v[192:195], a[24:27], v[20:23]
    buffer_load_dwordx2 a[54:55], v2, s[16:19], s72 offen offset:3584 sc1
    s_waitcnt lgkmcnt(4)
    v_mfma_f32_16x16x32_bf16 v[24:27], v[168:171], a[16:19], v[24:27]
    ds_read_b128 v[192:195], v249 offset:22528
    v_mfma_f32_16x16x32_bf16 v[24:27], v[172:175], a[20:23], v[24:27]
    s_add_u32 s25, s25, s23
    v_mul_f32 v16, v16, v7
    v_mfma_f32_16x16x32_bf16 v[28:31], v[172:175], a[28:31], v[28:31]
    ds_read_b128 v[196:199], v249 offset:31744
    v_mul_f32 v17, v17, v7
    v_mfma_f32_16x16x32_bf16 v[28:31], v[168:171], a[24:27], v[28:31]
    buffer_load_dwordx2 a[56:57], v2, s[16:19], s73 offen offset:2048 sc1
    v_mul_f32 v18, v18, v7
    s_waitcnt lgkmcnt(4)
    v_mfma_f32_16x16x32_bf16 v[32:35], v[176:179], a[16:19], v[32:35]
    ds_read_b128 v[168:171], v249 offset:23552
    buffer_load_dwordx4 v11, s[4:7], s25 offen offset:2048 sc1 lds
    v_mul_f32 v19, v19, v7
    v_mfma_f32_16x16x32_bf16 v[32:35], v[180:183], a[20:23], v[32:35]
    v_mul_f32 v20, v20, v8
    v_mul_f32 v21, v21, v8
    v_mfma_f32_16x16x32_bf16 v[36:39], v[180:183], a[28:31], v[36:39]
    ds_read_b128 v[172:175], v249 offset:32768
    v_mul_f32 v22, v22, v8
    v_mfma_f32_16x16x32_bf16 v[36:39], v[176:179], a[24:27], v[36:39]
    s_add_u32 s25, s25, s23
    v_mul_f32 v23, v23, v8
    s_waitcnt lgkmcnt(4)
    v_mfma_f32_16x16x32_bf16 v[200:203], v[184:187], a[16:19], v[200:203]
    ds_read_b128 v[176:179], v249 offset:24576
    buffer_load_dwordx2 a[58:59], v2, s[16:19], s73 offen offset:2560 sc1
    v_mul_f32 v24, v24, v7
    v_mfma_f32_16x16x32_bf16 v[200:203], v[188:191], a[20:23], v[200:203]
    buffer_load_dwordx4 v11, s[4:7], s25 offen offset:3072 sc1 lds
    v_mul_f32 v25, v25, v7
    v_mul_f32 v26, v26, v7
    v_mfma_f32_16x16x32_bf16 v[204:207], v[188:191], a[28:31], v[204:207]
    ds_read_b128 v[180:183], v249 offset:33792
    v_mul_f32 v27, v27, v7
    v_mul_f32 v28, v28, v8
    v_mfma_f32_16x16x32_bf16 v[204:207], v[184:187], a[24:27], v[204:207]
    v_mul_f32 v29, v29, v8
    s_waitcnt lgkmcnt(4)
    v_mfma_f32_16x16x32_bf16 v[208:211], v[192:195], a[16:19], v[208:211]
    ds_read_b128 v[184:187], v249 offset:25600
    buffer_load_dwordx2 a[60:61], v2, s[16:19], s73 offen offset:3072 sc1
    v_mul_f32 v30, v30, v8
    v_mfma_f32_16x16x32_bf16 v[208:211], v[196:199], a[20:23], v[208:211]
    s_add_u32 m0, s26, 81920
    v_mul_f32 v31, v31, v8
    v_mul_f32 v32, v32, v7
    v_mfma_f32_16x16x32_bf16 v[212:215], v[196:199], a[28:31], v[212:215]
    ds_read_b128 v[188:191], v249 offset:34816
    v_mul_f32 v33, v33, v7
    v_mfma_f32_16x16x32_bf16 v[212:215], v[192:195], a[24:27], v[212:215]
    s_add_u32 s25, s25, s24
    v_mul_f32 v34, v34, v7
    s_waitcnt lgkmcnt(4)
    v_mfma_f32_16x16x32_bf16 v[216:219], v[168:171], a[16:19], v[216:219]
    ds_read_b128 v[192:195], v249 offset:26624
    v_mul_f32 v35, v35, v7
    v_mul_f32 v36, v36, v8
    v_mfma_f32_16x16x32_bf16 v[216:219], v[172:175], a[20:23], v[216:219]
    buffer_load_dwordx2 a[62:63], v2, s[16:19], s73 offen offset:3584 sc1
    v_mul_f32 v37, v37, v8
    v_mul_f32 v38, v38, v8
    v_mfma_f32_16x16x32_bf16 v[220:223], v[172:175], a[28:31], v[220:223]
    ds_read_b128 v[196:199], v249 offset:35840
    buffer_load_dwordx4 v11, s[4:7], s25 offen offset:0 sc1 lds
    v_mul_f32 v39, v39, v8
    v_mfma_f32_16x16x32_bf16 v[220:223], v[168:171], a[24:27], v[220:223]
    s_waitcnt vmcnt(26)
    s_barrier
    s_waitcnt lgkmcnt(4)
    v_mfma_f32_16x16x32_bf16 v[224:227], v[176:179], a[16:19], v[224:227]
    ds_read_b128 v[168:171], v248 offset:0
    v_mul_f32 v200, v200, v7
    v_mul_f32 v201, v201, v7
    v_mfma_f32_16x16x32_bf16 v[224:227], v[180:183], a[20:23], v[224:227]
    s_add_u32 s22, s22, 147456
    v_mul_f32 v202, v202, v7
    v_mul_f32 v203, v203, v7
    v_mfma_f32_16x16x32_bf16 v[228:231], v[180:183], a[28:31], v[228:231]
    ds_read_b128 v[172:175], v248 offset:9216
    v_mul_f32 v204, v204, v8
    v_mul_f32 v205, v205, v8
    v_mfma_f32_16x16x32_bf16 v[228:231], v[176:179], a[24:27], v[228:231]
    v_mul_f32 v206, v206, v8
    s_waitcnt lgkmcnt(4)
    v_mfma_f32_16x16x32_bf16 v[232:235], v[184:187], a[16:19], v[232:235]
    ds_read_b128 v[176:179], v248 offset:1024
    v_mul_f32 v207, v207, v8
    v_mfma_f32_16x16x32_bf16 v[232:235], v[188:191], a[20:23], v[232:235]
    v_mul_f32 v208, v208, v7
    v_mul_f32 v209, v209, v7
    v_mfma_f32_16x16x32_bf16 v[236:239], v[188:191], a[28:31], v[236:239]
    ds_read_b128 v[180:183], v248 offset:10240
    v_mul_f32 v210, v210, v7
    v_mfma_f32_16x16x32_bf16 v[236:239], v[184:187], a[24:27], v[236:239]
    v_mul_f32 v211, v211, v7
    s_waitcnt lgkmcnt(4)
    v_mfma_f32_16x16x32_bf16 v[240:243], v[192:195], a[16:19], v[240:243]
    ds_read_b128 v[184:187], v248 offset:2048
    v_mul_f32 v212, v212, v8
    v_mfma_f32_16x16x32_bf16 v[240:243], v[196:199], a[20:23], v[240:243]
    v_mul_f32 v213, v213, v8
    v_mul_f32 v214, v214, v8
    v_mfma_f32_16x16x32_bf16 v[244:247], v[196:199], a[28:31], v[244:247]
    ds_read_b128 v[188:191], v248 offset:11264
    v_mul_f32 v215, v215, v8
    v_mul_f32 v216, v216, v7
    v_mfma_f32_16x16x32_bf16 v[244:247], v[192:195], a[24:27], v[244:247]
    v_mul_f32 v217, v217, v7
    s_waitcnt lgkmcnt(4)
    s_waitcnt vmcnt(24)
    v_mfma_f32_16x16x32_bf16 v[16:19], v[168:171], a[32:35], v[16:19]
    ds_read_b128 v[192:195], v248 offset:3072
    s_add_u32 m0, s26, 110592
    s_waitcnt vmcnt(22)
    v_mfma_f32_16x16x32_bf16 v[16:19], v[172:175], a[36:39], v[16:19]
    v_mul_f32 v218, v218, v7
    v_mul_f32 v219, v219, v7
    v_mul_f32 v220, v220, v8
    s_waitcnt vmcnt(15)
    v_mfma_f32_16x16x32_bf16 v[20:23], v[172:175], a[44:47], v[20:23]
    ds_read_b128 v[196:199], v248 offset:12288
    s_waitcnt vmcnt(12)
    v_cmp_ne_u32 vcc, s1, v1
    v_mul_f32 v221, v221, v8
    v_mfma_f32_16x16x32_bf16 v[20:23], v[168:171], a[40:43], v[20:23]
    s_mov_b32 s25, s22
    v_mul_f32 v222, v222, v8
    s_waitcnt lgkmcnt(4)
    v_mfma_f32_16x16x32_bf16 v[24:27], v[176:179], a[32:35], v[24:27]
    ds_read_b128 v[168:171], v248 offset:4096
    s_mov_b32 s0, s0
    s_cbranch_vccnz L_slow_m2
L_ok_m2:
    v_mul_f32 v223, v223, v8
    v_mfma_f32_16x16x32_bf16 v[24:27], v[180:183], a[36:39], v[24:27]
    s_barrier
    v_mul_f32 v224, v224, v7
    v_mfma_f32_16x16x32_bf16 v[28:31], v[180:183], a[44:47], v[28:31]
    ds_read_b128 v[172:175], v248 offset:13312
    buffer_load_dwordx4 v11, s[4:7], s25 offen offset:0 sc1 lds
    v_mul_f32 v225, v225, v7
    v_mfma_f32_16x16x32_bf16 v[28:31], v[176:179], a[40:43], v[28:31]
    v_mul_f32 v226, v226, v7
    v_mul_f32 v227, v227, v7
    s_waitcnt lgkmcnt(4)
    v_mfma_f32_16x16x32_bf16 v[32:35], v[184:187], a[32:35], v[32:35]
    ds_read_b128 v[176:179], v248 offset:5120
    v_mul_f32 v228, v228, v8
    v_mul_f32 v229, v229, v8
    v_mfma_f32_16x16x32_bf16 v[32:35], v[188:191], a[36:39], v[32:35]
    s_add_u32 s25, s25, s23
    v_mul_f32 v230, v230, v8
    v_mfma_f32_16x16x32_bf16 v[36:39], v[188:191], a[44:47], v[36:39]
    ds_read_b128 v[180:183], v248 offset:14336
    buffer_load_dwordx4 a[64:67], v11, s[16:19], s20 offen offset:0 sc1
    v_mul_f32 v231, v231, v8
    v_mfma_f32_16x16x32_bf16 v[36:39], v[184:187], a[40:43], v[36:39]
    v_mul_f32 v232, v232, v7
    v_mul_f32 v233, v233, v7
    s_waitcnt lgkmcnt(4)
    v_mfma_f32_16x16x32_bf16 v[200:203], v[192:195], a[32:35], v[200:203]
    ds_read_b128 v[184:187], v248 offset:6144
    buffer_load_dwordx4 v11, s[4:7], s25 offen offset:1024 sc1 lds
    v_mul_f32 v234, v234, v7
    v_mfma_f32_16x16x32_bf16 v[200:203], v[196:199], a[36:39], v[200:203]
    buffer_load_dwordx4 a[68:71], v11, s[16:19], s20 offen offset:1024 sc1
    v_mul_f32 v235, v235, v7
    v_mul_f32 v236, v236, v8
    v_mfma_f32_16x16x32_bf16 v[204:207], v[196:199], a[44:47], v[204:207]
    ds_read_b128 v[188:191], v248 offset:15360
    v_mul_f32 v237, v237, v8
    v_mfma_f32_16x16x32_bf16 v[204:207], v[192:195], a[40:43], v[204:207]
    s_add_u32 s25, s25, s23
    v_mul_f32 v238, v238, v8
    s_waitcnt lgkmcnt(4)
    v_mfma_f32_16x16x32_bf16 v[208:211], v[168:171], a[32:35], v[208:211]
    ds_read_b128 v[192:195], v248 offset:7168
    buffer_load_dwordx4 a[72:75], v11, s[16:19], s21 offen offset:0 sc1
    v_mul_f32 v239, v239, v8
    v_mfma_f32_16x16x32_bf16 v[208:211], v[172:175], a[36:39], v[208:211]
    buffer_load_dwordx4 v11, s[4:7], s25 offen offset:2048 sc1 lds
    v_mul_f32 v240, v240, v7
    v_mul_f32 v241, v241, v7
    v_mfma_f32_16x16x32_bf16 v[212:215], v[172:175], a[44:47], v[212:215]
    ds_read_b128 v[196:199], v248 offset:16384
    buffer_load_dwordx4 a[76:79], v11, s[16:19], s21 offen offset:1024 sc1
    v_mul_f32 v242, v242, v7
    v_mfma_f32_16x16x32_bf16 v[212:215], v[168:171], a[40:43], v[212:215]
    v_mul_f32 v243, v243, v7
    v_mul_f32 v244, v244, v8
    s_waitcnt lgkmcnt(4)
    v_mfma_f32_16x16x32_bf16 v[216:219], v[176:179], a[32:35], v[216:219]
    ds_read_b128 v[168:171], v248 offset:8192
    s_add_u32 s20, s20, 2048
    v_mul_f32 v245, v245, v8
    v_mfma_f32_16x16x32_bf16 v[216:219], v[180:183], a[36:39], v[216:219]
    s_add_u32 s25, s25, s23
    v_mul_f32 v246, v246, v8
    v_mfma_f32_16x16x32_bf16 v[220:223], v[180:183], a[44:47], v[220:223]
    ds_read_b128 v[172:175], v248 offset:17408
    s_add_u32 s21, s21, 2048
    v_mul_f32 v247, v247, v8
    v_mfma_f32_16x16x32_bf16 v[220:223], v[176:179], a[40:43], v[220:223]
    buffer_load_dwordx4 v11, s[4:7], s25 offen offset:3072 sc1 lds
    s_waitcnt lgkmcnt(4)
    v_mfma_f32_16x16x32_bf16 v[224:227], v[184:187], a[32:35], v[224:227]
    ds_read_b128 v[176:179], v248 offset:18432
    v_mfma_f32_16x16x32_bf16 v[224:227], v[188:191], a[36:39], v[224:227]
    v_mfma_f32_16x16x32_bf16 v[228:231], v[188:191], a[44:47], v[228:231]
    ds_read_b128 v[180:183], v248 offset:27648
    s_add_u32 m0, s26, 114688
    v_mfma_f32_16x16x32_bf16 v[228:231], v[184:187], a[40:43], v[228:231]
    buffer_load_dwordx4 a[80:83], v11, s[16:19], s20 offen offset:0 sc1
    s_waitcnt lgkmcnt(4)
    v_mfma_f32_16x16x32_bf16 v[232:235], v[192:195], a[32:35], v[232:235]
    ds_read_b128 v[184:187], v248 offset:19456
    v_mfma_f32_16x16x32_bf16 v[232:235], v[196:199], a[36:39], v[232:235]
    s_add_u32 s25, s25, s24
    v_mfma_f32_16x16x32_bf16 v[236:239], v[196:199], a[44:47], v[236:239]
    ds_read_b128 v[188:191], v248 offset:28672
    buffer_load_dwordx4 a[84:87], v11, s[16:19], s20 offen offset:1024 sc1
    v_mfma_f32_16x16x32_bf16 v[236:239], v[192:195], a[40:43], v[236:239]
    s_waitcnt lgkmcnt(4)
    v_mfma_f32_16x16x32_bf16 v[240:243], v[168:171], a[32:35], v[240:243]
    ds_read_b128 v[192:195], v248 offset:20480
    buffer_load_dwordx4 v11, s[4:7], s25 offen offset:0 sc1 lds
    v_mfma_f32_16x16x32_bf16 v[240:243], v[172:175], a[36:39], v[240:243]
    buffer_load_dwordx4 a[88:91], v11, s[16:19], s21 offen offset:0 sc1
    v_mfma_f32_16x16x32_bf16 v[244:247], v[172:175], a[44:47], v[244:247]
    ds_read_b128 v[196:199], v248 offset:29696
    v_mfma_f32_16x16x32_bf16 v[244:247], v[168:171], a[40:43], v[244:247]
    s_add_u32 s25, s25, s23
    s_waitcnt lgkmcnt(4)
    s_waitcnt vmcnt(22)
    v_mfma_f32_16x16x32_bf16 v[16:19], v[176:179], a[48:51], v[16:19]
    ds_read_b128 v[168:171], v248 offset:21504
    buffer_load_dwordx4 a[92:95], v11, s[16:19], s21 offen offset:1024 sc1
    s_waitcnt vmcnt(20)
    v_mfma_f32_16x16x32_bf16 v[16:19], v[180:183], a[52:55], v[16:19]
    s_add_u32 s20, s20, 2048
    s_waitcnt vmcnt(14)
    v_mfma_f32_16x16x32_bf16 v[20:23], v[180:183], a[60:63], v[20:23]
    ds_read_b128 v[172:175], v248 offset:30720
    buffer_load_dwordx4 v11, s[4:7], s25 offen offset:1024 sc1 lds
L_wm9:
    s_cbranch_execz L_wm_done
    v_mfma_f32_16x16x32_bf16 v[20:23], v[176:179], a[56:59], v[20:23]
    s_waitcnt lgkmcnt(4)
    v_mfma_f32_16x16x32_bf16 v[24:27], v[184:187], a[48:51], v[24:27]
    ds_read_b128 v[176:179], v248 offset:22528
    s_add_u32 s21, s21, 2048
    v_mfma_f32_16x16x32_bf16 v[24:27], v[188:191], a[52:55], v[24:27]
    s_add_u32 s25, s25, s23
    v_mfma_f32_16x16x32_bf16 v[28:31], v[188:191], a[60:63], v[28:31]
    ds_read_b128 v[180:183], v248 offset:31744
    v_mfma_f32_16x16x32_bf16 v[28:31], v[184:187], a[56:59], v[28:31]
    s_waitcnt lgkmcnt(4)
    v_mfma_f32_16x16x32_bf16 v[32:35], v[192:195], a[48:51], v[32:35]
    ds_read_b128 v[184:187], v248 offset:23552
    buffer_load_dwordx4 v11, s[4:7], s25 offen offset:2048 sc1 lds
    v_mfma_f32_16x16x32_bf16 v[32:35], v[196:199], a[52:55], v[32:35]
    buffer_load_dwordx4 a[96:99], v11, s[16:19], s20 offen offset:0 sc1
    v_mfma_f32_16x16x32_bf16 v[36:39], v[196:199], a[60:63], v[36:39]
    ds_read_b128 v[188:191], v248 offset:32768
    v_mfma_f32_16x16x32_bf16 v[36:39], v[192:195], a[56:59], v[36:39]
    s_add_u32 s25, s25, s23
    s_waitcnt lgkmcnt(4)
    v_mfma_f32_16x16x32_bf16 v[200:203], v[168:171], a[48:51], v[200:203]
    ds_read_b128 v[192:195], v248 offset:24576
    buffer_load_dwordx4 a[100:103], v11, s[16:19], s20 offen offset:1024 sc1
    v_mfma_f32_16x16x32_bf16 v[200:203], v[172:175], a[52:55], v[200:203]
    buffer_load_dwordx4 v11, s[4:7], s25 offen offset:3072 sc1 lds
    v_mfma_f32_16x16x32_bf16 v[204:207], v[172:175], a[60:63], v[204:207]
    ds_read_b128 v[196:199], v248 offset:33792
    buffer_load_dwordx4 a[104:107], v11, s[16:19], s21 offen offset:0 sc1
    v_mfma_f32_16x16x32_bf16 v[204:207], v[168:171], a[56:59], v[204:207]
    s_waitcnt lgkmcnt(4)
    v_mfma_f32_16x16x32_bf16 v[208:211], v[176:179], a[48:51], v[208:211]
    ds_read_b128 v[168:171], v248 offset:25600
    v_mfma_f32_16x16x32_bf16 v[208:211], v[180:183], a[52:55], v[208:211]
    s_add_u32 m0, s26, 118784
    buffer_load_dwordx4 a[108:111], v11, s[16:19], s21 offen offset:1024 sc1
    v_mfma_f32_16x16x32_bf16 v[212:215], v[180:183], a[60:63], v[212:215]
    ds_read_b128 v[172:175], v248 offset:34816
    v_mfma_f32_16x16x32_bf16 v[212:215], v[176:179], a[56:59], v[212:215]
    s_add_u32 s25, s25, s24
    s_waitcnt lgkmcnt(4)
    v_mfma_f32_16x16x32_bf16 v[216:219], v[184:187], a[48:51], v[216:219]
    ds_read_b128 v[176:179], v248 offset:26624
    s_add_u32 s20, s20, 2048
    v_mfma_f32_16x16x32_bf16 v[216:219], v[188:191], a[52:55], v[216:219]
    s_add_u32 s21, s21, 2048
    v_mfma_f32_16x16x32_bf16 v[220:223], v[188:191], a[60:63], v[220:223]
    ds_read_b128 v[180:183], v248 offset:35840
    buffer_load_dwordx4 v11, s[4:7], s25 offen offset:0 sc1 lds
    v_mfma_f32_16x16x32_bf16 v[220:223], v[184:187], a[56:59], v[220:223]
    s_waitcnt vmcnt(21)
    s_barrier
    s_waitcnt lgkmcnt(4)
    v_mfma_f32_16x16x32_bf16 v[224:227], v[192:195], a[48:51], v[224:227]
    ds_read_b128 v[184:187], v250 offset:0
    v_mfma_f32_16x16x32_bf16 v[224:227], v[196:199], a[52:55], v[224:227]
    s_add_u32 s22, s22, 147456
    v_mfma_f32_16x16x32_bf16 v[228:231], v[196:199], a[60:63], v[228:231]
    ds_read_b128 v[188:191], v250 offset:9216
    v_mfma_f32_16x16x32_bf16 v[228:231], v[192:195], a[56:59], v[228:231]
    buffer_load_dwordx4 a[112:115], v11, s[16:19], s20 offen offset:0 sc1
    s_waitcnt lgkmcnt(4)
    v_mfma_f32_16x16x32_bf16 v[232:235], v[168:171], a[48:51], v[232:235]
    ds_read_b128 v[192:195], v250 offset:1024
    v_mfma_f32_16x16x32_bf16 v[232:235], v[172:175], a[52:55], v[232:235]
    buffer_load_dwordx4 a[116:119], v11, s[16:19], s20 offen offset:1024 sc1
    v_mfma_f32_16x16x32_bf16 v[236:239], v[172:175], a[60:63], v[236:239]
    ds_read_b128 v[196:199], v250 offset:10240
    v_mfma_f32_16x16x32_bf16 v[236:239], v[168:171], a[56:59], v[236:239]
    s_waitcnt lgkmcnt(4)
    v_mfma_f32_16x16x32_bf16 v[240:243], v[176:179], a[48:51], v[240:243]
    ds_read_b128 v[168:171], v250 offset:2048
    v_mfma_f32_16x16x32_bf16 v[240:243], v[180:183], a[52:55], v[240:243]
    buffer_load_dwordx4 a[120:123], v11, s[16:19], s21 offen offset:0 sc1
    v_mfma_f32_16x16x32_bf16 v[244:247], v[180:183], a[60:63], v[244:247]
    ds_read_b128 v[172:175], v250 offset:11264
    v_mfma_f32_16x16x32_bf16 v[244:247], v[176:179], a[56:59], v[244:247]
    buffer_load_dwordx4 a[124:127], v11, s[16:19], s21 offen offset:1024 sc1
    s_waitcnt lgkmcnt(4)
    s_waitcnt vmcnt(23)
    v_mfma_f32_16x16x32_bf16 v[16:19], v[184:187], a[64:67], v[16:19]
    ds_read_b128 v[176:179], v250 offset:3072
    s_add_u32 m0, s26, 36864
    s_waitcnt vmcnt(21)
    v_mfma_f32_16x16x32_bf16 v[16:19], v[188:191], a[68:71], v[16:19]
    s_add_u32 s20, s20, 2048
    s_waitcnt vmcnt(18)
    v_mfma_f32_16x16x32_bf16 v[20:23], v[188:191], a[76:79], v[20:23]
    ds_read_b128 v[180:183], v250 offset:12288
    v_mfma_f32_16x16x32_bf16 v[20:23], v[184:187], a[72:75], v[20:23]
    s_mov_b32 s25, s22
    s_waitcnt lgkmcnt(4)
    v_mfma_f32_16x16x32_bf16 v[24:27], v[192:195], a[64:67], v[24:27]
    ds_read_b128 v[184:187], v250 offset:4096
    v_mfma_f32_16x16x32_bf16 v[24:27], v[196:199], a[68:71], v[24:27]
    s_add_u32 s21, s21, 2048
    v_mfma_f32_16x16x32_bf16 v[28:31], v[196:199], a[76:79], v[28:31]
    ds_read_b128 v[188:191], v250 offset:13312
    buffer_load_dwordx4 v11, s[4:7], s25 offen offset:0 sc1 lds
    v_mfma_f32_16x16x32_bf16 v[28:31], v[192:195], a[72:75], v[28:31]
    s_waitcnt lgkmcnt(4)
    v_mfma_f32_16x16x32_bf16 v[32:35], v[168:171], a[64:67], v[32:35]
    ds_read_b128 v[192:195], v250 offset:5120
    v_mfma_f32_16x16x32_bf16 v[32:35], v[172:175], a[68:71], v[32:35]
    s_add_u32 s25, s25, s23
    buffer_load_dwordx4 a[0:3], v11, s[16:19], s20 offen offset:0 sc1
    v_mfma_f32_16x16x32_bf16 v[36:39], v[172:175], a[76:79], v[36:39]
    ds_read_b128 v[196:199], v250 offset:14336
    v_mfma_f32_16x16x32_bf16 v[36:39], v[168:171], a[72:75], v[36:39]
    s_waitcnt lgkmcnt(4)
    v_mfma_f32_16x16x32_bf16 v[200:203], v[176:179], a[64:67], v[200:203]
    ds_read_b128 v[168:171], v250 offset:6144
    buffer_load_dwordx4 v11, s[4:7], s25 offen offset:1024 sc1 lds
    v_mfma_f32_16x16x32_bf16 v[200:203], v[180:183], a[68:71], v[200:203]
    buffer_load_dwordx4 a[4:7], v11, s[16:19], s20 offen offset:1024 sc1
    v_mfma_f32_16x16x32_bf16 v[204:207], v[180:183], a[76:79], v[204:207]
    ds_read_b128 v[172:175], v250 offset:15360
    v_mfma_f32_16x16x32_bf16 v[204:207], v[176:179], a[72:75], v[204:207]
    s_add_u32 s25, s25, s23
    s_waitcnt lgkmcnt(4)
    v_mfma_f32_16x16x32_bf16 v[208:211], v[184:187], a[64:67], v[208:211]
    ds_read_b128 v[176:179], v250 offset:7168
    v_mfma_f32_16x16x32_bf16 v[208:211], v[188:191], a[68:71], v[208:211]
    buffer_load_dwordx4 v11, s[4:7], s25 offen offset:2048 sc1 lds
    buffer_load_dwordx4 a[8:11], v11, s[16:19], s21 offen offset:0 sc1
    v_mfma_f32_16x16x32_bf16 v[212:215], v[188:191], a[76:79], v[212:215]
    ds_read_b128 v[180:183], v250 offset:16384
    v_mfma_f32_16x16x32_bf16 v[212:215], v[184:187], a[72:75], v[212:215]
    s_waitcnt lgkmcnt(4)
    v_mfma_f32_16x16x32_bf16 v[216:219], v[192:195], a[64:67], v[216:219]
    ds_read_b128 v[184:187], v250 offset:8192
    v_mfma_f32_16x16x32_bf16 v[216:219], v[196:199], a[68:71], v[216:219]
    s_add_u32 s25, s25, s23
    buffer_load_dwordx4 a[12:15], v11, s[16:19], s21 offen offset:1024 sc1
    v_mfma_f32_16x16x32_bf16 v[220:223], v[196:199], a[76:79], v[220:223]
    ds_read_b128 v[188:191], v250 offset:17408
    v_mfma_f32_16x16x32_bf16 v[220:223], v[192:195], a[72:75], v[220:223]
    buffer_load_dwordx4 v11, s[4:7], s25 offen offset:3072 sc1 lds
    s_waitcnt lgkmcnt(4)
    v_mfma_f32_16x16x32_bf16 v[224:227], v[168:171], a[64:67], v[224:227]
    ds_read_b128 v[192:195], v250 offset:18432
    v_mfma_f32_16x16x32_bf16 v[224:227], v[172:175], a[68:71], v[224:227]
    s_add_u32 s20, s20, 2048
    v_mfma_f32_16x16x32_bf16 v[228:231], v[172:175], a[76:79], v[228:231]
    ds_read_b128 v[196:199], v250 offset:27648
    s_add_u32 m0, s26, 40960
    v_mfma_f32_16x16x32_bf16 v[228:231], v[168:171], a[72:75], v[228:231]
    s_waitcnt lgkmcnt(4)
    v_mfma_f32_16x16x32_bf16 v[232:235], v[176:179], a[64:67], v[232:235]
    ds_read_b128 v[168:171], v250 offset:19456
    s_add_u32 s21, s21, 2048
    v_mfma_f32_16x16x32_bf16 v[232:235], v[180:183], a[68:71], v[232:235]
    s_add_u32 s25, s25, s24
    v_mfma_f32_16x16x32_bf16 v[236:239], v[180:183], a[76:79], v[236:239]
    ds_read_b128 v[172:175], v250 offset:28672
    v_mfma_f32_16x16x32_bf16 v[236:239], v[176:179], a[72:75], v[236:239]
    s_waitcnt lgkmcnt(4)
    v_mfma_f32_16x16x32_bf16 v[240:243], v[184:187], a[64:67], v[240:243]
    ds_read_b128 v[176:179], v250 offset:20480
    buffer_load_dwordx4 v11, s[4:7], s25 offen offset:0 sc1 lds
    v_mfma_f32_16x16x32_bf16 v[240:243], v[188:191], a[68:71], v[240:243]
    v_mfma_f32_16x16x32_bf16 v[244:247], v[188:191], a[76:79], v[244:247]
    ds_read_b128 v[180:183], v250 offset:29696
    v_mfma_f32_16x16x32_bf16 v[244:247], v[184:187], a[72:75], v[244:247]
    s_add_u32 s25, s25, s23
    s_waitcnt lgkmcnt(4)
    s_waitcnt vmcnt(25)
    v_mfma_f32_16x16x32_bf16 v[16:19], v[192:195], a[80:83], v[16:19]
    ds_read_b128 v[184:187], v250 offset:21504
    buffer_load_dwordx4 a[16:19], v11, s[16:19], s20 offen offset:0 sc1
    s_waitcnt vmcnt(25)
    v_mfma_f32_16x16x32_bf16 v[16:19], v[196:199], a[84:87], v[16:19]
    s_waitcnt vmcnt(22)
    v_mfma_f32_16x16x32_bf16 v[20:23], v[196:199], a[92:95], v[20:23]
    ds_read_b128 v[188:191], v250 offset:30720
    buffer_load_dwordx4 v11, s[4:7], s25 offen offset:1024 sc1 lds
    v_mfma_f32_16x16x32_bf16 v[20:23], v[192:195], a[88:91], v[20:23]
    s_waitcnt lgkmcnt(4)
    v_mfma_f32_16x16x32_bf16 v[24:27], v[168:171], a[80:83], v[24:27]
    ds_read_b128 v[192:195], v250 offset:22528
    v_mfma_f32_16x16x32_bf16 v[24:27], v[172:175], a[84:87], v[24:27]
    s_add_u32 s25, s25, s23
    v_mfma_f32_16x16x32_bf16 v[28:31], v[172:175], a[92:95], v[28:31]
    ds_read_b128 v[196:199], v250 offset:31744
    buffer_load_dwordx4 a[20:23], v11, s[16:19], s20 offen offset:1024 sc1
    v_mfma_f32_16x16x32_bf16 v[28:31], v[168:171], a[88:91], v[28:31]
    s_waitcnt lgkmcnt(4)
    v_mfma_f32_16x16x32_bf16 v[32:35], v[176:179], a[80:83], v[32:35]
    ds_read_b128 v[168:171], v250 offset:23552
    buffer_load_dwordx4 v11, s[4:7], s25 offen offset:2048 sc1 lds
    v_mfma_f32_16x16x32_bf16 v[32:35], v[180:183], a[84:87], v[32:35]
    v_mfma_f32_16x16x32_bf16 v[36:39], v[180:183], a[92:95], v[36:39]
    ds_read_b128 v[172:175], v250 offset:32768
    buffer_load_dwordx4 a[24:27], v11, s[16:19], s21 offen offset:0 sc1
    v_mfma_f32_16x16x32_bf16 v[36:39], v[176:179], a[88:91], v[36:39]
    s_add_u32 s25, s25, s23
    s_waitcnt lgkmcnt(4)
    v_mfma_f32_16x16x32_bf16 v[200:203], v[184:187], a[80:83], v[200:203]
    ds_read_b128 v[176:179], v250 offset:24576
    s_lshl_b32 s0, s56, 5
    v_mfma_f32_16x16x32_bf16 v[200:203], v[188:191], a[84:87], v[200:203]
    s_lshl_b32 s0, s0, 7
    buffer_load_dwordx4 v11, s[4:7], s25 offen offset:3072 sc1 lds
    v_mfma_f32_16x16x32_bf16 v[204:207], v[188:191], a[92:95], v[204:207]
    ds_read_b128 v[180:183], v250 offset:33792
    s_add_u32 s0, s0, 28442624
    v_mfma_f32_16x16x32_bf16 v[204:207], v[184:187], a[88:91], v[204:207]
    s_cmp_eq_u32 s54, 0
    s_cselect_b32 s0, s0, 1073741824
    s_waitcnt lgkmcnt(4)
    v_mfma_f32_16x16x32_bf16 v[208:211], v[192:195], a[80:83], v[208:211]
    ds_read_b128 v[184:187], v250 offset:25600
    v_bfe_u32 v1, v11, 4, 5
    v_mfma_f32_16x16x32_bf16 v[208:211], v[196:199], a[84:87], v[208:211]
    v_lshlrev_b32 v1, 7, v1
    buffer_load_dword v1, v1, s[16:19], s0 offen sc1
    v_mfma_f32_16x16x32_bf16 v[212:215], v[196:199], a[92:95], v[212:215]
    ds_read_b128 v[188:191], v250 offset:34816
    s_add_u32 m0, s26, 45056
    v_mfma_f32_16x16x32_bf16 v[212:215], v[192:195], a[88:91], v[212:215]
    s_add_u32 s25, s25, s24
    s_waitcnt lgkmcnt(4)
    v_mfma_f32_16x16x32_bf16 v[216:219], v[168:171], a[80:83], v[216:219]
    ds_read_b128 v[192:195], v250 offset:26624
    buffer_load_dwordx4 a[28:31], v11, s[16:19], s21 offen offset:1024 sc1
    v_mfma_f32_16x16x32_bf16 v[216:219], v[172:175], a[84:87], v[216:219]
    s_add_u32 s20, s20, 2048
    v_mfma_f32_16x16x32_bf16 v[220:223], v[172:175], a[92:95], v[220:223]
    ds_read_b128 v[196:199], v250 offset:35840
    buffer_load_dwordx4 v11, s[4:7], s25 offen offset:0 sc1 lds
    v_mfma_f32_16x16x32_bf16 v[220:223], v[168:171], a[88:91], v[220:223]
    s_waitcnt vmcnt(22)
    s_barrier
    s_waitcnt lgkmcnt(4)
    v_mfma_f32_16x16x32_bf16 v[224:227], v[176:179], a[80:83], v[224:227]
    ds_read_b128 v[168:171], v251 offset:0
    v_mfma_f32_16x16x32_bf16 v[224:227], v[180:183], a[84:87], v[224:227]
    s_add_u32 s22, s22, 147456
    v_mfma_f32_16x16x32_bf16 v[228:231], v[180:183], a[92:95], v[228:231]
    ds_read_b128 v[172:175], v251 offset:9216
    v_mfma_f32_16x16x32_bf16 v[228:231], v[176:179], a[88:91], v[228:231]
    s_waitcnt lgkmcnt(4)
    v_mfma_f32_16x16x32_bf16 v[232:235], v[184:187], a[80:83], v[232:235]
    ds_read_b128 v[176:179], v251 offset:1024
    v_mfma_f32_16x16x32_bf16 v[232:235], v[188:191], a[84:87], v[232:235]
    s_add_u32 s21, s21, 2048
    v_mfma_f32_16x16x32_bf16 v[236:239], v[188:191], a[92:95], v[236:239]
    ds_read_b128 v[180:183], v251 offset:10240
    v_mfma_f32_16x16x32_bf16 v[236:239], v[184:187], a[88:91], v[236:239]
    s_waitcnt lgkmcnt(4)
    v_mfma_f32_16x16x32_bf16 v[240:243], v[192:195], a[80:83], v[240:243]
    ds_read_b128 v[184:187], v251 offset:2048
    v_mfma_f32_16x16x32_bf16 v[240:243], v[196:199], a[84:87], v[240:243]
    v_mfma_f32_16x16x32_bf16 v[244:247], v[196:199], a[92:95], v[244:247]
    ds_read_b128 v[188:191], v251 offset:11264
    v_mfma_f32_16x16x32_bf16 v[244:247], v[192:195], a[88:91], v[244:247]
    s_mov_b32 s8, s48
    s_waitcnt lgkmcnt(4)
    v_mfma_f32_16x16x32_bf16 v[16:19], v[168:171], a[96:99], v[16:19]
    ds_read_b128 v[192:195], v251 offset:3072
    s_add_u32 m0, s26, 0
    v_mfma_f32_16x16x32_bf16 v[16:19], v[172:175], a[100:103], v[16:19]
    buffer_load_dwordx4 a[32:35], v11, s[16:19], s20 offen offset:0 sc1
    v_mfma_f32_16x16x32_bf16 v[20:23], v[172:175], a[108:111], v[20:23]
    ds_read_b128 v[196:199], v251 offset:12288
    s_mov_b32 s9, s49
    v_mfma_f32_16x16x32_bf16 v[20:23], v[168:171], a[104:107], v[20:23]
    s_mov_b32 s25, s22
    s_waitcnt lgkmcnt(4)
    v_mfma_f32_16x16x32_bf16 v[24:27], v[176:179], a[96:99], v[24:27]
    ds_read_b128 v[168:171], v251 offset:4096
    s_mov_b32 s10, 2359296
    v_mfma_f32_16x16x32_bf16 v[24:27], v[180:183], a[100:103], v[24:27]
    buffer_load_dwordx4 a[36:39], v11, s[16:19], s20 offen offset:1024 sc1
    v_mfma_f32_16x16x32_bf16 v[28:31], v[180:183], a[108:111], v[28:31]
    ds_read_b128 v[172:175], v251 offset:13312
    buffer_load_dwordx4 v11, s[4:7], s25 offen offset:0 sc1 lds
    v_mfma_f32_16x16x32_bf16 v[28:31], v[176:179], a[104:107], v[28:31]
    s_mov_b32 s11, 0x00020000
    s_waitcnt lgkmcnt(4)
    v_mfma_f32_16x16x32_bf16 v[32:35], v[184:187], a[96:99], v[32:35]
    ds_read_b128 v[176:179], v251 offset:5120
    v_mfma_f32_16x16x32_bf16 v[32:35], v[188:191], a[100:103], v[32:35]
    s_add_u32 s25, s25, s23
    v_mfma_f32_16x16x32_bf16 v[36:39], v[188:191], a[108:111], v[36:39]
    ds_read_b128 v[180:183], v251 offset:14336
    v_bfe_u32 v9, v11, 4, 4
    v_mfma_f32_16x16x32_bf16 v[36:39], v[184:187], a[104:107], v[36:39]
    buffer_load_dwordx4 a[40:43], v11, s[16:19], s21 offen offset:0 sc1
    s_waitcnt lgkmcnt(4)
    v_mfma_f32_16x16x32_bf16 v[200:203], v[192:195], a[96:99], v[200:203]
    ds_read_b128 v[184:187], v251 offset:6144
    buffer_load_dwordx4 v11, s[4:7], s25 offen offset:1024 sc1 lds
    v_mfma_f32_16x16x32_bf16 v[200:203], v[196:199], a[100:103], v[200:203]
    v_mul_u32_u24 v10, 1152, v9
    v_mfma_f32_16x16x32_bf16 v[204:207], v[196:199], a[108:111], v[204:207]
    ds_read_b128 v[188:191], v251 offset:15360
    v_mfma_f32_16x16x32_bf16 v[204:207], v[192:195], a[104:107], v[204:207]
    s_add_u32 s25, s25, s23
    s_waitcnt lgkmcnt(4)
    v_mfma_f32_16x16x32_bf16 v[208:211], v[168:171], a[96:99], v[208:211]
    ds_read_b128 v[192:195], v251 offset:7168
    v_lshrrev_b32 v9, 8, v11
    v_mfma_f32_16x16x32_bf16 v[208:211], v[172:175], a[100:103], v[208:211]
    buffer_load_dwordx4 a[44:47], v11, s[16:19], s21 offen offset:1024 sc1
    v_lshl_add_u32 v10, v9, 3, v10
    v_mfma_f32_16x16x32_bf16 v[212:215], v[172:175], a[108:111], v[212:215]
    ds_read_b128 v[196:199], v251 offset:16384
    buffer_load_dwordx4 v11, s[4:7], s25 offen offset:2048 sc1 lds
    v_mfma_f32_16x16x32_bf16 v[212:215], v[168:171], a[104:107], v[212:215]
    s_waitcnt lgkmcnt(4)
    v_mfma_f32_16x16x32_bf16 v[216:219], v[176:179], a[96:99], v[216:219]
    ds_read_b128 v[168:171], v251 offset:8192
    v_mfma_f32_16x16x32_bf16 v[216:219], v[180:183], a[100:103], v[216:219]
    s_add_u32 s25, s25, s23
    v_lshrrev_b32 v9, 2, v11
    v_mfma_f32_16x16x32_bf16 v[220:223], v[180:183], a[108:111], v[220:223]
    ds_read_b128 v[172:175], v251 offset:17408
    v_mfma_f32_16x16x32_bf16 v[220:223], v[176:179], a[104:107], v[220:223]
    s_add_u32 s20, s20, 2048
    s_waitcnt lgkmcnt(4)
    v_mfma_f32_16x16x32_bf16 v[224:227], v[184:187], a[96:99], v[224:227]
    ds_read_b128 v[176:179], v251 offset:18432
    s_xor_b32 s31, s58, 1
    v_mfma_f32_16x16x32_bf16 v[224:227], v[188:191], a[100:103], v[224:227]
    buffer_load_dwordx4 v11, s[4:7], s25 offen offset:3072 sc1 lds
    v_mfma_f32_16x16x32_bf16 v[228:231], v[188:191], a[108:111], v[228:231]
    ds_read_b128 v[180:183], v251 offset:27648
    s_sub_u32 s31, s31, s58
    v_mfma_f32_16x16x32_bf16 v[228:231], v[184:187], a[104:107], v[228:231]
    s_add_u32 m0, s26, 4096
    s_waitcnt lgkmcnt(4)
    v_mfma_f32_16x16x32_bf16 v[232:235], v[192:195], a[96:99], v[232:235]
    ds_read_b128 v[184:187], v251 offset:19456
    v_mfma_f32_16x16x32_bf16 v[232:235], v[196:199], a[100:103], v[232:235]
    s_add_u32 s21, s21, 2048
    s_mul_i32 s31, s31, 36864
    v_mfma_f32_16x16x32_bf16 v[236:239], v[196:199], a[108:111], v[236:239]
    ds_read_b128 v[188:191], v251 offset:28672
    s_add_u32 s25, s25, s24
    v_mfma_f32_16x16x32_bf16 v[236:239], v[192:195], a[104:107], v[236:239]
    s_add_u32 s86, s79, s31
    s_waitcnt lgkmcnt(4)
    v_mfma_f32_16x16x32_bf16 v[240:243], v[168:171], a[96:99], v[240:243]
    ds_read_b128 v[192:195], v251 offset:20480
    v_mfma_f32_16x16x32_bf16 v[240:243], v[172:175], a[100:103], v[240:243]
    buffer_load_dwordx4 v11, s[4:7], s25 offen offset:0 sc1 lds
    v_mfma_f32_16x16x32_bf16 v[244:247], v[172:175], a[108:111], v[244:247]
    ds_read_b128 v[196:199], v251 offset:29696
    s_add_u32 s86, s86, 0
    v_mfma_f32_16x16x32_bf16 v[244:247], v[168:171], a[104:107], v[244:247]
    s_waitcnt vmcnt(11)
    v_cmp_ne_u32 vcc, s1, v1
    s_waitcnt lgkmcnt(4)
    v_mfma_f32_16x16x32_bf16 v[16:19], v[176:179], a[112:115], v[16:19]
    ds_read_b128 v[168:171], v251 offset:21504
    s_add_u32 s25, s25, s23
    v_mfma_f32_16x16x32_bf16 v[16:19], v[180:183], a[116:119], v[16:19]
    s_mov_b32 s0, s0
    s_cbranch_vccnz L_slow_m3w
L_ok_m3w:
    v_mfma_f32_16x16x32_bf16 v[20:23], v[180:183], a[124:127], v[20:23]
    ds_read_b128 v[172:175], v251 offset:30720
    buffer_load_dwordx4 a[48:51], v11, s[16:19], s20 offen offset:0 sc1
    v_mfma_f32_16x16x32_bf16 v[20:23], v[176:179], a[120:123], v[20:23]
    s_xor_b32 s31, s58, 2
    s_waitcnt lgkmcnt(4)
    v_mfma_f32_16x16x32_bf16 v[24:27], v[184:187], a[112:115], v[24:27]
    ds_read_b128 v[176:179], v251 offset:22528
    buffer_load_dwordx4 v11, s[4:7], s25 offen offset:1024 sc1 lds
    v_mfma_f32_16x16x32_bf16 v[24:27], v[188:191], a[116:119], v[24:27]
    s_sub_u32 s31, s31, s58
    v_mfma_f32_16x16x32_bf16 v[28:31], v[188:191], a[124:127], v[28:31]
    ds_read_b128 v[180:183], v251 offset:31744
    s_mul_i32 s31, s31, 36864
    v_mfma_f32_16x16x32_bf16 v[28:31], v[184:187], a[120:123], v[28:31]
    s_add_u32 s25, s25, s23
    s_waitcnt lgkmcnt(4)
    v_mfma_f32_16x16x32_bf16 v[32:35], v[192:195], a[112:115], v[32:35]
    ds_read_b128 v[184:187], v251 offset:23552
    s_add_u32 s87, s79, s31
    v_mfma_f32_16x16x32_bf16 v[32:35], v[196:199], a[116:119], v[32:35]
    buffer_load_dwordx4 v11, s[4:7], s25 offen offset:2048 sc1 lds
    buffer_load_dwordx4 a[52:55], v11, s[16:19], s20 offen offset:1024 sc1
    v_mfma_f32_16x16x32_bf16 v[36:39], v[196:199], a[124:127], v[36:39]
    ds_read_b128 v[188:191], v251 offset:32768
    v_mfma_f32_16x16x32_bf16 v[36:39], v[192:195], a[120:123], v[36:39]
    s_add_u32 s87, s87, 3072
    s_waitcnt lgkmcnt(4)
    v_mfma_f32_16x16x32_bf16 v[200:203], v[168:171], a[112:115], v[200:203]
    ds_read_b128 v[192:195], v251 offset:24576
    v_mfma_f32_16x16x32_bf16 v[200:203], v[172:175], a[116:119], v[200:203]
    s_add_u32 s25, s25, s23
    v_mfma_f32_16x16x32_bf16 v[204:207], v[172:175], a[124:127], v[204:207]
    ds_read_b128 v[196:199], v251 offset:33792
    s_xor_b32 s31, s58, 3
    v_mfma_f32_16x16x32_bf16 v[204:207], v[168:171], a[120:123], v[204:207]
    s_waitcnt lgkmcnt(4)
    v_mfma_f32_16x16x32_bf16 v[208:211], v[176:179], a[112:115], v[208:211]
    ds_read_b128 v[168:171], v251 offset:25600
    buffer_load_dwordx4 v11, s[4:7], s25 offen offset:3072 sc1 lds
    v_mfma_f32_16x16x32_bf16 v[208:211], v[180:183], a[116:119], v[208:211]
    buffer_load_dwordx4 a[56:59], v11, s[16:19], s21 offen offset:0 sc1
    s_sub_u32 s31, s31, s58
    v_mfma_f32_16x16x32_bf16 v[212:215], v[180:183], a[124:127], v[212:215]
    ds_read_b128 v[172:175], v251 offset:34816
    v_mfma_f32_16x16x32_bf16 v[212:215], v[176:179], a[120:123], v[212:215]
    s_add_u32 m0, s26, 8192
    s_waitcnt lgkmcnt(4)
    v_mfma_f32_16x16x32_bf16 v[216:219], v[184:187], a[112:115], v[216:219]
    ds_read_b128 v[176:179], v251 offset:26624
    s_mul_i32 s31, s31, 36864
    v_mfma_f32_16x16x32_bf16 v[216:219], v[188:191], a[116:119], v[216:219]
    s_add_u32 s88, s79, s31
    v_mfma_f32_16x16x32_bf16 v[220:223], v[188:191], a[124:127], v[220:223]
    ds_read_b128 v[180:183], v251 offset:35840
    s_add_u32 s25, s25, s24
    v_mfma_f32_16x16x32_bf16 v[220:223], v[184:187], a[120:123], v[220:223]
    s_waitcnt vmcnt(15)
    s_barrier
    s_waitcnt lgkmcnt(4)
    v_mfma_f32_16x16x32_bf16 v[224:227], v[192:195], a[112:115], v[224:227]
    ds_read_b128 v[184:187], v249 offset:0
    v_mfma_f32_16x16x32_bf16 v[224:227], v[196:199], a[116:119], v[224:227]
    buffer_load_dwordx4 v11, s[4:7], s25 offen offset:0 sc1 lds
    s_add_u32 s88, s88, 6144
    v_mfma_f32_16x16x32_bf16 v[228:231], v[196:199], a[124:127], v[228:231]
    ds_read_b128 v[188:191], v249 offset:9216
    buffer_load_dwordx4 a[60:63], v11, s[16:19], s21 offen offset:1024 sc1
    v_mfma_f32_16x16x32_bf16 v[228:231], v[192:195], a[120:123], v[228:231]
    s_waitcnt lgkmcnt(4)
    v_mfma_f32_16x16x32_bf16 v[232:235], v[168:171], a[112:115], v[232:235]
    ds_read_b128 v[192:195], v249 offset:1024
    s_mul_i32 s89, s82, 18432
    v_mfma_f32_16x16x32_bf16 v[232:235], v[172:175], a[116:119], v[232:235]
    v_mfma_f32_16x16x32_bf16 v[236:239], v[172:175], a[124:127], v[236:239]
    ds_read_b128 v[196:199], v249 offset:10240
    s_mul_i32 s31, s84, 288
    v_mfma_f32_16x16x32_bf16 v[236:239], v[168:171], a[120:123], v[236:239]
    s_waitcnt lgkmcnt(4)
    v_mfma_f32_16x16x32_bf16 v[240:243], v[176:179], a[112:115], v[240:243]
    ds_read_b128 v[168:171], v249 offset:2048
    v_mfma_f32_16x16x32_bf16 v[240:243], v[180:183], a[116:119], v[240:243]
    s_add_u32 s89, s89, s31
    v_mfma_f32_16x16x32_bf16 v[244:247], v[180:183], a[124:127], v[244:247]
    ds_read_b128 v[172:175], v249 offset:11264
    v_mfma_f32_16x16x32_bf16 v[244:247], v[176:179], a[120:123], v[244:247]
    s_lshl_b32 s31, s85, 2
    s_waitcnt lgkmcnt(4)
    v_mfma_f32_16x16x32_bf16 v[16:19], v[184:187], a[0:3], v[16:19]
    ds_read_b128 v[176:179], v249 offset:3072
    s_mul_i32 s25, s54, 3072
    v_mfma_f32_16x16x32_bf16 v[16:19], v[188:191], a[4:7], v[16:19]
    buffer_load_dword a64, v3, s[16:19], s74 offen offset:0 sc1
    v_mov_b32 v43, s80
    v_mfma_f32_16x16x32_bf16 v[20:23], v[188:191], a[12:15], v[20:23]
    ds_read_b128 v[180:183], v249 offset:12288
    s_add_u32 s93, s89, s31
    v_mfma_f32_16x16x32_bf16 v[20:23], v[184:187], a[8:11], v[20:23]
    s_waitcnt lgkmcnt(4)
    v_mfma_f32_16x16x32_bf16 v[24:27], v[192:195], a[0:3], v[24:27]
    ds_read_b128 v[184:187], v249 offset:4096
    v_mfma_f32_16x16x32_bf16 v[24:27], v[196:199], a[4:7], v[24:27]
    buffer_load_dword a65, v3, s[16:19], s74 offen offset:256 sc1
    s_add_u32 s93, s93, 128
    v_mfma_f32_16x16x32_bf16 v[28:31], v[196:199], a[12:15], v[28:31]
    ds_read_b128 v[188:191], v249 offset:13312
    v_mov_b32 v47, s80
    v_mfma_f32_16x16x32_bf16 v[28:31], v[192:195], a[8:11], v[28:31]
    s_lshl_b32 s31, s85, 8
    s_waitcnt lgkmcnt(4)
    v_mfma_f32_16x16x32_bf16 v[32:35], v[168:171], a[0:3], v[32:35]
    ds_read_b128 v[192:195], v249 offset:5120
    s_add_u32 m0, s25, 73728
    v_mfma_f32_16x16x32_bf16 v[32:35], v[172:175], a[4:7], v[32:35]
    buffer_load_dword a66, v3, s[16:19], s74 offen offset:512 sc1
    v_mfma_f32_16x16x32_bf16 v[36:39], v[172:175], a[12:15], v[36:39]
    ds_read_b128 v[196:199], v249 offset:14336
    s_add_u32 s89, s89, s31
    v_mfma_f32_16x16x32_bf16 v[36:39], v[168:171], a[8:11], v[36:39]
    v_mov_b32 v51, s80
    s_waitcnt lgkmcnt(4)
    v_mfma_f32_16x16x32_bf16 v[200:203], v[176:179], a[0:3], v[200:203]
    ds_read_b128 v[168:171], v249 offset:6144
    v_mfma_f32_16x16x32_bf16 v[200:203], v[180:183], a[4:7], v[200:203]
    buffer_load_dword a67, v3, s[16:19], s74 offen offset:768 sc1
    s_mul_i32 s31, s85, 4294967232
    v_mfma_f32_16x16x32_bf16 v[204:207], v[180:183], a[12:15], v[204:207]
    ds_read_b128 v[172:175], v249 offset:15360
    v_mfma_f32_16x16x32_bf16 v[204:207], v[176:179], a[8:11], v[204:207]
    s_add_u32 s31, s31, 32
    s_waitcnt lgkmcnt(4)
    v_mfma_f32_16x16x32_bf16 v[208:211], v[184:187], a[0:3], v[208:211]
    ds_read_b128 v[176:179], v249 offset:7168
    s_mov_b32 s25, s30
    v_mfma_f32_16x16x32_bf16 v[208:211], v[188:191], a[4:7], v[208:211]
    buffer_load_dword a72, v3, s[16:19], s75 offen offset:0 sc1
    v_mov_b32 v55, s80
    v_mfma_f32_16x16x32_bf16 v[212:215], v[188:191], a[12:15], v[212:215]
    ds_read_b128 v[180:183], v249 offset:16384
    v_mfma_f32_16x16x32_bf16 v[212:215], v[184:187], a[8:11], v[212:215]
    s_add_u32 s90, s89, s31
    s_waitcnt lgkmcnt(4)
    v_mfma_f32_16x16x32_bf16 v[216:219], v[192:195], a[0:3], v[216:219]
    ds_read_b128 v[184:187], v249 offset:8192
    v_mfma_f32_16x16x32_bf16 v[216:219], v[196:199], a[4:7], v[216:219]
    buffer_load_dword a73, v3, s[16:19], s75 offen offset:256 sc1
    s_add_u32 s91, s90, s31
    v_mfma_f32_16x16x32_bf16 v[220:223], v[196:199], a[12:15], v[220:223]
    ds_read_b128 v[188:191], v249 offset:17408
    v_mov_b32 v59, s80
    v_mfma_f32_16x16x32_bf16 v[220:223], v[192:195], a[8:11], v[220:223]
    s_add_u32 s92, s91, s31
    s_waitcnt lgkmcnt(4)
    v_mfma_f32_16x16x32_bf16 v[224:227], v[168:171], a[0:3], v[224:227]
    ds_read_b128 v[192:195], v249 offset:18432
    buffer_load_dwordx4 v11, s[4:7], s25 offen offset:0 sc1 lds
    v_mfma_f32_16x16x32_bf16 v[224:227], v[172:175], a[4:7], v[224:227]
    buffer_load_dword a74, v3, s[16:19], s75 offen offset:512 sc1
    v_mfma_f32_16x16x32_bf16 v[228:231], v[172:175], a[12:15], v[228:231]
    ds_read_b128 v[196:199], v249 offset:27648
    v_mfma_f32_16x16x32_bf16 v[228:231], v[168:171], a[8:11], v[228:231]
    s_sub_u32 s94, 0, s85
    s_waitcnt lgkmcnt(4)
    v_mfma_f32_16x16x32_bf16 v[232:235], v[176:179], a[0:3], v[232:235]
    ds_read_b128 v[168:171], v249 offset:19456
    v_mfma_f32_16x16x32_bf16 v[232:235], v[180:183], a[4:7], v[232:235]
    s_sub_u32 s95, 0, s85
    v_mov_b32 v63, s80
    v_mfma_f32_16x16x32_bf16 v[236:239], v[180:183], a[12:15], v[236:239]
    ds_read_b128 v[172:175], v249 offset:28672
    buffer_load_dword a75, v3, s[16:19], s75 offen offset:768 sc1
    v_mfma_f32_16x16x32_bf16 v[236:239], v[176:179], a[8:11], v[236:239]
    s_waitcnt lgkmcnt(4)
    v_mfma_f32_16x16x32_bf16 v[240:243], v[184:187], a[0:3], v[240:243]
    ds_read_b128 v[176:179], v249 offset:20480
    s_add_u32 s25, s25, s23
    v_mfma_f32_16x16x32_bf16 v[240:243], v[188:191], a[4:7], v[240:243]
    v_mfma_f32_16x16x32_bf16 v[244:247], v[188:191], a[12:15], v[244:247]
    ds_read_b128 v[180:183], v249 offset:29696
    v_mfma_f32_16x16x32_bf16 v[244:247], v[184:187], a[8:11], v[244:247]
    s_waitcnt lgkmcnt(4)
    v_mfma_f32_16x16x32_bf16 v[16:19], v[192:195], a[16:19], v[16:19]
    ds_read_b128 v[184:187], v249 offset:21504
    v_mov_b32 v67, s80
    v_mfma_f32_16x16x32_bf16 v[16:19], v[196:199], a[20:23], v[16:19]
    v_mfma_f32_16x16x32_bf16 v[20:23], v[196:199], a[28:31], v[20:23]
    ds_read_b128 v[188:191], v249 offset:30720
    v_mfma_f32_16x16x32_bf16 v[20:23], v[192:195], a[24:27], v[20:23]
    s_waitcnt lgkmcnt(4)
    v_mfma_f32_16x16x32_bf16 v[24:27], v[168:171], a[16:19], v[24:27]
    ds_read_b128 v[192:195], v249 offset:22528
    buffer_load_dwordx4 v11, s[4:7], s25 offen offset:1024 sc1 lds
    v_mfma_f32_16x16x32_bf16 v[24:27], v[172:175], a[20:23], v[24:27]
    v_mfma_f32_16x16x32_bf16 v[28:31], v[172:175], a[28:31], v[28:31]
    ds_read_b128 v[196:199], v249 offset:31744
    v_mov_b32 v71, s80
    v_mfma_f32_16x16x32_bf16 v[28:31], v[168:171], a[24:27], v[28:31]
    s_waitcnt lgkmcnt(4)
    v_mfma_f32_16x16x32_bf16 v[32:35], v[176:179], a[16:19], v[32:35]
    ds_read_b128 v[168:171], v249 offset:23552
    v_mfma_f32_16x16x32_bf16 v[32:35], v[180:183], a[20:23], v[32:35]
    v_mfma_f32_16x16x32_bf16 v[36:39], v[180:183], a[28:31], v[36:39]
    ds_read_b128 v[172:175], v249 offset:32768
    v_mfma_f32_16x16x32_bf16 v[36:39], v[176:179], a[24:27], v[36:39]
    s_waitcnt lgkmcnt(4)
    v_mfma_f32_16x16x32_bf16 v[200:203], v[184:187], a[16:19], v[200:203]
    ds_read_b128 v[176:179], v249 offset:24576
    s_add_u32 s25, s25, s23
    v_mfma_f32_16x16x32_bf16 v[200:203], v[188:191], a[20:23], v[200:203]
    v_mov_b32 v75, s80
    v_mfma_f32_16x16x32_bf16 v[204:207], v[188:191], a[28:31], v[204:207]
    ds_read_b128 v[180:183], v249 offset:33792
    v_mfma_f32_16x16x32_bf16 v[204:207], v[184:187], a[24:27], v[204:207]
    s_waitcnt lgkmcnt(4)
    v_mfma_f32_16x16x32_bf16 v[208:211], v[192:195], a[16:19], v[208:211]
    ds_read_b128 v[184:187], v249 offset:25600
    v_mfma_f32_16x16x32_bf16 v[208:211], v[196:199], a[20:23], v[208:211]
    v_mfma_f32_16x16x32_bf16 v[212:215], v[196:199], a[28:31], v[212:215]
    ds_read_b128 v[188:191], v249 offset:34816
L_wm10:
    s_cbranch_execz L_wm_done
    v_mfma_f32_16x16x32_bf16 v[212:215], v[192:195], a[24:27], v[212:215]
    s_waitcnt lgkmcnt(4)
    v_mfma_f32_16x16x32_bf16 v[216:219], v[168:171], a[16:19], v[216:219]
    ds_read_b128 v[192:195], v249 offset:26624
    buffer_load_dwordx4 v11, s[4:7], s25 offen offset:2048 sc1 lds
    v_mfma_f32_16x16x32_bf16 v[216:219], v[172:175], a[20:23], v[216:219]
    v_mfma_f32_16x16x32_bf16 v[220:223], v[172:175], a[28:31], v[220:223]
    ds_read_b128 v[196:199], v249 offset:35840
    v_mfma_f32_16x16x32_bf16 v[220:223], v[168:171], a[24:27], v[220:223]
    s_waitcnt vmcnt(12)
    s_barrier
    s_waitcnt lgkmcnt(4)
    v_mfma_f32_16x16x32_bf16 v[224:227], v[176:179], a[16:19], v[224:227]
    ds_read_b128 v[168:171], v248 offset:0
    v_mfma_f32_16x16x32_bf16 v[224:227], v[180:183], a[20:23], v[224:227]
    v_mfma_f32_16x16x32_bf16 v[228:231], v[180:183], a[28:31], v[228:231]
    ds_read_b128 v[172:175], v248 offset:9216
    v_mfma_f32_16x16x32_bf16 v[228:231], v[176:179], a[24:27], v[228:231]
    s_waitcnt lgkmcnt(4)
    v_mfma_f32_16x16x32_bf16 v[232:235], v[184:187], a[16:19], v[232:235]
    ds_read_b128 v[176:179], v248 offset:1024
    v_mfma_f32_16x16x32_bf16 v[232:235], v[188:191], a[20:23], v[232:235]
    v_mfma_f32_16x16x32_bf16 v[236:239], v[188:191], a[28:31], v[236:239]
    ds_read_b128 v[180:183], v248 offset:10240
    v_mfma_f32_16x16x32_bf16 v[236:239], v[184:187], a[24:27], v[236:239]
    s_waitcnt lgkmcnt(4)
    v_mfma_f32_16x16x32_bf16 v[240:243], v[192:195], a[16:19], v[240:243]
    ds_read_b128 v[184:187], v248 offset:2048
    v_mfma_f32_16x16x32_bf16 v[240:243], v[196:199], a[20:23], v[240:243]
    v_mfma_f32_16x16x32_bf16 v[244:247], v[196:199], a[28:31], v[244:247]
    ds_read_b128 v[188:191], v248 offset:11264
    v_mfma_f32_16x16x32_bf16 v[244:247], v[192:195], a[24:27], v[244:247]
    s_waitcnt lgkmcnt(4)
    v_mfma_f32_16x16x32_bf16 v[16:19], v[168:171], a[32:35], v[16:19]
    ds_read_b128 v[192:195], v248 offset:3072
    v_mfma_f32_16x16x32_bf16 v[16:19], v[172:175], a[36:39], v[16:19]
    v_mfma_f32_16x16x32_bf16 v[20:23], v[172:175], a[44:47], v[20:23]
    ds_read_b128 v[196:199], v248 offset:12288
    v_mfma_f32_16x16x32_bf16 v[20:23], v[168:171], a[40:43], v[20:23]
    s_waitcnt lgkmcnt(4)
    v_mfma_f32_16x16x32_bf16 v[24:27], v[176:179], a[32:35], v[24:27]
    ds_read_b128 v[168:171], v248 offset:4096
    v_mfma_f32_16x16x32_bf16 v[24:27], v[180:183], a[36:39], v[24:27]
    v_mfma_f32_16x16x32_bf16 v[28:31], v[180:183], a[44:47], v[28:31]
    ds_read_b128 v[172:175], v248 offset:13312
    v_mfma_f32_16x16x32_bf16 v[28:31], v[176:179], a[40:43], v[28:31]
    s_waitcnt lgkmcnt(4)
    v_mfma_f32_16x16x32_bf16 v[32:35], v[184:187], a[32:35], v[32:35]
    ds_read_b128 v[176:179], v248 offset:5120
    v_mfma_f32_16x16x32_bf16 v[32:35], v[188:191], a[36:39], v[32:35]
    v_mfma_f32_16x16x32_bf16 v[36:39], v[188:191], a[44:47], v[36:39]
    ds_read_b128 v[180:183], v248 offset:14336
    v_mfma_f32_16x16x32_bf16 v[36:39], v[184:187], a[40:43], v[36:39]
    s_waitcnt lgkmcnt(4)
    v_mfma_f32_16x16x32_bf16 v[200:203], v[192:195], a[32:35], v[200:203]
    ds_read_b128 v[184:187], v248 offset:6144
    v_mfma_f32_16x16x32_bf16 v[200:203], v[196:199], a[36:39], v[200:203]
    v_mfma_f32_16x16x32_bf16 v[204:207], v[196:199], a[44:47], v[204:207]
    ds_read_b128 v[188:191], v248 offset:15360
    v_mfma_f32_16x16x32_bf16 v[204:207], v[192:195], a[40:43], v[204:207]
    s_waitcnt lgkmcnt(4)
    v_mfma_f32_16x16x32_bf16 v[208:211], v[168:171], a[32:35], v[208:211]
    ds_read_b128 v[192:195], v248 offset:7168
    v_mfma_f32_16x16x32_bf16 v[208:211], v[172:175], a[36:39], v[208:211]
    v_mfma_f32_16x16x32_bf16 v[212:215], v[172:175], a[44:47], v[212:215]
    ds_read_b128 v[196:199], v248 offset:16384
    v_mfma_f32_16x16x32_bf16 v[212:215], v[168:171], a[40:43], v[212:215]
    s_waitcnt lgkmcnt(4)
    v_mfma_f32_16x16x32_bf16 v[216:219], v[176:179], a[32:35], v[216:219]
    ds_read_b128 v[168:171], v248 offset:8192
    v_mfma_f32_16x16x32_bf16 v[216:219], v[180:183], a[36:39], v[216:219]
    v_mfma_f32_16x16x32_bf16 v[220:223], v[180:183], a[44:47], v[220:223]
    ds_read_b128 v[172:175], v248 offset:17408
    v_mfma_f32_16x16x32_bf16 v[220:223], v[176:179], a[40:43], v[220:223]
    s_waitcnt lgkmcnt(4)
    v_mfma_f32_16x16x32_bf16 v[224:227], v[184:187], a[32:35], v[224:227]
    ds_read_b128 v[176:179], v248 offset:18432
    v_mfma_f32_16x16x32_bf16 v[224:227], v[188:191], a[36:39], v[224:227]
    v_mfma_f32_16x16x32_bf16 v[228:231], v[188:191], a[44:47], v[228:231]
    ds_read_b128 v[180:183], v248 offset:27648
    v_mfma_f32_16x16x32_bf16 v[228:231], v[184:187], a[40:43], v[228:231]
    s_waitcnt lgkmcnt(4)
    v_mfma_f32_16x16x32_bf16 v[232:235], v[192:195], a[32:35], v[232:235]
    ds_read_b128 v[184:187], v248 offset:19456
    v_mfma_f32_16x16x32_bf16 v[232:235], v[196:199], a[36:39], v[232:235]
    v_mfma_f32_16x16x32_bf16 v[236:239], v[196:199], a[44:47], v[236:239]
    ds_read_b128 v[188:191], v248 offset:28672
    v_mfma_f32_16x16x32_bf16 v[236:239], v[192:195], a[40:43], v[236:239]
    s_waitcnt lgkmcnt(4)
    v_mfma_f32_16x16x32_bf16 v[240:243], v[168:171], a[32:35], v[240:243]
    ds_read_b128 v[192:195], v248 offset:20480
    v_mfma_f32_16x16x32_bf16 v[240:243], v[172:175], a[36:39], v[240:243]
    v_mfma_f32_16x16x32_bf16 v[244:247], v[172:175], a[44:47], v[244:247]
    ds_read_b128 v[196:199], v248 offset:29696
    v_mfma_f32_16x16x32_bf16 v[244:247], v[168:171], a[40:43], v[244:247]
    s_waitcnt lgkmcnt(4)
    v_mfma_f32_16x16x32_bf16 v[16:19], v[176:179], a[48:51], v[16:19]
    ds_read_b128 v[168:171], v248 offset:21504
    v_mfma_f32_16x16x32_bf16 v[16:19], v[180:183], a[52:55], v[16:19]
    s_waitcnt vmcnt(11)
    v_mfma_f32_16x16x32_bf16 v[20:23], v[180:183], a[60:63], v[20:23]
    ds_read_b128 v[172:175], v248 offset:30720
    v_mfma_f32_16x16x32_bf16 v[20:23], v[176:179], a[56:59], v[20:23]
    s_waitcnt lgkmcnt(4)
    v_mfma_f32_16x16x32_bf16 v[24:27], v[184:187], a[48:51], v[24:27]
    ds_read_b128 v[176:179], v248 offset:22528
    v_mfma_f32_16x16x32_bf16 v[24:27], v[188:191], a[52:55], v[24:27]
    v_mfma_f32_16x16x32_bf16 v[28:31], v[188:191], a[60:63], v[28:31]
    ds_read_b128 v[180:183], v248 offset:31744
    v_mfma_f32_16x16x32_bf16 v[28:31], v[184:187], a[56:59], v[28:31]
    s_waitcnt lgkmcnt(4)
    v_mfma_f32_16x16x32_bf16 v[32:35], v[192:195], a[48:51], v[32:35]
    ds_read_b128 v[184:187], v248 offset:23552
    v_mfma_f32_16x16x32_bf16 v[32:35], v[196:199], a[52:55], v[32:35]
    v_mfma_f32_16x16x32_bf16 v[36:39], v[196:199], a[60:63], v[36:39]
    ds_read_b128 v[188:191], v248 offset:32768
    v_mfma_f32_16x16x32_bf16 v[36:39], v[192:195], a[56:59], v[36:39]
    s_waitcnt lgkmcnt(4)
    v_mfma_f32_16x16x32_bf16 v[200:203], v[168:171], a[48:51], v[200:203]
    ds_read_b128 v[192:195], v248 offset:24576
    v_mfma_f32_16x16x32_bf16 v[200:203], v[172:175], a[52:55], v[200:203]
    v_mfma_f32_16x16x32_bf16 v[204:207], v[172:175], a[60:63], v[204:207]
    ds_read_b128 v[196:199], v248 offset:33792
    v_mfma_f32_16x16x32_bf16 v[204:207], v[168:171], a[56:59], v[204:207]
    s_waitcnt lgkmcnt(4)
    v_mfma_f32_16x16x32_bf16 v[208:211], v[176:179], a[48:51], v[208:211]
    ds_read_b128 v[168:171], v248 offset:25600
    v_mfma_f32_16x16x32_bf16 v[208:211], v[180:183], a[52:55], v[208:211]
    v_mfma_f32_16x16x32_bf16 v[212:215], v[180:183], a[60:63], v[212:215]
    ds_read_b128 v[172:175], v248 offset:34816
    v_mfma_f32_16x16x32_bf16 v[212:215], v[176:179], a[56:59], v[212:215]
    s_waitcnt lgkmcnt(4)
    v_mfma_f32_16x16x32_bf16 v[216:219], v[184:187], a[48:51], v[216:219]
    ds_read_b128 v[176:179], v248 offset:26624
    v_mfma_f32_16x16x32_bf16 v[216:219], v[188:191], a[52:55], v[216:219]
    v_mfma_f32_16x16x32_bf16 v[220:223], v[188:191], a[60:63], v[220:223]
    ds_read_b128 v[180:183], v248 offset:35840
    v_mfma_f32_16x16x32_bf16 v[220:223], v[184:187], a[56:59], v[220:223]
    s_waitcnt vmcnt(0)
    s_barrier
    s_waitcnt lgkmcnt(4)
    v_mfma_f32_16x16x32_bf16 v[224:227], v[192:195], a[48:51], v[224:227]
    ds_read_b128 v[184:187], v250 offset:0
    v_mfma_f32_16x16x32_bf16 v[224:227], v[196:199], a[52:55], v[224:227]
    v_mfma_f32_16x16x32_bf16 v[228:231], v[196:199], a[60:63], v[228:231]
    v_mfma_f32_16x16x32_bf16 v[228:231], v[192:195], a[56:59], v[228:231]
    s_waitcnt lgkmcnt(3)
    v_mfma_f32_16x16x32_bf16 v[232:235], v[168:171], a[48:51], v[232:235]
    ds_read_b128 v[192:195], v250 offset:1024
    v_mfma_f32_16x16x32_bf16 v[232:235], v[172:175], a[52:55], v[232:235]
    v_mfma_f32_16x16x32_bf16 v[236:239], v[172:175], a[60:63], v[236:239]
    v_mfma_f32_16x16x32_bf16 v[236:239], v[168:171], a[56:59], v[236:239]
    s_waitcnt lgkmcnt(2)
    v_mfma_f32_16x16x32_bf16 v[240:243], v[176:179], a[48:51], v[240:243]
    ds_read_b128 v[168:171], v250 offset:2048
    v_mfma_f32_16x16x32_bf16 v[240:243], v[180:183], a[52:55], v[240:243]
    v_mfma_f32_16x16x32_bf16 v[244:247], v[180:183], a[60:63], v[244:247]
    v_mfma_f32_16x16x32_bf16 v[244:247], v[176:179], a[56:59], v[244:247]
    s_waitcnt lgkmcnt(2)
    v_mfma_f32_16x16x32_bf16 v[16:19], v[184:187], a[64:67], v[16:19]
    ds_read_b128 v[176:179], v250 offset:3072
    v_mfma_f32_16x16x32_bf16 v[20:23], v[184:187], a[72:75], v[20:23]
    s_waitcnt lgkmcnt(2)
    v_mfma_f32_16x16x32_bf16 v[24:27], v[192:195], a[64:67], v[24:27]
    ds_read_b128 v[184:187], v250 offset:4096
    v_mfma_f32_16x16x32_bf16 v[28:31], v[192:195], a[72:75], v[28:31]
    s_waitcnt lgkmcnt(2)
    v_mfma_f32_16x16x32_bf16 v[32:35], v[168:171], a[64:67], v[32:35]
    ds_read_b128 v[192:195], v250 offset:5120
    v_mfma_f32_16x16x32_bf16 v[36:39], v[168:171], a[72:75], v[36:39]
    s_waitcnt lgkmcnt(2)
    v_mfma_f32_16x16x32_bf16 v[200:203], v[176:179], a[64:67], v[200:203]
    ds_read_b128 v[168:171], v250 offset:6144
    v_mfma_f32_16x16x32_bf16 v[204:207], v[176:179], a[72:75], v[204:207]
    s_waitcnt lgkmcnt(2)
    v_mfma_f32_16x16x32_bf16 v[208:211], v[184:187], a[64:67], v[208:211]
    ds_read_b128 v[176:179], v250 offset:7168
    v_mfma_f32_16x16x32_bf16 v[212:215], v[184:187], a[72:75], v[212:215]
    s_waitcnt lgkmcnt(2)
    v_mfma_f32_16x16x32_bf16 v[216:219], v[192:195], a[64:67], v[216:219]
    ds_read_b128 v[184:187], v250 offset:8192
    v_mfma_f32_16x16x32_bf16 v[220:223], v[192:195], a[72:75], v[220:223]
    s_waitcnt lgkmcnt(2)
    v_mfma_f32_16x16x32_bf16 v[224:227], v[168:171], a[64:67], v[224:227]
    v_mfma_f32_16x16x32_bf16 v[228:231], v[168:171], a[72:75], v[228:231]
    s_waitcnt lgkmcnt(1)
    v_mfma_f32_16x16x32_bf16 v[232:235], v[176:179], a[64:67], v[232:235]
    v_mfma_f32_16x16x32_bf16 v[236:239], v[176:179], a[72:75], v[236:239]
    s_waitcnt lgkmcnt(0)
    v_mfma_f32_16x16x32_bf16 v[240:243], v[184:187], a[64:67], v[240:243]
    v_mfma_f32_16x16x32_bf16 v[244:247], v[184:187], a[72:75], v[244:247]
    v_cvt_pk_bf16_f32 v14, v212, v213
    v_cvt_pk_bf16_f32 v15, v214, v215
    v_cndmask_b32 v62, v14, v15, s[94:95]
    v_cndmask_b32 v74, v15, v14, s[94:95]
    v_cvt_pk_bf16_f32 v4, v208, v209
    v_cvt_pk_bf16_f32 v5, v210, v211
    v_cndmask_b32 v50, v5, v4, s[94:95]
    v_cvt_pk_bf16_f32 v52, v20, v21
    v_cvt_pk_bf16_f32 v53, v22, v23
    v_cvt_pk_bf16_f32 v54, v28, v29
    buffer_store_dwordx4 v[52:55], v11, s[16:19], s87 offen offset:0 sc1
    v_cvt_pk_bf16_f32 v56, v30, v31
    v_cvt_pk_bf16_f32 v57, v36, v37
    v_cvt_pk_bf16_f32 v58, v38, v39
    buffer_store_dwordx4 v[56:59], v11, s[16:19], s87 offen offset:1024 sc1
    v_cvt_pk_bf16_f32 v60, v204, v205
    v_cvt_pk_bf16_f32 v61, v206, v207
    buffer_store_dwordx4 v[60:63], v11, s[16:19], s87 offen offset:2048 sc1
    v_cvt_pk_bf16_f32 v64, v244, v245
    v_cvt_pk_bf16_f32 v65, v246, v247
    v_cvt_pk_bf16_f32 v66, v236, v237
    buffer_store_dwordx4 v[64:67], v11, s[16:19], s88 offen offset:0 sc1
    v_cvt_pk_bf16_f32 v68, v238, v239
    v_cvt_pk_bf16_f32 v69, v228, v229
    v_cvt_pk_bf16_f32 v70, v230, v231
    buffer_store_dwordx4 v[68:71], v11, s[16:19], s88 offen offset:1024 sc1
    v_cvt_pk_bf16_f32 v72, v220, v221
    v_cvt_pk_bf16_f32 v73, v222, v223
    buffer_store_dwordx4 v[72:75], v11, s[16:19], s88 offen offset:2048 sc1
    v_cvt_pk_bf16_f32 v40, v240, v241
    v_cvt_pk_bf16_f32 v41, v242, v243
    v_cvt_pk_bf16_f32 v42, v232, v233
    buffer_store_dwordx4 v[40:43], v11, s[16:19], s86 offen offset:0 sc1
    v_cvt_pk_bf16_f32 v44, v234, v235
    v_cvt_pk_bf16_f32 v45, v224, v225
    v_cvt_pk_bf16_f32 v46, v226, v227
    buffer_store_dwordx4 v[44:47], v11, s[16:19], s86 offen offset:1024 sc1
    v_cvt_pk_bf16_f32 v48, v216, v217
    v_cvt_pk_bf16_f32 v49, v218, v219
    buffer_store_dwordx4 v[48:51], v11, s[16:19], s86 offen offset:2048 sc1
    v_cndmask_b32 v12, v208, v210, s[94:95]
    v_cndmask_b32 v13, v209, v211, s[94:95]
    s_mov_b32 s31, 200000
    s_add_u32 s81, s79, 3072
    s_add_u32 s39, s79, 6144
L_recv:
    buffer_load_dwordx4 v[116:119], v11, s[16:19], s81 offen offset:0 sc1
    buffer_load_dwordx4 v[120:123], v11, s[16:19], s81 offen offset:1024 sc1
    buffer_load_dwordx4 v[124:127], v11, s[16:19], s81 offen offset:2048 sc1
    buffer_load_dwordx4 v[128:131], v11, s[16:19], s39 offen offset:0 sc1
    buffer_load_dwordx4 v[132:135], v11, s[16:19], s39 offen offset:1024 sc1
    buffer_load_dwordx4 v[136:139], v11, s[16:19], s39 offen offset:2048 sc1
    buffer_load_dwordx4 v[104:107], v11, s[16:19], s79 offen offset:0 sc1
    buffer_load_dwordx4 v[108:111], v11, s[16:19], s79 offen offset:1024 sc1
    buffer_load_dwordx4 v[112:115], v11, s[16:19], s79 offen offset:2048 sc1
    s_waitcnt vmcnt(6)
    v_min3_u32 v14, v119, v123, v127
    v_max3_u32 v15, v119, v123, v127
    s_waitcnt vmcnt(4)
    v_min3_u32 v14, v131, v135, v14
    v_max3_u32 v15, v131, v135, v15
    s_waitcnt vmcnt(2)
    v_min3_u32 v14, v139, v107, v14
    v_max3_u32 v15, v139, v107, v15
    s_waitcnt vmcnt(0)
    v_min3_u32 v14, v111, v115, v14
    v_max3_u32 v15, v111, v115, v15
    v_xor_b32 v14, s80, v14
    v_xor_b32 v15, s80, v15
    v_or_b32 v14, v14, v15
    v_cmp_ne_u32 vcc, 0, v14
    s_nop 4
    s_cbranch_vccnz L_slow_x
L_got:
    v_lshlrev_b32 v14, 16, v104
    v_and_b32 v104, 0xffff0000, v104
    v_add_f32 v16, v16, v14
    v_add_f32 v17, v17, v104
    v_lshlrev_b32 v14, 16, v116
    v_and_b32 v116, 0xffff0000, v116
    v_add_f32 v16, v16, v14
    v_add_f32 v17, v17, v116
    v_lshlrev_b32 v14, 16, v128
    v_and_b32 v128, 0xffff0000, v128
    v_add_f32 v16, v16, v14
    v_add_f32 v17, v17, v128
    v_lshlrev_b32 v14, 16, v105
    v_and_b32 v105, 0xffff0000, v105
    v_add_f32 v18, v18, v14
    v_add_f32 v19, v19, v105
    v_lshlrev_b32 v14, 16, v117
    v_and_b32 v117, 0xffff0000, v117
    v_add_f32 v18, v18, v14
    v_add_f32 v19, v19, v117
    v_lshlrev_b32 v14, 16, v129
    v_and_b32 v129, 0xffff0000, v129
    v_add_f32 v18, v18, v14
    v_add_f32 v19, v19, v129
    v_cvt_pk_bf16_f32 v16, v16, v17
    v_cvt_pk_bf16_f32 v17, v18, v19
    buffer_store_dwordx2 v[16:17], v10, s[8:11], s89 offen
    v_lshlrev_b32 v14, 16, v106
    v_and_b32 v106, 0xffff0000, v106
    v_add_f32 v24, v24, v14
    v_add_f32 v25, v25, v106
    v_lshlrev_b32 v14, 16, v118
    v_and_b32 v118, 0xffff0000, v118
    v_add_f32 v24, v24, v14
    v_add_f32 v25, v25, v118
    v_lshlrev_b32 v14, 16, v130
    v_and_b32 v130, 0xffff0000, v130
    v_add_f32 v24, v24, v14
    v_add_f32 v25, v25, v130
    v_lshlrev_b32 v14, 16, v108
    v_and_b32 v108, 0xffff0000, v108
    v_add_f32 v26, v26, v14
    v_add_f32 v27, v27, v108
    v_lshlrev_b32 v14, 16, v120
    v_and_b32 v120, 0xffff0000, v120
    v_add_f32 v26, v26, v14
    v_add_f32 v27, v27, v120
    v_lshlrev_b32 v14, 16, v132
    v_and_b32 v132, 0xffff0000, v132
    v_add_f32 v26, v26, v14
    v_add_f32 v27, v27, v132
    v_cvt_pk_bf16_f32 v24, v24, v25
    v_cvt_pk_bf16_f32 v25, v26, v27
    buffer_store_dwordx2 v[24:25], v10, s[8:11], s90 offen
    v_lshlrev_b32 v14, 16, v109
    v_and_b32 v109, 0xffff0000, v109
    v_add_f32 v32, v32, v14
    v_add_f32 v33, v33, v109
    v_lshlrev_b32 v14, 16, v121
    v_and_b32 v121, 0xffff0000, v121
    v_add_f32 v32, v32, v14
    v_add_f32 v33, v33, v121
    v_lshlrev_b32 v14, 16, v133
    v_and_b32 v133, 0xffff0000, v133
    v_add_f32 v32, v32, v14
    v_add_f32 v33, v33, v133
    v_lshlrev_b32 v14, 16, v110
    v_and_b32 v110, 0xffff0000, v110
    v_add_f32 v34, v34, v14
    v_add_f32 v35, v35, v110
    v_lshlrev_b32 v14, 16, v122
    v_and_b32 v122, 0xffff0000, v122
    v_add_f32 v34, v34, v14
    v_add_f32 v35, v35, v122
    v_lshlrev_b32 v14, 16, v134
    v_and_b32 v134, 0xffff0000, v134
    v_add_f32 v34, v34, v14
    v_add_f32 v35, v35, v134
    v_cvt_pk_bf16_f32 v32, v32, v33
    v_cvt_pk_bf16_f32 v33, v34, v35
    buffer_store_dwordx2 v[32:33], v10, s[8:11], s91 offen
    v_lshlrev_b32 v14, 16, v112
    v_and_b32 v112, 0xffff0000, v112
    v_add_f32 v200, v200, v14
    v_add_f32 v201, v201, v112
    v_lshlrev_b32 v14, 16, v124
    v_and_b32 v124, 0xffff0000, v124
    v_add_f32 v200, v200, v14
    v_add_f32 v201, v201, v124
    v_lshlrev_b32 v14, 16, v136
    v_and_b32 v136, 0xffff0000, v136
    v_add_f32 v200, v200, v14
    v_add_f32 v201, v201, v136
    v_lshlrev_b32 v14, 16, v113
    v_and_b32 v113, 0xffff0000, v113
    v_add_f32 v202, v202, v14
    v_add_f32 v203, v203, v113
    v_lshlrev_b32 v14, 16, v125
    v_and_b32 v125, 0xffff0000, v125
    v_add_f32 v202, v202, v14
    v_add_f32 v203, v203, v125
    v_lshlrev_b32 v14, 16, v137
    v_and_b32 v137, 0xffff0000, v137
    v_add_f32 v202, v202, v14
    v_add_f32 v203, v203, v137
    v_cvt_pk_bf16_f32 v200, v200, v201
    v_cvt_pk_bf16_f32 v201, v202, v203
    buffer_store_dwordx2 v[200:201], v10, s[8:11], s92 offen
    v_lshlrev_b32 v14, 16, v114
    v_and_b32 v114, 0xffff0000, v114
    v_add_f32 v12, v12, v14
    v_add_f32 v13, v13, v114
    v_lshlrev_b32 v14, 16, v126
    v_and_b32 v126, 0xffff0000, v126
    v_add_f32 v12, v12, v14
    v_add_f32 v13, v13, v126
    v_lshlrev_b32 v14, 16, v138
    v_and_b32 v138, 0xffff0000, v138
    v_add_f32 v12, v12, v14
    v_add_f32 v13, v13, v138
    v_cvt_pk_bf16_f32 v12, v12, v13
    buffer_store_dword v12, v10, s[8:11], s93 offen
L_end:
    s_endpgm
L_slow_non:
    s_mov_b32 s39, 200000
L_spin_non:
    s_sleep 4
    v_mov_b32 v1, 0
    buffer_load_dword v1, v1, s[20:23], 0 offen sc1
    s_waitcnt vmcnt(0)
    v_readfirstlane_b32 s80, v1
    s_nop 4
    s_sub_u32 s39, s39, 1
    s_cmp_eq_u32 s39, 0
    s_cbranch_scc1 L_ok_non
    s_cmp_lg_u32 s80, 0
    s_cbranch_scc0 L_spin_non
    s_branch L_ok_non
L_slow_cq:
    s_mov_b32 s39, 200000
L_spin_cq:
    s_sleep 4
    v_bfe_u32 v1, v11, 4, 6
    v_lshlrev_b32 v1, 7, v1
    buffer_load_dword v1, v1, s[16:19], s0 offen sc1
    s_waitcnt vmcnt(0)
    v_cmp_ne_u32 vcc, s1, v1
    s_nop 4
    s_sub_u32 s39, s39, 1
    s_cmp_eq_u32 s39, 0
    s_cbranch_scc1 L_ok_cq
    s_cbranch_vccnz L_spin_cq
    s_branch L_ok_cq
L_slow_m1:
    s_mov_b32 s39, 200000
L_spin_m1:
    s_sleep 4
    v_bfe_u32 v1, v11, 4, 6
    v_lshlrev_b32 v1, 7, v1
    buffer_load_dword v1, v1, s[16:19], s0 offen sc1
    s_waitcnt vmcnt(0)
    v_cmp_ne_u32 vcc, s1, v1
    s_nop 4
    s_sub_u32 s39, s39, 1
    s_cmp_eq_u32 s39, 0
    s_cbranch_scc1 L_ok_m1
    s_cbranch_vccnz L_spin_m1
    s_branch L_ok_m1
L_slow_kv:
    s_mov_b32 s39, 200000
L_spin_kv:
    s_sub_u32 s39, s39, 1
    s_cmp_eq_u32 s39, 0
    s_cbranch_scc1 L_ok_kv
    s_sleep 4
    v_bfe_u32 v12, v11, 4, 3
    v_lshlrev_b32 v12, 10, v12
    buffer_load_dword v12, v12, s[16:19], s76 offen offset:1020 sc1
    s_waitcnt vmcnt(0)
    v_cmp_ne_u32 vcc, s80, v12
    s_nop 4
    s_cbranch_vccnz L_spin_kv
    buffer_load_dwordx4 v[168:171], v11, s[16:19], s76 offen offset:0 sc1
    buffer_load_dwordx4 v[172:175], v11, s[16:19], s76 offen offset:1024 sc1
    buffer_load_dwordx4 v[176:179], v11, s[16:19], s76 offen offset:2048 sc1
    buffer_load_dwordx4 v[180:183], v11, s[16:19], s76 offen offset:3072 sc1
    buffer_load_dwordx4 v[184:187], v11, s[16:19], s77 offen offset:0 sc1
    buffer_load_dwordx4 v[188:191], v11, s[16:19], s77 offen offset:1024 sc1
    buffer_load_dwordx4 v[192:195], v11, s[16:19], s77 offen offset:2048 sc1
    buffer_load_dwordx4 v[196:199], v11, s[16:19], s77 offen offset:3072 sc1
    s_waitcnt vmcnt(0)
    v_min_u32 v12, v171, v175
    v_max_u32 v13, v171, v175
    v_min3_u32 v12, v179, v183, v12
    v_max3_u32 v13, v179, v183, v13
    v_min3_u32 v12, v187, v191, v12
    v_max3_u32 v13, v187, v191, v13
    v_min3_u32 v12, v195, v199, v12
    v_max3_u32 v13, v195, v199, v13
    v_xor_b32 v12, s80, v12
    v_xor_b32 v13, s80, v13
    v_or_b32 v12, v12, v13
    v_cmp_ne_u32 vcc, 0, v12
    s_nop 4
    s_cbranch_vccnz L_spin_kv
    s_branch L_ok_kv
L_slow_m3:
    s_mov_b32 s39, 200000
L_spin_m3:
    s_sleep 4
    v_bfe_u32 v1, v11, 4, 3
    v_lshlrev_b32 v1, 7, v1
    buffer_load_dword v1, v1, s[16:19], s0 offen sc1
    s_waitcnt vmcnt(0)
    v_cmp_ne_u32 vcc, s1, v1
    s_nop 4
    s_sub_u32 s39, s39, 1
    s_cmp_eq_u32 s39, 0
    s_cbranch_scc1 L_ok_m3
    s_cbranch_vccnz L_spin_m3
    s_branch L_ok_m3
L_slow_m2:
    s_mov_b32 s39, 200000
L_spin_m2:
    s_sleep 4
    v_bfe_u32 v1, v11, 4, 3
    v_lshlrev_b32 v1, 7, v1
    buffer_load_dword v1, v1, s[16:19], s0 offen sc1
    s_waitcnt vmcnt(0)
    v_cmp_ne_u32 vcc, s1, v1
    s_nop 4
    s_sub_u32 s39, s39, 1
    s_cmp_eq_u32 s39, 0
    s_cbranch_scc1 L_ok_m2
    s_cbranch_vccnz L_spin_m2
    s_branch L_ok_m2
L_slow_m3w:
    s_mov_b32 s39, 200000
L_spin_m3w:
    s_sleep 4
    v_bfe_u32 v1, v11, 4, 5
    v_lshlrev_b32 v1, 7, v1
    buffer_load_dword v1, v1, s[16:19], s0 offen sc1
    s_waitcnt vmcnt(0)
    v_cmp_ne_u32 vcc, s1, v1
    s_nop 4
    s_sub_u32 s39, s39, 1
    s_cmp_eq_u32 s39, 0
    s_cbranch_scc1 L_ok_m3w
    s_cbranch_vccnz L_spin_m3w
    s_branch L_ok_m3w
L_slow_x:
    s_sub_u32 s31, s31, 1
    s_cmp_eq_u32 s31, 0
    s_cbranch_scc1 L_got
    s_sleep 2
    v_bfe_u32 v14, v11, 4, 2
    v_min_u32 v14, 2, v14
    v_mul_u32_u24 v14, 3072, v14
    buffer_load_dword v14, v14, s[16:19], s79 offen offset:3068 sc1
    s_waitcnt vmcnt(0)
    v_cmp_ne_u32 vcc, s80, v14
    s_nop 4
    s_cbranch_vccnz L_slow_x
    s_branch L_recv
L_code_end:
.section .rodata,"a"
.p2align 6
.amdhsa_kernel gated_mix__linear_attn_block__glu_gated_bilinear__prompt_kernel
  .amdhsa_next_free_vgpr 512
  .amdhsa_next_free_sgpr 102
  .amdhsa_accum_offset 256
  .amdhsa_group_segment_fixed_size 0
  .amdhsa_kernarg_size 88
  .amdhsa_user_sgpr_count 2
  .amdhsa_user_sgpr_kernarg_segment_ptr 1
  .amdhsa_system_sgpr_workgroup_id_x 1
.end_amdhsa_kernel
```
